```python
import torch

def _softmax(x, axis=-1):
    return torch.softmax(x, dim=axis)
def _gelu(x):
    return torch.nn.functional.gelu(x, approximate="tanh")
def _silu(x):
    return torch.nn.functional.silu(x)
def _sigmoid(x):
    return torch.sigmoid(x)
def _layernorm(x, axis=-1, eps=1e-5):
    m = x.mean(dim=axis, keepdim=True)
    v = x.var(dim=axis, keepdim=True, unbiased=False)
    return (x - m) / torch.sqrt(v + eps)
def _scatter_add(tgt, idx, src, axis=0):
    return tgt.clone().index_add_(axis, idx, src)
def _segment_sum(src, seg, n):
    out = torch.zeros((n,) + src.shape[1:], dtype=src.dtype)
    return out.index_add_(0, seg, src)
def _pad(x, pw):
    flat = tuple(v for pair in reversed(pw) for v in pair)
    return torch.nn.functional.pad(x, flat)

kernel_name = 'standalone__mha_block_cached__near_ridge'

def setup_inputs():

    _w = (lambda a: (lambda t: t.to(torch.bfloat16) if t.is_floating_point() else t)(torch.as_tensor(a)))
    B, Sq, D = 16, 64, 1024
    H, Sk, Dh = 32, 512, 128
    return {
        "x": _w((lambda *s: torch.randn(*s, dtype=torch.bfloat16) * 0.8)(B, Sq, D)),
        "k_cache": _w((lambda *s: torch.randn(*s, dtype=torch.bfloat16) * 0.8)(B, H, Sk, Dh)),
        "v_cache": _w((lambda *s: torch.randn(*s, dtype=torch.bfloat16) * 0.05)(B, H, Sk, Dh)),
        "wq": _w((lambda *s: torch.randn(*s, dtype=torch.bfloat16) * 0.8)(D, H * Dh) * (D ** -0.5)),
        "wo": _w((lambda *s: torch.randn(*s, dtype=torch.bfloat16) * 0.05)(H * Dh, D) * ((H * Dh) ** -0.5)),
    }

def reference(x, k_cache, v_cache, wq, wo):
    B, Sq, D = x.shape
    H, Dh = 32, 128
    q = (lambda x, *d: x.permute(*d))((x @ wq).reshape(B, Sq, H, Dh), 0, 2, 1, 3)
    scores = torch.einsum("bhqd,bhkd->bhqk", q, k_cache) * (Dh ** -0.5)
    p = _softmax(scores, axis=-1)
    o = torch.einsum("bhqk,bhkd->bhqd", p, v_cache)
    return (lambda x, *d: x.permute(*d))(o, 0, 2, 1, 3).reshape(B, Sq, H * Dh) @ wo
```

```asm
; @launch grid=(256,1,1) block=(256,1,1) lds=163840
.amdgcn_target "amdgcn-amd-amdhsa--gfx950"
.text
.globl standalone__mha_block_cached__near_ridge_kernel
.p2align 8
.type standalone__mha_block_cached__near_ridge_kernel,@function
standalone__mha_block_cached__near_ridge_kernel:
    s_cmp_ge_u32 s2, 256
    s_cbranch_scc1 L_end
    s_load_dwordx8 s[4:11], s[0:1], 0
    s_load_dwordx8 s[80:87], s[0:1], 32
    v_lshrrev_b32 v56, 6, v0
    v_and_b32 v1, 63, v0
    v_readfirstlane_b32 s3, v56
    s_and_b32 s69, s2, 3
    s_bfe_u32 s68, s2, 0x30003
    s_bfe_u32 s66, s2, 0x10000
    s_bfe_u32 s61, s2, 0x10001
    s_lshl_b32 s61, s61, 3
    s_or_b32 s66, s66, s61
    s_bfe_u32 s61, s2, 0x20003
    s_lshl_b32 s61, s61, 1
    s_or_b32 s66, s66, s61
    s_bfe_u32 s61, s2, 0x10005
    s_lshl_b32 s61, s61, 4
    s_or_b32 s66, s66, s61
    s_bfe_u32 s67, s2, 0x10002
    s_lshl_b32 s67, s67, 3
    s_bfe_u32 s61, s2, 0x20006
    s_lshl_b32 s61, s61, 1
    s_or_b32 s67, s67, s61
    s_lshr_b32 s70, s2, 6
    s_lshl_b32 s64, s70, 1
    s_xor_b32 s59, s68, s64
    s_lshl_b32 s59, s59, 0
    s_lshl_b32 s14, s3, 12
    v_lshrrev_b32 v56, 3, v1
    v_lshlrev_b32 v56, 11, v56
    v_lshrrev_b32 v57, 4, v1
    v_and_b32 v58, 7, v1
    v_xor_b32 v58, v58, v57
    v_lshl_add_u32 v2, v58, 4, v56
    v_xor_b32 v59, 64, v2
    v_add_u32 v3, 15360, v59
    v_add_u32 v4, 30720, v2
    v_add_u32 v5, 46080, v59
    v_and_b32 v58, 15, v1
    v_lshlrev_b32 v59, 2, v57
    v_xor_b32 v59, v58, v59
    v_lshlrev_b32 v59, 4, v59
    v_lshl_add_u32 v6, v57, 13, v59
    v_add_u32 v7, 31744, v6
    v_add_u32 v8, 63488, v6
    v_xor_b32 v8, 32, v8
    v_add_u32 v9, 95232, v6
    v_xor_b32 v9, 32, v9
    s_lshl_b32 s61, s66, 8
    s_lshl_b32 s62, s3, 17
    s_add_u32 s61, s61, s62
    s_sub_u32 s22, 0x800000, s61
    s_mov_b32 s23, 0x20000
    s_lshl_b32 s63, s67, 17
    s_lshl_b32 s62, s3, 16
    s_add_u32 s63, s63, s62
    s_mov_b32 s18, 0x10000
    s_mov_b32 s19, 0x20000
    s_waitcnt lgkmcnt(0)
    s_add_u32 s20, s10, s61
    s_addc_u32 s21, s11, 0
    s_add_u32 s16, s4, s63
    s_addc_u32 s17, s5, 0
    s_xor_b32 s56, s59, 0
    s_add_u32 m0, s14, 114688
    s_lshl_b32 s58, s56, 19
    buffer_load_dwordx4 v6, s[20:23], s58 offen offset:0  lds
    buffer_load_dwordx4 v7, s[20:23], s58 offen offset:1024  lds
    buffer_load_dwordx4 v8, s[20:23], s58 offen offset:2048  lds
    buffer_load_dwordx4 v9, s[20:23], s58 offen offset:3072  lds
    s_add_u32 m0, s14, 65536
    s_lshl_b32 s57, s56, 7
    buffer_load_dwordx4 v2, s[16:19], s57 offen offset:0  lds
    buffer_load_dwordx4 v3, s[16:19], s57 offen offset:1024  lds
    buffer_load_dwordx4 v4, s[16:19], s57 offen offset:2048  lds
    buffer_load_dwordx4 v5, s[16:19], s57 offen offset:3072  lds
    s_getpc_b64 s[34:35]
L_pc:
    s_lshr_b32 s61, s2, 3
    s_lshl_b32 s61, s61, 12
    v_lshlrev_b32 v41, 4, v0
    v_add_u32 v41, s61, v41
    v_min_u32 v41, L_end-L_pc-16, v41
    global_load_dwordx4 v[248:251], v41, s[34:35]
    s_xor_b32 s56, s59, 1
    s_add_u32 m0, s14, 131072
    s_lshl_b32 s58, s56, 19
    buffer_load_dwordx4 v6, s[20:23], s58 offen offset:0  lds
    buffer_load_dwordx4 v7, s[20:23], s58 offen offset:1024  lds
    buffer_load_dwordx4 v8, s[20:23], s58 offen offset:2048  lds
    buffer_load_dwordx4 v9, s[20:23], s58 offen offset:3072  lds
    s_add_u32 m0, s14, 81920
    s_lshl_b32 s57, s56, 7
    buffer_load_dwordx4 v2, s[16:19], s57 offen offset:0  lds
    buffer_load_dwordx4 v3, s[16:19], s57 offen offset:1024  lds
    buffer_load_dwordx4 v4, s[16:19], s57 offen offset:2048  lds
    buffer_load_dwordx4 v5, s[16:19], s57 offen offset:3072  lds
    s_lshr_b32 s61, 0x55, s68
    s_bitcmp1_b32 s61, 0
    s_mov_b32 s100, 0x76543210
    s_cmov_b32 s100, 0x54329810
    s_mov_b32 s101, 0xfedcba98
    s_cmov_b32 s101, 0xfedcba76
    s_mov_b32 s12, 0
    s_and_b32 s13, s3, 1
    s_lshl_b32 s13, s13, 13
    s_xor_b32 s13, s13, s12
    s_getreg_b32 s15, hwreg(HW_REG_XCC_ID, 0, 4)
    s_lshl_b32 s15, s15, 4
    s_mov_b32 s60, 0x3e0293ee
    v_lshlrev_b32 v59, 1, v57
    v_xor_b32 v59, v58, v59
    v_lshlrev_b32 v59, 4, v59
    v_lshl_add_u32 v14, v57, 11, v59
    v_xor_b32 v59, v58, v57
    v_lshlrev_b32 v59, 4, v59
    v_lshl_add_u32 v10, v57, 8, v59
    v_lshlrev_b32 v36, 4, v1
    v_xor_b32 v11, 64, v10
    v_add_u32 v15, 7168, v14
    v_xor_b32 v15, 128, v15
    v_xor_b32 v12, 128, v10
    v_add_u32 v16, 14336, v14
    v_xor_b32 v13, 192, v10
    v_add_u32 v17, 21504, v14
    v_xor_b32 v17, 128, v17
    s_lshr_b32 s62, s3, 1
    s_add_u32 s62, s62, s67
    s_lshl_b32 s61, s62, 5
    s_add_u32 s61, s61, s66
    s_lshl_b32 s61, s61, 17
    s_and_b32 s63, s3, 1
    s_lshl_b32 s64, s63, 12
    s_add_u32 s61, s61, s64
    s_sub_u32 s64, 0x20000, s64
    s_add_u32 s24, s6, s61
    s_addc_u32 s25, s7, 0
    s_mov_b32 s26, s64
    s_mov_b32 s27, 0x20000
    s_lshl_b32 s64, s63, 12
    s_sub_u32 s61, s61, s64
    s_add_u32 s28, s8, s61
    s_addc_u32 s29, s9, 0
    s_mov_b32 s30, 0x20000
    s_mov_b32 s31, 0x20000
    s_lshl_b32 s61, s62, 1
    s_add_u32 s61, s61, s63
    s_lshl_b32 s61, s61, 18
    s_lshl_b32 s64, s69, 16
    s_add_u32 s61, s61, s64
    s_add_u32 s40, s86, s61
    s_addc_u32 s41, s87, 0
    s_mov_b32 s42, 0x10000
    s_mov_b32 s43, 0x20000
    s_add_u32 s44, s86, 0x800000
    s_addc_u32 s45, s87, 0
    s_mov_b32 s46, 0x1200000
    s_mov_b32 s47, 0x20000
    s_add_u32 s92, s84, 0
    s_addc_u32 s93, s85, 0
    s_mov_b32 s94, 0x100
    s_mov_b32 s95, 0x20000
    s_lshl_b32 s62, s70, 1
    s_xor_b32 s62, s62, s68
    s_lshl_b32 s61, s3, 15
    s_lshl_b32 s64, s62, 8
    s_add_u32 s61, s61, s64
    s_sub_u32 s63, 0x800000, s61
    s_add_u32 s36, s80, s61
    s_addc_u32 s37, s81, 0
    s_mov_b32 s38, s63
    s_mov_b32 s39, 0x20000
    s_lshl_b32 s61, s67, 17
    s_lshl_b32 s63, s69, 16
    s_add_u32 s61, s61, s63
    s_lshl_b32 s63, s3, 6
    s_add_u32 s64, s64, s63
    s_add_u32 s61, s61, s64
    s_sub_u32 s63, 65536, s64
    s_add_u32 s48, s82, s61
    s_addc_u32 s49, s83, 0
    s_mov_b32 s50, s63
    s_mov_b32 s51, 0x20000
    v_and_b32 v56, 3, v1
    v_xor_b32 v57, s2, v56
    v_lshlrev_b32 v57, 9, v57
    s_lshl_b32 s61, s3, 7
    v_add_u32 v57, s61, v57
    v_lshl_add_u32 v57, v56, 2, v57
    v_mov_b32 v58, 0x10ffffc
    v_mov_b32 v59, 0x1000000
    v_cmp_eq_u32 vcc, 0, v56
    s_nop 1
    v_cndmask_b32 v58, v58, v59, vcc
    v_add_u32 v39, v57, v58
    v_mov_b32 v59, s15
    v_cndmask_b32 v59, 0, v59, vcc
    s_mov_b64 exec, 15
    buffer_store_dword v59, v39, s[44:47], 0 offen sc1
    s_mov_b64 exec, -1
    s_lshl_b32 s61, s2, 2
    s_add_u32 s61, s61, s3
    s_mul_i32 s91, s61, 12288
    s_xor_b32 s62, s61, 4
    s_mul_i32 s62, s62, 12288
    s_add_u32 s88, s62, 0
    s_xor_b32 s62, s61, 8
    s_mul_i32 s62, s62, 12288
    s_add_u32 s89, s62, 4096
    s_xor_b32 s62, s61, 12
    s_mul_i32 s62, s62, 12288
    s_add_u32 s90, s62, 8192
    v_lshrrev_b32 v56, 2, v1
    v_and_b32 v57, 3, v1
    v_lshlrev_b32 v57, 3, v57
    s_lshr_b32 s61, s3, 1
    s_lshl_b32 s61, s61, 13
    v_bfe_u32 v58, v1, 3, 2
    v_lshl_add_u32 v58, v58, 5, v57
    v_lshl_add_u32 v26, v56, 7, v58
    v_add_u32 v26, s61, v26
    v_xor_b32 v27, 32, v26
    v_xor_b32 v28, 64, v26
    v_xor_b32 v29, 96, v26
    v_and_b32 v58, 7, v56
    v_lshl_add_u32 v58, v58, 5, v57
    v_lshl_add_u32 v30, v56, 8, v58
    s_lshl_b32 s62, s3, 6
    v_xor_b32 v30, s62, v30
    v_xor_b32 v31, 32, v30
    v_lshrrev_b32 v60, 3, v1
    v_lshrrev_b32 v59, 4, v1
    v_lshlrev_b32 v61, 1, v59
    v_and_b32 v62, 7, v1
    v_xor_b32 v61, v61, v62
    v_lshlrev_b32 v61, 4, v61
    v_lshl_add_u32 v18, v60, 8, v61
    v_add_u32 v19, 1024, v18
    v_add_u32 v20, 2048, v18
    v_add_u32 v21, 3072, v18
    v_and_b32 v60, 15, v1
    v_xor_b32 v61, v60, v59
    v_lshlrev_b32 v61, 4, v61
    v_lshl_add_u32 v22, v60, 8, v61
    v_add_u32 v22, s61, v22
    s_and_b32 s63, s3, 1
    s_lshl_b32 s63, s63, 7
    v_xor_b32 v22, s63, v22
    v_xor_b32 v23, 64, v22
    v_xor_b32 v24, 128, v22
    v_xor_b32 v25, 192, v22
    s_lshl_b32 s62, s69, 12
    v_add_u32 v32, s62, v36
    v_xor_b32 v33, 4096, v32
    v_xor_b32 v34, 8192, v32
    v_xor_b32 v35, 12288, v32
    v_and_b32 v60, 7, v1
    v_lshlrev_b32 v60, 3, v60
    v_xor_b32 v60, s2, v60
    v_lshlrev_b32 v60, 9, v60
    s_lshl_b32 s62, s3, 7
    s_add_u32 s62, s62, 0x1000000
    v_add_u32 v38, s62, v60
    v_lshrrev_b32 v56, 4, v1
    v_bfe_u32 v57, v1, 2, 2
    v_and_b32 v58, 3, v1
    v_lshlrev_b32 v58, 3, v58
    v_and_b32 v59, 1, v56
    v_lshl_add_u32 v58, v59, 5, v58
    v_lshl_add_u32 v58, v57, 6, v58
    v_lshl_add_u32 v58, v57, 8, v58
    v_lshl_add_u32 v76, v56, 11, v58
    s_and_b32 s63, s3, 1
    s_lshl_b32 s63, s63, 7
    v_xor_b32 v76, s63, v76
    v_add_u32 v76, 0x1c000, v76
    v_xor_b32 v77, 32, v76
    v_xor_b32 v78, 64, v76
    v_xor_b32 v79, 96, v76
    v_and_b32 v57, 15, v1
    v_lshrrev_b32 v58, 1, v57
    v_xor_b32 v58, v58, v56
    v_lshlrev_b32 v58, 4, v58
    v_lshl_add_u32 v72, v57, 7, v58
    s_add_u32 s63, s14, 0x10000
    v_add_u32 v72, s63, v72
    v_xor_b32 v73, 4096, v72
    v_xor_b32 v74, 64, v72
    v_xor_b32 v75, 64, v73
    s_bfe_u32 s56, s100, 0x40008
    s_xor_b32 s56, s56, s59
    s_add_u32 m0, s14, 147456
    s_lshl_b32 s58, s56, 19
    buffer_load_dwordx4 v6, s[20:23], s58 offen offset:0  lds
    buffer_load_dwordx4 v7, s[20:23], s58 offen offset:1024  lds
    buffer_load_dwordx4 v8, s[20:23], s58 offen offset:2048  lds
    buffer_load_dwordx4 v9, s[20:23], s58 offen offset:3072  lds
    s_add_u32 m0, s14, 98304
    s_lshl_b32 s57, s56, 7
    buffer_load_dwordx4 v2, s[16:19], s57 offen offset:0  lds
    buffer_load_dwordx4 v3, s[16:19], s57 offen offset:1024  lds
    buffer_load_dwordx4 v4, s[16:19], s57 offen offset:2048  lds
    buffer_load_dwordx4 v5, s[16:19], s57 offen offset:3072  lds
    s_lshl_b32 s61, s68, 2
    s_lshr_b32 s54, 0xe0e0e0e0, s61
    s_and_b32 s54, s54, 15
    s_waitcnt vmcnt(18)
    s_barrier
    ds_read_b64_tr_b16 v[56:57], v76 offset:0
    ds_read_b64_tr_b16 v[58:59], v76 offset:1024
    ds_read_b128 v[152:155], v72 offset:0
    ds_read_b128 v[156:159], v72 offset:2048
    ds_read_b64_tr_b16 v[60:61], v77 offset:0
    ds_read_b64_tr_b16 v[62:63], v77 offset:1024
    ds_read_b128 v[160:163], v73 offset:0
    ds_read_b128 v[164:167], v73 offset:2048
    s_waitcnt lgkmcnt(4)
    v_mfma_f32_16x16x32_bf16 v[88:91], v[56:59], v[152:155], 0
    ds_read_b64_tr_b16 v[64:65], v78 offset:0
    v_mfma_f32_16x16x32_bf16 v[104:107], v[56:59], v[156:159], 0
    ds_read_b64_tr_b16 v[66:67], v78 offset:1024
    s_waitcnt lgkmcnt(4)
    v_mfma_f32_16x16x32_bf16 v[92:95], v[60:63], v[152:155], 0
    ds_read_b64_tr_b16 v[68:69], v79 offset:0
    v_mfma_f32_16x16x32_bf16 v[108:111], v[60:63], v[156:159], 0
    ds_read_b64_tr_b16 v[70:71], v79 offset:1024
    s_waitcnt lgkmcnt(4)
    v_mfma_f32_16x16x32_bf16 v[120:123], v[56:59], v[160:163], 0
    v_mfma_f32_16x16x32_bf16 v[136:139], v[56:59], v[164:167], 0
    v_mfma_f32_16x16x32_bf16 v[124:127], v[60:63], v[160:163], 0
    v_mfma_f32_16x16x32_bf16 v[140:143], v[60:63], v[164:167], 0
    s_waitcnt lgkmcnt(0)
    v_mfma_f32_16x16x32_bf16 v[96:99], v[64:67], v[152:155], 0
    ds_read_b64_tr_b16 v[56:57], v76 offset:8192
    ds_read_b64_tr_b16 v[58:59], v76 offset:9216
    v_mfma_f32_16x16x32_bf16 v[112:115], v[64:67], v[156:159], 0
    ds_read_b128 v[168:171], v74 offset:0
    ds_read_b128 v[172:175], v74 offset:2048
    v_mfma_f32_16x16x32_bf16 v[100:103], v[68:71], v[152:155], 0
    ds_read_b64_tr_b16 v[60:61], v77 offset:8192
    v_mfma_f32_16x16x32_bf16 v[116:119], v[68:71], v[156:159], 0
    ds_read_b64_tr_b16 v[62:63], v77 offset:9216
    ds_read_b128 v[176:179], v75 offset:0
    v_mfma_f32_16x16x32_bf16 v[128:131], v[64:67], v[160:163], 0
    ds_read_b128 v[180:183], v75 offset:2048
    v_mfma_f32_16x16x32_bf16 v[144:147], v[64:67], v[164:167], 0
    v_mfma_f32_16x16x32_bf16 v[132:135], v[68:71], v[160:163], 0
    v_mfma_f32_16x16x32_bf16 v[148:151], v[68:71], v[164:167], 0
    s_waitcnt lgkmcnt(4)
    v_mfma_f32_16x16x32_bf16 v[88:91], v[56:59], v[168:171], v[88:91]
    ds_read_b64_tr_b16 v[64:65], v78 offset:8192
    v_mfma_f32_16x16x32_bf16 v[104:107], v[56:59], v[172:175], v[104:107]
    ds_read_b64_tr_b16 v[66:67], v78 offset:9216
    s_waitcnt lgkmcnt(4)
    v_mfma_f32_16x16x32_bf16 v[92:95], v[60:63], v[168:171], v[92:95]
    ds_read_b64_tr_b16 v[68:69], v79 offset:8192
    v_mfma_f32_16x16x32_bf16 v[108:111], v[60:63], v[172:175], v[108:111]
    ds_read_b64_tr_b16 v[70:71], v79 offset:9216
    s_waitcnt lgkmcnt(4)
    v_mfma_f32_16x16x32_bf16 v[120:123], v[56:59], v[176:179], v[120:123]
    v_mfma_f32_16x16x32_bf16 v[136:139], v[56:59], v[180:183], v[136:139]
    v_mfma_f32_16x16x32_bf16 v[124:127], v[60:63], v[176:179], v[124:127]
    v_mfma_f32_16x16x32_bf16 v[140:143], v[60:63], v[180:183], v[140:143]
    s_waitcnt lgkmcnt(0)
    v_mfma_f32_16x16x32_bf16 v[96:99], v[64:67], v[168:171], v[96:99]
    v_mfma_f32_16x16x32_bf16 v[112:115], v[64:67], v[172:175], v[112:115]
    s_waitcnt vmcnt(9)
    s_barrier
    ds_read_b64_tr_b16 v[56:57], v76 offset:16384
    ds_read_b64_tr_b16 v[58:59], v76 offset:17408
    v_mfma_f32_16x16x32_bf16 v[100:103], v[68:71], v[168:171], v[100:103]
    ds_read_b128 v[152:155], v72 offset:16384
    ds_read_b128 v[156:159], v72 offset:18432
    v_mfma_f32_16x16x32_bf16 v[116:119], v[68:71], v[172:175], v[116:119]
    ds_read_b64_tr_b16 v[60:61], v77 offset:16384
    v_mfma_f32_16x16x32_bf16 v[128:131], v[64:67], v[176:179], v[128:131]
    ds_read_b64_tr_b16 v[62:63], v77 offset:17408
    ds_read_b128 v[160:163], v73 offset:16384
    v_mfma_f32_16x16x32_bf16 v[144:147], v[64:67], v[180:183], v[144:147]
    ds_read_b128 v[164:167], v73 offset:18432
    s_bfe_u32 s56, s100, 0x4000c
    s_xor_b32 s56, s56, s59
    s_add_u32 m0, s14, 114688
    s_lshl_b32 s58, s56, 19
    buffer_load_dwordx4 v6, s[20:23], s58 offen offset:0  lds
    v_mfma_f32_16x16x32_bf16 v[132:135], v[68:71], v[176:179], v[132:135]
    buffer_load_dwordx4 v7, s[20:23], s58 offen offset:1024  lds
    v_mfma_f32_16x16x32_bf16 v[148:151], v[68:71], v[180:183], v[148:151]
    s_waitcnt lgkmcnt(4)
    v_mfma_f32_16x16x32_bf16 v[88:91], v[56:59], v[152:155], v[88:91]
    ds_read_b64_tr_b16 v[64:65], v78 offset:16384
    v_mfma_f32_16x16x32_bf16 v[104:107], v[56:59], v[156:159], v[104:107]
    ds_read_b64_tr_b16 v[66:67], v78 offset:17408
    s_waitcnt lgkmcnt(4)
    v_mfma_f32_16x16x32_bf16 v[92:95], v[60:63], v[152:155], v[92:95]
    ds_read_b64_tr_b16 v[68:69], v79 offset:16384
    v_mfma_f32_16x16x32_bf16 v[108:111], v[60:63], v[156:159], v[108:111]
    ds_read_b64_tr_b16 v[70:71], v79 offset:17408
    s_waitcnt lgkmcnt(4)
    v_mfma_f32_16x16x32_bf16 v[120:123], v[56:59], v[160:163], v[120:123]
    buffer_load_dwordx4 v8, s[20:23], s58 offen offset:2048  lds
    v_mfma_f32_16x16x32_bf16 v[136:139], v[56:59], v[164:167], v[136:139]
    v_mfma_f32_16x16x32_bf16 v[124:127], v[60:63], v[160:163], v[124:127]
    buffer_load_dwordx4 v9, s[20:23], s58 offen offset:3072  lds
    v_mfma_f32_16x16x32_bf16 v[140:143], v[60:63], v[164:167], v[140:143]
    s_waitcnt lgkmcnt(0)
    v_mfma_f32_16x16x32_bf16 v[96:99], v[64:67], v[152:155], v[96:99]
    ds_read_b64_tr_b16 v[56:57], v76 offset:24576
    ds_read_b64_tr_b16 v[58:59], v76 offset:25600
    v_mfma_f32_16x16x32_bf16 v[112:115], v[64:67], v[156:159], v[112:115]
    ds_read_b128 v[168:171], v74 offset:16384
    ds_read_b128 v[172:175], v74 offset:18432
    v_mfma_f32_16x16x32_bf16 v[100:103], v[68:71], v[152:155], v[100:103]
    ds_read_b64_tr_b16 v[60:61], v77 offset:24576
    v_mfma_f32_16x16x32_bf16 v[116:119], v[68:71], v[156:159], v[116:119]
    ds_read_b64_tr_b16 v[62:63], v77 offset:25600
    ds_read_b128 v[176:179], v75 offset:16384
    v_mfma_f32_16x16x32_bf16 v[128:131], v[64:67], v[160:163], v[128:131]
    ds_read_b128 v[180:183], v75 offset:18432
    v_mfma_f32_16x16x32_bf16 v[144:147], v[64:67], v[164:167], v[144:147]
    s_add_u32 m0, s14, 65536
    s_lshl_b32 s57, s56, 7
    buffer_load_dwordx4 v2, s[16:19], s57 offen offset:0  lds
    v_mfma_f32_16x16x32_bf16 v[132:135], v[68:71], v[160:163], v[132:135]
    buffer_load_dwordx4 v3, s[16:19], s57 offen offset:1024  lds
    v_mfma_f32_16x16x32_bf16 v[148:151], v[68:71], v[164:167], v[148:151]
    s_waitcnt lgkmcnt(4)
    v_mfma_f32_16x16x32_bf16 v[88:91], v[56:59], v[168:171], v[88:91]
    ds_read_b64_tr_b16 v[64:65], v78 offset:24576
    v_mfma_f32_16x16x32_bf16 v[104:107], v[56:59], v[172:175], v[104:107]
    ds_read_b64_tr_b16 v[66:67], v78 offset:25600
    s_waitcnt lgkmcnt(4)
    v_mfma_f32_16x16x32_bf16 v[92:95], v[60:63], v[168:171], v[92:95]
    ds_read_b64_tr_b16 v[68:69], v79 offset:24576
    v_mfma_f32_16x16x32_bf16 v[108:111], v[60:63], v[172:175], v[108:111]
    ds_read_b64_tr_b16 v[70:71], v79 offset:25600
    s_waitcnt lgkmcnt(4)
    v_mfma_f32_16x16x32_bf16 v[120:123], v[56:59], v[176:179], v[120:123]
    buffer_load_dwordx4 v4, s[16:19], s57 offen offset:2048  lds
    v_mfma_f32_16x16x32_bf16 v[136:139], v[56:59], v[180:183], v[136:139]
    v_mfma_f32_16x16x32_bf16 v[124:127], v[60:63], v[176:179], v[124:127]
    buffer_load_dwordx4 v5, s[16:19], s57 offen offset:3072  lds
    v_mfma_f32_16x16x32_bf16 v[140:143], v[60:63], v[180:183], v[140:143]
    s_cmp_lg_u32 s54, 0
    s_cbranch_scc1 L_nohook_1
    s_call_b64 s[32:33], L_burst
L_nohook_1:
    s_waitcnt lgkmcnt(0)
    v_mfma_f32_16x16x32_bf16 v[96:99], v[64:67], v[168:171], v[96:99]
    v_mfma_f32_16x16x32_bf16 v[112:115], v[64:67], v[172:175], v[112:115]
    s_waitcnt vmcnt(8)
    s_barrier
    ds_read_b64_tr_b16 v[56:57], v76 offset:32768
    ds_read_b64_tr_b16 v[58:59], v76 offset:33792
    v_mfma_f32_16x16x32_bf16 v[100:103], v[68:71], v[168:171], v[100:103]
    ds_read_b128 v[152:155], v72 offset:32768
    ds_read_b128 v[156:159], v72 offset:34816
    v_mfma_f32_16x16x32_bf16 v[116:119], v[68:71], v[172:175], v[116:119]
    ds_read_b64_tr_b16 v[60:61], v77 offset:32768
    v_mfma_f32_16x16x32_bf16 v[128:131], v[64:67], v[176:179], v[128:131]
    ds_read_b64_tr_b16 v[62:63], v77 offset:33792
    ds_read_b128 v[160:163], v73 offset:32768
    v_mfma_f32_16x16x32_bf16 v[144:147], v[64:67], v[180:183], v[144:147]
    ds_read_b128 v[164:167], v73 offset:34816
    s_bfe_u32 s56, s100, 0x40010
    s_xor_b32 s56, s56, s59
    s_add_u32 m0, s14, 131072
    s_lshl_b32 s58, s56, 19
    buffer_load_dwordx4 v6, s[20:23], s58 offen offset:0  lds
    v_mfma_f32_16x16x32_bf16 v[132:135], v[68:71], v[176:179], v[132:135]
    buffer_load_dwordx4 v7, s[20:23], s58 offen offset:1024  lds
    v_mfma_f32_16x16x32_bf16 v[148:151], v[68:71], v[180:183], v[148:151]
    s_waitcnt lgkmcnt(4)
    v_mfma_f32_16x16x32_bf16 v[88:91], v[56:59], v[152:155], v[88:91]
    ds_read_b64_tr_b16 v[64:65], v78 offset:32768
    v_mfma_f32_16x16x32_bf16 v[104:107], v[56:59], v[156:159], v[104:107]
    ds_read_b64_tr_b16 v[66:67], v78 offset:33792
    s_waitcnt lgkmcnt(4)
    v_mfma_f32_16x16x32_bf16 v[92:95], v[60:63], v[152:155], v[92:95]
    ds_read_b64_tr_b16 v[68:69], v79 offset:32768
    v_mfma_f32_16x16x32_bf16 v[108:111], v[60:63], v[156:159], v[108:111]
    ds_read_b64_tr_b16 v[70:71], v79 offset:33792
    s_waitcnt lgkmcnt(4)
    v_mfma_f32_16x16x32_bf16 v[120:123], v[56:59], v[160:163], v[120:123]
    buffer_load_dwordx4 v8, s[20:23], s58 offen offset:2048  lds
    v_mfma_f32_16x16x32_bf16 v[136:139], v[56:59], v[164:167], v[136:139]
    v_mfma_f32_16x16x32_bf16 v[124:127], v[60:63], v[160:163], v[124:127]
    buffer_load_dwordx4 v9, s[20:23], s58 offen offset:3072  lds
    v_mfma_f32_16x16x32_bf16 v[140:143], v[60:63], v[164:167], v[140:143]
    s_waitcnt lgkmcnt(0)
    v_mfma_f32_16x16x32_bf16 v[96:99], v[64:67], v[152:155], v[96:99]
    ds_read_b64_tr_b16 v[56:57], v76 offset:40960
    ds_read_b64_tr_b16 v[58:59], v76 offset:41984
    v_mfma_f32_16x16x32_bf16 v[112:115], v[64:67], v[156:159], v[112:115]
    ds_read_b128 v[168:171], v74 offset:32768
    ds_read_b128 v[172:175], v74 offset:34816
    v_mfma_f32_16x16x32_bf16 v[100:103], v[68:71], v[152:155], v[100:103]
    ds_read_b64_tr_b16 v[60:61], v77 offset:40960
    v_mfma_f32_16x16x32_bf16 v[116:119], v[68:71], v[156:159], v[116:119]
    ds_read_b64_tr_b16 v[62:63], v77 offset:41984
    ds_read_b128 v[176:179], v75 offset:32768
    v_mfma_f32_16x16x32_bf16 v[128:131], v[64:67], v[160:163], v[128:131]
    ds_read_b128 v[180:183], v75 offset:34816
    v_mfma_f32_16x16x32_bf16 v[144:147], v[64:67], v[164:167], v[144:147]
    s_add_u32 m0, s14, 81920
    s_lshl_b32 s57, s56, 7
    buffer_load_dwordx4 v2, s[16:19], s57 offen offset:0  lds
    v_mfma_f32_16x16x32_bf16 v[132:135], v[68:71], v[160:163], v[132:135]
    buffer_load_dwordx4 v3, s[16:19], s57 offen offset:1024  lds
    v_mfma_f32_16x16x32_bf16 v[148:151], v[68:71], v[164:167], v[148:151]
    s_waitcnt lgkmcnt(4)
    v_mfma_f32_16x16x32_bf16 v[88:91], v[56:59], v[168:171], v[88:91]
    ds_read_b64_tr_b16 v[64:65], v78 offset:40960
    v_mfma_f32_16x16x32_bf16 v[104:107], v[56:59], v[172:175], v[104:107]
    ds_read_b64_tr_b16 v[66:67], v78 offset:41984
    s_waitcnt lgkmcnt(4)
    v_mfma_f32_16x16x32_bf16 v[92:95], v[60:63], v[168:171], v[92:95]
    ds_read_b64_tr_b16 v[68:69], v79 offset:40960
    v_mfma_f32_16x16x32_bf16 v[108:111], v[60:63], v[172:175], v[108:111]
    ds_read_b64_tr_b16 v[70:71], v79 offset:41984
    s_waitcnt lgkmcnt(4)
    v_mfma_f32_16x16x32_bf16 v[120:123], v[56:59], v[176:179], v[120:123]
    buffer_load_dwordx4 v4, s[16:19], s57 offen offset:2048  lds
    v_mfma_f32_16x16x32_bf16 v[136:139], v[56:59], v[180:183], v[136:139]
    v_mfma_f32_16x16x32_bf16 v[124:127], v[60:63], v[176:179], v[124:127]
    buffer_load_dwordx4 v5, s[16:19], s57 offen offset:3072  lds
    v_mfma_f32_16x16x32_bf16 v[140:143], v[60:63], v[180:183], v[140:143]
    s_waitcnt lgkmcnt(0)
    v_mfma_f32_16x16x32_bf16 v[96:99], v[64:67], v[168:171], v[96:99]
    v_mfma_f32_16x16x32_bf16 v[112:115], v[64:67], v[172:175], v[112:115]
    s_waitcnt vmcnt(8)
    s_barrier
    ds_read_b64_tr_b16 v[56:57], v76 offset:0
    ds_read_b64_tr_b16 v[58:59], v76 offset:1024
    v_mfma_f32_16x16x32_bf16 v[100:103], v[68:71], v[168:171], v[100:103]
    ds_read_b128 v[152:155], v72 offset:0
    ds_read_b128 v[156:159], v72 offset:2048
    v_mfma_f32_16x16x32_bf16 v[116:119], v[68:71], v[172:175], v[116:119]
    ds_read_b64_tr_b16 v[60:61], v77 offset:0
    v_mfma_f32_16x16x32_bf16 v[128:131], v[64:67], v[176:179], v[128:131]
    ds_read_b64_tr_b16 v[62:63], v77 offset:1024
    ds_read_b128 v[160:163], v73 offset:0
    v_mfma_f32_16x16x32_bf16 v[144:147], v[64:67], v[180:183], v[144:147]
    ds_read_b128 v[164:167], v73 offset:2048
    s_bfe_u32 s56, s100, 0x40014
    s_xor_b32 s56, s56, s59
    s_add_u32 m0, s14, 147456
    s_lshl_b32 s58, s56, 19
    buffer_load_dwordx4 v6, s[20:23], s58 offen offset:0  lds
    v_mfma_f32_16x16x32_bf16 v[132:135], v[68:71], v[176:179], v[132:135]
    buffer_load_dwordx4 v7, s[20:23], s58 offen offset:1024  lds
    v_mfma_f32_16x16x32_bf16 v[148:151], v[68:71], v[180:183], v[148:151]
    s_waitcnt lgkmcnt(4)
    v_mfma_f32_16x16x32_bf16 v[88:91], v[56:59], v[152:155], v[88:91]
    ds_read_b64_tr_b16 v[64:65], v78 offset:0
    v_mfma_f32_16x16x32_bf16 v[104:107], v[56:59], v[156:159], v[104:107]
    ds_read_b64_tr_b16 v[66:67], v78 offset:1024
    s_waitcnt lgkmcnt(4)
    v_mfma_f32_16x16x32_bf16 v[92:95], v[60:63], v[152:155], v[92:95]
    ds_read_b64_tr_b16 v[68:69], v79 offset:0
    v_mfma_f32_16x16x32_bf16 v[108:111], v[60:63], v[156:159], v[108:111]
    ds_read_b64_tr_b16 v[70:71], v79 offset:1024
    s_waitcnt lgkmcnt(4)
    v_mfma_f32_16x16x32_bf16 v[120:123], v[56:59], v[160:163], v[120:123]
    buffer_load_dwordx4 v8, s[20:23], s58 offen offset:2048  lds
    v_mfma_f32_16x16x32_bf16 v[136:139], v[56:59], v[164:167], v[136:139]
    v_mfma_f32_16x16x32_bf16 v[124:127], v[60:63], v[160:163], v[124:127]
    buffer_load_dwordx4 v9, s[20:23], s58 offen offset:3072  lds
    v_mfma_f32_16x16x32_bf16 v[140:143], v[60:63], v[164:167], v[140:143]
    s_waitcnt lgkmcnt(0)
    v_mfma_f32_16x16x32_bf16 v[96:99], v[64:67], v[152:155], v[96:99]
    ds_read_b64_tr_b16 v[56:57], v76 offset:8192
    ds_read_b64_tr_b16 v[58:59], v76 offset:9216
    v_mfma_f32_16x16x32_bf16 v[112:115], v[64:67], v[156:159], v[112:115]
    ds_read_b128 v[168:171], v74 offset:0
    ds_read_b128 v[172:175], v74 offset:2048
    v_mfma_f32_16x16x32_bf16 v[100:103], v[68:71], v[152:155], v[100:103]
    ds_read_b64_tr_b16 v[60:61], v77 offset:8192
    v_mfma_f32_16x16x32_bf16 v[116:119], v[68:71], v[156:159], v[116:119]
    ds_read_b64_tr_b16 v[62:63], v77 offset:9216
    ds_read_b128 v[176:179], v75 offset:0
    v_mfma_f32_16x16x32_bf16 v[128:131], v[64:67], v[160:163], v[128:131]
    ds_read_b128 v[180:183], v75 offset:2048
    v_mfma_f32_16x16x32_bf16 v[144:147], v[64:67], v[164:167], v[144:147]
    s_add_u32 m0, s14, 98304
    s_lshl_b32 s57, s56, 7
    buffer_load_dwordx4 v2, s[16:19], s57 offen offset:0  lds
    v_mfma_f32_16x16x32_bf16 v[132:135], v[68:71], v[160:163], v[132:135]
    buffer_load_dwordx4 v3, s[16:19], s57 offen offset:1024  lds
    v_mfma_f32_16x16x32_bf16 v[148:151], v[68:71], v[164:167], v[148:151]
    s_waitcnt lgkmcnt(4)
    v_mfma_f32_16x16x32_bf16 v[88:91], v[56:59], v[168:171], v[88:91]
    ds_read_b64_tr_b16 v[64:65], v78 offset:8192
    v_mfma_f32_16x16x32_bf16 v[104:107], v[56:59], v[172:175], v[104:107]
    ds_read_b64_tr_b16 v[66:67], v78 offset:9216
    s_waitcnt lgkmcnt(4)
    v_mfma_f32_16x16x32_bf16 v[92:95], v[60:63], v[168:171], v[92:95]
    ds_read_b64_tr_b16 v[68:69], v79 offset:8192
    v_mfma_f32_16x16x32_bf16 v[108:111], v[60:63], v[172:175], v[108:111]
    ds_read_b64_tr_b16 v[70:71], v79 offset:9216
    s_waitcnt lgkmcnt(4)
    v_mfma_f32_16x16x32_bf16 v[120:123], v[56:59], v[176:179], v[120:123]
    buffer_load_dwordx4 v4, s[16:19], s57 offen offset:2048  lds
    v_mfma_f32_16x16x32_bf16 v[136:139], v[56:59], v[180:183], v[136:139]
    v_mfma_f32_16x16x32_bf16 v[124:127], v[60:63], v[176:179], v[124:127]
    buffer_load_dwordx4 v5, s[16:19], s57 offen offset:3072  lds
    v_mfma_f32_16x16x32_bf16 v[140:143], v[60:63], v[180:183], v[140:143]
    s_waitcnt lgkmcnt(0)
    v_mfma_f32_16x16x32_bf16 v[96:99], v[64:67], v[168:171], v[96:99]
    v_mfma_f32_16x16x32_bf16 v[112:115], v[64:67], v[172:175], v[112:115]
    s_waitcnt vmcnt(8)
    s_barrier
    ds_read_b64_tr_b16 v[56:57], v76 offset:16384
    ds_read_b64_tr_b16 v[58:59], v76 offset:17408
    v_mfma_f32_16x16x32_bf16 v[100:103], v[68:71], v[168:171], v[100:103]
    ds_read_b128 v[152:155], v72 offset:16384
    ds_read_b128 v[156:159], v72 offset:18432
    v_mfma_f32_16x16x32_bf16 v[116:119], v[68:71], v[172:175], v[116:119]
    ds_read_b64_tr_b16 v[60:61], v77 offset:16384
    v_mfma_f32_16x16x32_bf16 v[128:131], v[64:67], v[176:179], v[128:131]
    ds_read_b64_tr_b16 v[62:63], v77 offset:17408
    ds_read_b128 v[160:163], v73 offset:16384
    v_mfma_f32_16x16x32_bf16 v[144:147], v[64:67], v[180:183], v[144:147]
    ds_read_b128 v[164:167], v73 offset:18432
    s_bfe_u32 s56, s100, 0x40018
    s_xor_b32 s56, s56, s59
    s_add_u32 m0, s14, 114688
    s_lshl_b32 s58, s56, 19
    buffer_load_dwordx4 v6, s[20:23], s58 offen offset:0  lds
    v_mfma_f32_16x16x32_bf16 v[132:135], v[68:71], v[176:179], v[132:135]
    buffer_load_dwordx4 v7, s[20:23], s58 offen offset:1024  lds
    v_mfma_f32_16x16x32_bf16 v[148:151], v[68:71], v[180:183], v[148:151]
    s_waitcnt lgkmcnt(4)
    v_mfma_f32_16x16x32_bf16 v[88:91], v[56:59], v[152:155], v[88:91]
    ds_read_b64_tr_b16 v[64:65], v78 offset:16384
    v_mfma_f32_16x16x32_bf16 v[104:107], v[56:59], v[156:159], v[104:107]
    ds_read_b64_tr_b16 v[66:67], v78 offset:17408
    s_waitcnt lgkmcnt(4)
    v_mfma_f32_16x16x32_bf16 v[92:95], v[60:63], v[152:155], v[92:95]
    ds_read_b64_tr_b16 v[68:69], v79 offset:16384
    v_mfma_f32_16x16x32_bf16 v[108:111], v[60:63], v[156:159], v[108:111]
    ds_read_b64_tr_b16 v[70:71], v79 offset:17408
    s_waitcnt lgkmcnt(4)
    v_mfma_f32_16x16x32_bf16 v[120:123], v[56:59], v[160:163], v[120:123]
    buffer_load_dwordx4 v8, s[20:23], s58 offen offset:2048  lds
    v_mfma_f32_16x16x32_bf16 v[136:139], v[56:59], v[164:167], v[136:139]
    v_mfma_f32_16x16x32_bf16 v[124:127], v[60:63], v[160:163], v[124:127]
    buffer_load_dwordx4 v9, s[20:23], s58 offen offset:3072  lds
    v_mfma_f32_16x16x32_bf16 v[140:143], v[60:63], v[164:167], v[140:143]
    s_waitcnt lgkmcnt(0)
    v_mfma_f32_16x16x32_bf16 v[96:99], v[64:67], v[152:155], v[96:99]
    ds_read_b64_tr_b16 v[56:57], v76 offset:24576
    ds_read_b64_tr_b16 v[58:59], v76 offset:25600
    v_mfma_f32_16x16x32_bf16 v[112:115], v[64:67], v[156:159], v[112:115]
    ds_read_b128 v[168:171], v74 offset:16384
    ds_read_b128 v[172:175], v74 offset:18432
    v_mfma_f32_16x16x32_bf16 v[100:103], v[68:71], v[152:155], v[100:103]
    ds_read_b64_tr_b16 v[60:61], v77 offset:24576
    v_mfma_f32_16x16x32_bf16 v[116:119], v[68:71], v[156:159], v[116:119]
    ds_read_b64_tr_b16 v[62:63], v77 offset:25600
    ds_read_b128 v[176:179], v75 offset:16384
    v_mfma_f32_16x16x32_bf16 v[128:131], v[64:67], v[160:163], v[128:131]
    ds_read_b128 v[180:183], v75 offset:18432
    v_mfma_f32_16x16x32_bf16 v[144:147], v[64:67], v[164:167], v[144:147]
    s_add_u32 m0, s14, 65536
    s_lshl_b32 s57, s56, 7
    buffer_load_dwordx4 v2, s[16:19], s57 offen offset:0  lds
    v_mfma_f32_16x16x32_bf16 v[132:135], v[68:71], v[160:163], v[132:135]
    buffer_load_dwordx4 v3, s[16:19], s57 offen offset:1024  lds
    v_mfma_f32_16x16x32_bf16 v[148:151], v[68:71], v[164:167], v[148:151]
    s_waitcnt lgkmcnt(4)
    v_mfma_f32_16x16x32_bf16 v[88:91], v[56:59], v[168:171], v[88:91]
    ds_read_b64_tr_b16 v[64:65], v78 offset:24576
    v_mfma_f32_16x16x32_bf16 v[104:107], v[56:59], v[172:175], v[104:107]
    ds_read_b64_tr_b16 v[66:67], v78 offset:25600
    s_waitcnt lgkmcnt(4)
    v_mfma_f32_16x16x32_bf16 v[92:95], v[60:63], v[168:171], v[92:95]
    ds_read_b64_tr_b16 v[68:69], v79 offset:24576
    v_mfma_f32_16x16x32_bf16 v[108:111], v[60:63], v[172:175], v[108:111]
    ds_read_b64_tr_b16 v[70:71], v79 offset:25600
    s_waitcnt lgkmcnt(4)
    v_mfma_f32_16x16x32_bf16 v[120:123], v[56:59], v[176:179], v[120:123]
    buffer_load_dwordx4 v4, s[16:19], s57 offen offset:2048  lds
    v_mfma_f32_16x16x32_bf16 v[136:139], v[56:59], v[180:183], v[136:139]
    v_mfma_f32_16x16x32_bf16 v[124:127], v[60:63], v[176:179], v[124:127]
    buffer_load_dwordx4 v5, s[16:19], s57 offen offset:3072  lds
    v_mfma_f32_16x16x32_bf16 v[140:143], v[60:63], v[180:183], v[140:143]
    s_waitcnt lgkmcnt(0)
    v_mfma_f32_16x16x32_bf16 v[96:99], v[64:67], v[168:171], v[96:99]
    v_mfma_f32_16x16x32_bf16 v[112:115], v[64:67], v[172:175], v[112:115]
    s_waitcnt vmcnt(8)
    s_barrier
    ds_read_b64_tr_b16 v[56:57], v76 offset:32768
    ds_read_b64_tr_b16 v[58:59], v76 offset:33792
    v_mfma_f32_16x16x32_bf16 v[100:103], v[68:71], v[168:171], v[100:103]
    ds_read_b128 v[152:155], v72 offset:32768
    ds_read_b128 v[156:159], v72 offset:34816
    v_mfma_f32_16x16x32_bf16 v[116:119], v[68:71], v[172:175], v[116:119]
    ds_read_b64_tr_b16 v[60:61], v77 offset:32768
    v_mfma_f32_16x16x32_bf16 v[128:131], v[64:67], v[176:179], v[128:131]
    ds_read_b64_tr_b16 v[62:63], v77 offset:33792
    ds_read_b128 v[160:163], v73 offset:32768
    v_mfma_f32_16x16x32_bf16 v[144:147], v[64:67], v[180:183], v[144:147]
    ds_read_b128 v[164:167], v73 offset:34816
    s_bfe_u32 s56, s100, 0x4001c
    s_xor_b32 s56, s56, s59
    s_add_u32 m0, s14, 131072
    s_lshl_b32 s58, s56, 19
    buffer_load_dwordx4 v6, s[20:23], s58 offen offset:0  lds
    v_mfma_f32_16x16x32_bf16 v[132:135], v[68:71], v[176:179], v[132:135]
    buffer_load_dwordx4 v7, s[20:23], s58 offen offset:1024  lds
    v_mfma_f32_16x16x32_bf16 v[148:151], v[68:71], v[180:183], v[148:151]
    buffer_load_dwordx4 v8, s[20:23], s58 offen offset:2048  lds
    s_waitcnt lgkmcnt(4)
    v_mfma_f32_16x16x32_bf16 v[88:91], v[56:59], v[152:155], v[88:91]
    ds_read_b64_tr_b16 v[64:65], v78 offset:32768
    v_mfma_f32_16x16x32_bf16 v[104:107], v[56:59], v[156:159], v[104:107]
    ds_read_b64_tr_b16 v[66:67], v78 offset:33792
    s_waitcnt lgkmcnt(4)
    v_mfma_f32_16x16x32_bf16 v[92:95], v[60:63], v[152:155], v[92:95]
    ds_read_b64_tr_b16 v[68:69], v79 offset:32768
    v_mfma_f32_16x16x32_bf16 v[108:111], v[60:63], v[156:159], v[108:111]
    ds_read_b64_tr_b16 v[70:71], v79 offset:33792
    s_waitcnt lgkmcnt(4)
    v_mfma_f32_16x16x32_bf16 v[120:123], v[56:59], v[160:163], v[120:123]
    buffer_load_dwordx4 v9, s[20:23], s58 offen offset:3072  lds
    v_mfma_f32_16x16x32_bf16 v[136:139], v[56:59], v[164:167], v[136:139]
    v_mfma_f32_16x16x32_bf16 v[124:127], v[60:63], v[160:163], v[124:127]
    s_add_u32 m0, s14, 81920
    s_lshl_b32 s57, s56, 7
    buffer_load_dwordx4 v2, s[16:19], s57 offen offset:0  lds
    v_mfma_f32_16x16x32_bf16 v[140:143], v[60:63], v[164:167], v[140:143]
    s_waitcnt lgkmcnt(0)
    v_mfma_f32_16x16x32_bf16 v[96:99], v[64:67], v[152:155], v[96:99]
    ds_read_b64_tr_b16 v[56:57], v76 offset:40960
    ds_read_b64_tr_b16 v[58:59], v76 offset:41984
    v_mfma_f32_16x16x32_bf16 v[112:115], v[64:67], v[156:159], v[112:115]
    ds_read_b128 v[168:171], v74 offset:32768
    ds_read_b128 v[172:175], v74 offset:34816
    v_mfma_f32_16x16x32_bf16 v[100:103], v[68:71], v[152:155], v[100:103]
    ds_read_b64_tr_b16 v[60:61], v77 offset:40960
    v_mfma_f32_16x16x32_bf16 v[116:119], v[68:71], v[156:159], v[116:119]
    ds_read_b64_tr_b16 v[62:63], v77 offset:41984
    ds_read_b128 v[176:179], v75 offset:32768
    v_mfma_f32_16x16x32_bf16 v[128:131], v[64:67], v[160:163], v[128:131]
    ds_read_b128 v[180:183], v75 offset:34816
    v_mfma_f32_16x16x32_bf16 v[144:147], v[64:67], v[164:167], v[144:147]
    buffer_load_dwordx4 v3, s[16:19], s57 offen offset:1024  lds
    v_mfma_f32_16x16x32_bf16 v[132:135], v[68:71], v[160:163], v[132:135]
    buffer_load_dwordx4 v4, s[16:19], s57 offen offset:2048  lds
    v_mfma_f32_16x16x32_bf16 v[148:151], v[68:71], v[164:167], v[148:151]
    s_waitcnt lgkmcnt(4)
    v_mfma_f32_16x16x32_bf16 v[88:91], v[56:59], v[168:171], v[88:91]
    ds_read_b64_tr_b16 v[64:65], v78 offset:40960
    v_mfma_f32_16x16x32_bf16 v[104:107], v[56:59], v[172:175], v[104:107]
    ds_read_b64_tr_b16 v[66:67], v78 offset:41984
    s_waitcnt lgkmcnt(4)
    v_mfma_f32_16x16x32_bf16 v[92:95], v[60:63], v[168:171], v[92:95]
    ds_read_b64_tr_b16 v[68:69], v79 offset:40960
    v_mfma_f32_16x16x32_bf16 v[108:111], v[60:63], v[172:175], v[108:111]
    ds_read_b64_tr_b16 v[70:71], v79 offset:41984
    s_waitcnt lgkmcnt(4)
    v_mfma_f32_16x16x32_bf16 v[120:123], v[56:59], v[176:179], v[120:123]
    buffer_load_dwordx4 v5, s[16:19], s57 offen offset:3072  lds
    v_mfma_f32_16x16x32_bf16 v[136:139], v[56:59], v[180:183], v[136:139]
    v_mfma_f32_16x16x32_bf16 v[124:127], v[60:63], v[176:179], v[124:127]
    global_load_dwordx4 v[248:251], v41, s[34:35]
    v_mfma_f32_16x16x32_bf16 v[140:143], v[60:63], v[180:183], v[140:143]
    s_waitcnt lgkmcnt(0)
    v_mfma_f32_16x16x32_bf16 v[96:99], v[64:67], v[168:171], v[96:99]
    v_mfma_f32_16x16x32_bf16 v[112:115], v[64:67], v[172:175], v[112:115]
    s_waitcnt vmcnt(9)
    s_barrier
    ds_read_b64_tr_b16 v[56:57], v76 offset:0
    ds_read_b64_tr_b16 v[58:59], v76 offset:1024
    v_mfma_f32_16x16x32_bf16 v[100:103], v[68:71], v[168:171], v[100:103]
    ds_read_b128 v[152:155], v72 offset:0
    ds_read_b128 v[156:159], v72 offset:2048
    v_mfma_f32_16x16x32_bf16 v[116:119], v[68:71], v[172:175], v[116:119]
    ds_read_b64_tr_b16 v[60:61], v77 offset:0
    v_mfma_f32_16x16x32_bf16 v[128:131], v[64:67], v[176:179], v[128:131]
    ds_read_b64_tr_b16 v[62:63], v77 offset:1024
    ds_read_b128 v[160:163], v73 offset:0
    v_mfma_f32_16x16x32_bf16 v[144:147], v[64:67], v[180:183], v[144:147]
    ds_read_b128 v[164:167], v73 offset:2048
    s_bfe_u32 s56, s101, 0x40000
    s_xor_b32 s56, s56, s59
    s_add_u32 m0, s14, 147456
    s_lshl_b32 s58, s56, 19
    buffer_load_dwordx4 v6, s[20:23], s58 offen offset:0  lds
    v_mfma_f32_16x16x32_bf16 v[132:135], v[68:71], v[176:179], v[132:135]
    buffer_load_dwordx4 v7, s[20:23], s58 offen offset:1024  lds
    v_mfma_f32_16x16x32_bf16 v[148:151], v[68:71], v[180:183], v[148:151]
    s_waitcnt lgkmcnt(4)
    v_mfma_f32_16x16x32_bf16 v[88:91], v[56:59], v[152:155], v[88:91]
    ds_read_b64_tr_b16 v[64:65], v78 offset:0
    v_mfma_f32_16x16x32_bf16 v[104:107], v[56:59], v[156:159], v[104:107]
    ds_read_b64_tr_b16 v[66:67], v78 offset:1024
    s_waitcnt lgkmcnt(4)
    v_mfma_f32_16x16x32_bf16 v[92:95], v[60:63], v[152:155], v[92:95]
    ds_read_b64_tr_b16 v[68:69], v79 offset:0
    v_mfma_f32_16x16x32_bf16 v[108:111], v[60:63], v[156:159], v[108:111]
    ds_read_b64_tr_b16 v[70:71], v79 offset:1024
    s_waitcnt lgkmcnt(4)
    v_mfma_f32_16x16x32_bf16 v[120:123], v[56:59], v[160:163], v[120:123]
    buffer_load_dwordx4 v8, s[20:23], s58 offen offset:2048  lds
    v_mfma_f32_16x16x32_bf16 v[136:139], v[56:59], v[164:167], v[136:139]
    v_mfma_f32_16x16x32_bf16 v[124:127], v[60:63], v[160:163], v[124:127]
    buffer_load_dwordx4 v9, s[20:23], s58 offen offset:3072  lds
    v_mfma_f32_16x16x32_bf16 v[140:143], v[60:63], v[164:167], v[140:143]
    s_waitcnt lgkmcnt(0)
    v_mfma_f32_16x16x32_bf16 v[96:99], v[64:67], v[152:155], v[96:99]
    ds_read_b64_tr_b16 v[56:57], v76 offset:8192
    ds_read_b64_tr_b16 v[58:59], v76 offset:9216
    v_mfma_f32_16x16x32_bf16 v[112:115], v[64:67], v[156:159], v[112:115]
    ds_read_b128 v[168:171], v74 offset:0
    ds_read_b128 v[172:175], v74 offset:2048
    v_mfma_f32_16x16x32_bf16 v[100:103], v[68:71], v[152:155], v[100:103]
    ds_read_b64_tr_b16 v[60:61], v77 offset:8192
    v_mfma_f32_16x16x32_bf16 v[116:119], v[68:71], v[156:159], v[116:119]
    ds_read_b64_tr_b16 v[62:63], v77 offset:9216
    ds_read_b128 v[176:179], v75 offset:0
    v_mfma_f32_16x16x32_bf16 v[128:131], v[64:67], v[160:163], v[128:131]
    ds_read_b128 v[180:183], v75 offset:2048
    v_mfma_f32_16x16x32_bf16 v[144:147], v[64:67], v[164:167], v[144:147]
    s_add_u32 m0, s14, 98304
    s_lshl_b32 s57, s56, 7
    buffer_load_dwordx4 v2, s[16:19], s57 offen offset:0  lds
    v_mfma_f32_16x16x32_bf16 v[132:135], v[68:71], v[160:163], v[132:135]
    buffer_load_dwordx4 v3, s[16:19], s57 offen offset:1024  lds
    v_mfma_f32_16x16x32_bf16 v[148:151], v[68:71], v[164:167], v[148:151]
    s_waitcnt lgkmcnt(4)
    v_mfma_f32_16x16x32_bf16 v[88:91], v[56:59], v[168:171], v[88:91]
    ds_read_b64_tr_b16 v[64:65], v78 offset:8192
    v_mfma_f32_16x16x32_bf16 v[104:107], v[56:59], v[172:175], v[104:107]
    ds_read_b64_tr_b16 v[66:67], v78 offset:9216
    s_waitcnt lgkmcnt(4)
    v_mfma_f32_16x16x32_bf16 v[92:95], v[60:63], v[168:171], v[92:95]
    ds_read_b64_tr_b16 v[68:69], v79 offset:8192
    v_mfma_f32_16x16x32_bf16 v[108:111], v[60:63], v[172:175], v[108:111]
    ds_read_b64_tr_b16 v[70:71], v79 offset:9216
    s_waitcnt lgkmcnt(4)
    v_mfma_f32_16x16x32_bf16 v[120:123], v[56:59], v[176:179], v[120:123]
    buffer_load_dwordx4 v4, s[16:19], s57 offen offset:2048  lds
    v_mfma_f32_16x16x32_bf16 v[136:139], v[56:59], v[180:183], v[136:139]
    v_mfma_f32_16x16x32_bf16 v[124:127], v[60:63], v[176:179], v[124:127]
    buffer_load_dwordx4 v5, s[16:19], s57 offen offset:3072  lds
    v_mfma_f32_16x16x32_bf16 v[140:143], v[60:63], v[180:183], v[140:143]
    s_waitcnt lgkmcnt(0)
    v_mfma_f32_16x16x32_bf16 v[96:99], v[64:67], v[168:171], v[96:99]
    v_mfma_f32_16x16x32_bf16 v[112:115], v[64:67], v[172:175], v[112:115]
    s_waitcnt vmcnt(9)
    s_barrier
    ds_read_b64_tr_b16 v[56:57], v76 offset:16384
    ds_read_b64_tr_b16 v[58:59], v76 offset:17408
    v_mfma_f32_16x16x32_bf16 v[100:103], v[68:71], v[168:171], v[100:103]
    ds_read_b128 v[152:155], v72 offset:16384
    ds_read_b128 v[156:159], v72 offset:18432
    v_mfma_f32_16x16x32_bf16 v[116:119], v[68:71], v[172:175], v[116:119]
    ds_read_b64_tr_b16 v[60:61], v77 offset:16384
    v_mfma_f32_16x16x32_bf16 v[128:131], v[64:67], v[176:179], v[128:131]
    ds_read_b64_tr_b16 v[62:63], v77 offset:17408
    ds_read_b128 v[160:163], v73 offset:16384
    v_mfma_f32_16x16x32_bf16 v[144:147], v[64:67], v[180:183], v[144:147]
    ds_read_b128 v[164:167], v73 offset:18432
    s_bfe_u32 s56, s101, 0x40004
    s_xor_b32 s56, s56, s59
    s_add_u32 m0, s14, 114688
    s_lshl_b32 s58, s56, 19
    buffer_load_dwordx4 v6, s[20:23], s58 offen offset:0  lds
    v_mfma_f32_16x16x32_bf16 v[132:135], v[68:71], v[176:179], v[132:135]
    buffer_load_dwordx4 v7, s[20:23], s58 offen offset:1024  lds
    v_mfma_f32_16x16x32_bf16 v[148:151], v[68:71], v[180:183], v[148:151]
    s_waitcnt lgkmcnt(4)
    v_mfma_f32_16x16x32_bf16 v[88:91], v[56:59], v[152:155], v[88:91]
    ds_read_b64_tr_b16 v[64:65], v78 offset:16384
    v_mfma_f32_16x16x32_bf16 v[104:107], v[56:59], v[156:159], v[104:107]
    ds_read_b64_tr_b16 v[66:67], v78 offset:17408
    s_waitcnt lgkmcnt(4)
    v_mfma_f32_16x16x32_bf16 v[92:95], v[60:63], v[152:155], v[92:95]
    ds_read_b64_tr_b16 v[68:69], v79 offset:16384
    v_mfma_f32_16x16x32_bf16 v[108:111], v[60:63], v[156:159], v[108:111]
    ds_read_b64_tr_b16 v[70:71], v79 offset:17408
    s_waitcnt lgkmcnt(4)
    v_mfma_f32_16x16x32_bf16 v[120:123], v[56:59], v[160:163], v[120:123]
    buffer_load_dwordx4 v8, s[20:23], s58 offen offset:2048  lds
    v_mfma_f32_16x16x32_bf16 v[136:139], v[56:59], v[164:167], v[136:139]
    v_mfma_f32_16x16x32_bf16 v[124:127], v[60:63], v[160:163], v[124:127]
    buffer_load_dwordx4 v9, s[20:23], s58 offen offset:3072  lds
    v_mfma_f32_16x16x32_bf16 v[140:143], v[60:63], v[164:167], v[140:143]
    s_waitcnt lgkmcnt(0)
    v_mfma_f32_16x16x32_bf16 v[96:99], v[64:67], v[152:155], v[96:99]
    ds_read_b64_tr_b16 v[56:57], v76 offset:24576
    ds_read_b64_tr_b16 v[58:59], v76 offset:25600
    v_mfma_f32_16x16x32_bf16 v[112:115], v[64:67], v[156:159], v[112:115]
    ds_read_b128 v[168:171], v74 offset:16384
    ds_read_b128 v[172:175], v74 offset:18432
    v_mfma_f32_16x16x32_bf16 v[100:103], v[68:71], v[152:155], v[100:103]
    ds_read_b64_tr_b16 v[60:61], v77 offset:24576
    v_mfma_f32_16x16x32_bf16 v[116:119], v[68:71], v[156:159], v[116:119]
    ds_read_b64_tr_b16 v[62:63], v77 offset:25600
    ds_read_b128 v[176:179], v75 offset:16384
    v_mfma_f32_16x16x32_bf16 v[128:131], v[64:67], v[160:163], v[128:131]
    ds_read_b128 v[180:183], v75 offset:18432
    v_mfma_f32_16x16x32_bf16 v[144:147], v[64:67], v[164:167], v[144:147]
    s_add_u32 m0, s14, 65536
    s_lshl_b32 s57, s56, 7
    buffer_load_dwordx4 v2, s[16:19], s57 offen offset:0  lds
    v_mfma_f32_16x16x32_bf16 v[132:135], v[68:71], v[160:163], v[132:135]
    buffer_load_dwordx4 v3, s[16:19], s57 offen offset:1024  lds
    v_mfma_f32_16x16x32_bf16 v[148:151], v[68:71], v[164:167], v[148:151]
    s_waitcnt lgkmcnt(4)
    v_mfma_f32_16x16x32_bf16 v[88:91], v[56:59], v[168:171], v[88:91]
    ds_read_b64_tr_b16 v[64:65], v78 offset:24576
    v_mfma_f32_16x16x32_bf16 v[104:107], v[56:59], v[172:175], v[104:107]
    ds_read_b64_tr_b16 v[66:67], v78 offset:25600
    s_waitcnt lgkmcnt(4)
    v_mfma_f32_16x16x32_bf16 v[92:95], v[60:63], v[168:171], v[92:95]
    ds_read_b64_tr_b16 v[68:69], v79 offset:24576
    v_mfma_f32_16x16x32_bf16 v[108:111], v[60:63], v[172:175], v[108:111]
    ds_read_b64_tr_b16 v[70:71], v79 offset:25600
    s_waitcnt lgkmcnt(4)
    v_mfma_f32_16x16x32_bf16 v[120:123], v[56:59], v[176:179], v[120:123]
    buffer_load_dwordx4 v4, s[16:19], s57 offen offset:2048  lds
    v_mfma_f32_16x16x32_bf16 v[136:139], v[56:59], v[180:183], v[136:139]
    v_mfma_f32_16x16x32_bf16 v[124:127], v[60:63], v[176:179], v[124:127]
    buffer_load_dwordx4 v5, s[16:19], s57 offen offset:3072  lds
    v_mfma_f32_16x16x32_bf16 v[140:143], v[60:63], v[180:183], v[140:143]
    s_waitcnt lgkmcnt(0)
    v_mfma_f32_16x16x32_bf16 v[96:99], v[64:67], v[168:171], v[96:99]
    v_mfma_f32_16x16x32_bf16 v[112:115], v[64:67], v[172:175], v[112:115]
    s_waitcnt vmcnt(8)
    s_barrier
    ds_read_b64_tr_b16 v[56:57], v76 offset:32768
    ds_read_b64_tr_b16 v[58:59], v76 offset:33792
    v_mfma_f32_16x16x32_bf16 v[100:103], v[68:71], v[168:171], v[100:103]
    ds_read_b128 v[152:155], v72 offset:32768
    ds_read_b128 v[156:159], v72 offset:34816
    v_mfma_f32_16x16x32_bf16 v[116:119], v[68:71], v[172:175], v[116:119]
    ds_read_b64_tr_b16 v[60:61], v77 offset:32768
    v_mfma_f32_16x16x32_bf16 v[128:131], v[64:67], v[176:179], v[128:131]
    ds_read_b64_tr_b16 v[62:63], v77 offset:33792
    ds_read_b128 v[160:163], v73 offset:32768
    v_mfma_f32_16x16x32_bf16 v[144:147], v[64:67], v[180:183], v[144:147]
    ds_read_b128 v[164:167], v73 offset:34816
    s_xor_b32 s56, s59, 10
    s_add_u32 m0, s14, 131072
    s_lshl_b32 s58, s56, 19
    buffer_load_dwordx4 v6, s[20:23], s58 offen offset:0  lds
    v_mfma_f32_16x16x32_bf16 v[132:135], v[68:71], v[176:179], v[132:135]
    buffer_load_dwordx4 v7, s[20:23], s58 offen offset:1024  lds
    v_mfma_f32_16x16x32_bf16 v[148:151], v[68:71], v[180:183], v[148:151]
    s_waitcnt lgkmcnt(4)
    v_mfma_f32_16x16x32_bf16 v[88:91], v[56:59], v[152:155], v[88:91]
    ds_read_b64_tr_b16 v[64:65], v78 offset:32768
    v_mfma_f32_16x16x32_bf16 v[104:107], v[56:59], v[156:159], v[104:107]
    ds_read_b64_tr_b16 v[66:67], v78 offset:33792
    s_waitcnt lgkmcnt(4)
    v_mfma_f32_16x16x32_bf16 v[92:95], v[60:63], v[152:155], v[92:95]
    ds_read_b64_tr_b16 v[68:69], v79 offset:32768
    v_mfma_f32_16x16x32_bf16 v[108:111], v[60:63], v[156:159], v[108:111]
    ds_read_b64_tr_b16 v[70:71], v79 offset:33792
    s_waitcnt lgkmcnt(4)
    v_mfma_f32_16x16x32_bf16 v[120:123], v[56:59], v[160:163], v[120:123]
    buffer_load_dwordx4 v8, s[20:23], s58 offen offset:2048  lds
    v_mfma_f32_16x16x32_bf16 v[136:139], v[56:59], v[164:167], v[136:139]
    v_mfma_f32_16x16x32_bf16 v[124:127], v[60:63], v[160:163], v[124:127]
    buffer_load_dwordx4 v9, s[20:23], s58 offen offset:3072  lds
    v_mfma_f32_16x16x32_bf16 v[140:143], v[60:63], v[164:167], v[140:143]
    s_waitcnt lgkmcnt(0)
    v_mfma_f32_16x16x32_bf16 v[96:99], v[64:67], v[152:155], v[96:99]
    ds_read_b64_tr_b16 v[56:57], v76 offset:40960
    ds_read_b64_tr_b16 v[58:59], v76 offset:41984
    v_mfma_f32_16x16x32_bf16 v[112:115], v[64:67], v[156:159], v[112:115]
    ds_read_b128 v[168:171], v74 offset:32768
    ds_read_b128 v[172:175], v74 offset:34816
    v_mfma_f32_16x16x32_bf16 v[100:103], v[68:71], v[152:155], v[100:103]
    ds_read_b64_tr_b16 v[60:61], v77 offset:40960
    v_mfma_f32_16x16x32_bf16 v[116:119], v[68:71], v[156:159], v[116:119]
    ds_read_b64_tr_b16 v[62:63], v77 offset:41984
    ds_read_b128 v[176:179], v75 offset:32768
    v_mfma_f32_16x16x32_bf16 v[128:131], v[64:67], v[160:163], v[128:131]
    ds_read_b128 v[180:183], v75 offset:34816
    v_mfma_f32_16x16x32_bf16 v[144:147], v[64:67], v[164:167], v[144:147]
    s_add_u32 m0, s14, 81920
    s_lshl_b32 s57, s56, 7
    buffer_load_dwordx4 v2, s[16:19], s57 offen offset:0  lds
    v_mfma_f32_16x16x32_bf16 v[132:135], v[68:71], v[160:163], v[132:135]
    buffer_load_dwordx4 v3, s[16:19], s57 offen offset:1024  lds
    v_mfma_f32_16x16x32_bf16 v[148:151], v[68:71], v[164:167], v[148:151]
    s_waitcnt lgkmcnt(4)
    v_mfma_f32_16x16x32_bf16 v[88:91], v[56:59], v[168:171], v[88:91]
    ds_read_b64_tr_b16 v[64:65], v78 offset:40960
    v_mfma_f32_16x16x32_bf16 v[104:107], v[56:59], v[172:175], v[104:107]
    ds_read_b64_tr_b16 v[66:67], v78 offset:41984
    s_waitcnt lgkmcnt(4)
    v_mfma_f32_16x16x32_bf16 v[92:95], v[60:63], v[168:171], v[92:95]
    ds_read_b64_tr_b16 v[68:69], v79 offset:40960
    v_mfma_f32_16x16x32_bf16 v[108:111], v[60:63], v[172:175], v[108:111]
    ds_read_b64_tr_b16 v[70:71], v79 offset:41984
    s_waitcnt lgkmcnt(4)
    v_mfma_f32_16x16x32_bf16 v[120:123], v[56:59], v[176:179], v[120:123]
    buffer_load_dwordx4 v4, s[16:19], s57 offen offset:2048  lds
    v_mfma_f32_16x16x32_bf16 v[136:139], v[56:59], v[180:183], v[136:139]
    v_mfma_f32_16x16x32_bf16 v[124:127], v[60:63], v[176:179], v[124:127]
    buffer_load_dwordx4 v5, s[16:19], s57 offen offset:3072  lds
    v_mfma_f32_16x16x32_bf16 v[140:143], v[60:63], v[180:183], v[140:143]
    s_waitcnt lgkmcnt(0)
    v_mfma_f32_16x16x32_bf16 v[96:99], v[64:67], v[168:171], v[96:99]
    v_mfma_f32_16x16x32_bf16 v[112:115], v[64:67], v[172:175], v[112:115]
    s_waitcnt vmcnt(8)
    s_barrier
    ds_read_b64_tr_b16 v[56:57], v76 offset:0
    ds_read_b64_tr_b16 v[58:59], v76 offset:1024
    v_mfma_f32_16x16x32_bf16 v[100:103], v[68:71], v[168:171], v[100:103]
    ds_read_b128 v[152:155], v72 offset:0
    ds_read_b128 v[156:159], v72 offset:2048
    v_mfma_f32_16x16x32_bf16 v[116:119], v[68:71], v[172:175], v[116:119]
    ds_read_b64_tr_b16 v[60:61], v77 offset:0
    v_mfma_f32_16x16x32_bf16 v[128:131], v[64:67], v[176:179], v[128:131]
    ds_read_b64_tr_b16 v[62:63], v77 offset:1024
    ds_read_b128 v[160:163], v73 offset:0
    v_mfma_f32_16x16x32_bf16 v[144:147], v[64:67], v[180:183], v[144:147]
    ds_read_b128 v[164:167], v73 offset:2048
    s_xor_b32 s56, s59, 11
    s_add_u32 m0, s14, 147456
    s_lshl_b32 s58, s56, 19
    buffer_load_dwordx4 v6, s[20:23], s58 offen offset:0  lds
    v_mfma_f32_16x16x32_bf16 v[132:135], v[68:71], v[176:179], v[132:135]
    buffer_load_dwordx4 v7, s[20:23], s58 offen offset:1024  lds
    v_mfma_f32_16x16x32_bf16 v[148:151], v[68:71], v[180:183], v[148:151]
    s_waitcnt lgkmcnt(4)
    v_mfma_f32_16x16x32_bf16 v[88:91], v[56:59], v[152:155], v[88:91]
    ds_read_b64_tr_b16 v[64:65], v78 offset:0
    v_mfma_f32_16x16x32_bf16 v[104:107], v[56:59], v[156:159], v[104:107]
    ds_read_b64_tr_b16 v[66:67], v78 offset:1024
    s_waitcnt lgkmcnt(4)
    v_mfma_f32_16x16x32_bf16 v[92:95], v[60:63], v[152:155], v[92:95]
    ds_read_b64_tr_b16 v[68:69], v79 offset:0
    v_mfma_f32_16x16x32_bf16 v[108:111], v[60:63], v[156:159], v[108:111]
    ds_read_b64_tr_b16 v[70:71], v79 offset:1024
    s_waitcnt lgkmcnt(4)
    v_mfma_f32_16x16x32_bf16 v[120:123], v[56:59], v[160:163], v[120:123]
    buffer_load_dwordx4 v8, s[20:23], s58 offen offset:2048  lds
    v_mfma_f32_16x16x32_bf16 v[136:139], v[56:59], v[164:167], v[136:139]
    v_mfma_f32_16x16x32_bf16 v[124:127], v[60:63], v[160:163], v[124:127]
    buffer_load_dwordx4 v9, s[20:23], s58 offen offset:3072  lds
    v_mfma_f32_16x16x32_bf16 v[140:143], v[60:63], v[164:167], v[140:143]
    s_waitcnt lgkmcnt(0)
    v_mfma_f32_16x16x32_bf16 v[96:99], v[64:67], v[152:155], v[96:99]
    ds_read_b64_tr_b16 v[56:57], v76 offset:8192
    ds_read_b64_tr_b16 v[58:59], v76 offset:9216
    v_mfma_f32_16x16x32_bf16 v[112:115], v[64:67], v[156:159], v[112:115]
    ds_read_b128 v[168:171], v74 offset:0
    ds_read_b128 v[172:175], v74 offset:2048
    v_mfma_f32_16x16x32_bf16 v[100:103], v[68:71], v[152:155], v[100:103]
    ds_read_b64_tr_b16 v[60:61], v77 offset:8192
    v_mfma_f32_16x16x32_bf16 v[116:119], v[68:71], v[156:159], v[116:119]
    ds_read_b64_tr_b16 v[62:63], v77 offset:9216
    ds_read_b128 v[176:179], v75 offset:0
    v_mfma_f32_16x16x32_bf16 v[128:131], v[64:67], v[160:163], v[128:131]
    ds_read_b128 v[180:183], v75 offset:2048
    v_mfma_f32_16x16x32_bf16 v[144:147], v[64:67], v[164:167], v[144:147]
    s_add_u32 m0, s14, 98304
    s_lshl_b32 s57, s56, 7
    buffer_load_dwordx4 v2, s[16:19], s57 offen offset:0  lds
    v_mfma_f32_16x16x32_bf16 v[132:135], v[68:71], v[160:163], v[132:135]
    buffer_load_dwordx4 v3, s[16:19], s57 offen offset:1024  lds
    v_mfma_f32_16x16x32_bf16 v[148:151], v[68:71], v[164:167], v[148:151]
    s_waitcnt lgkmcnt(4)
    v_mfma_f32_16x16x32_bf16 v[88:91], v[56:59], v[168:171], v[88:91]
    ds_read_b64_tr_b16 v[64:65], v78 offset:8192
    v_mfma_f32_16x16x32_bf16 v[104:107], v[56:59], v[172:175], v[104:107]
    ds_read_b64_tr_b16 v[66:67], v78 offset:9216
    s_waitcnt lgkmcnt(4)
    v_mfma_f32_16x16x32_bf16 v[92:95], v[60:63], v[168:171], v[92:95]
    ds_read_b64_tr_b16 v[68:69], v79 offset:8192
    v_mfma_f32_16x16x32_bf16 v[108:111], v[60:63], v[172:175], v[108:111]
    ds_read_b64_tr_b16 v[70:71], v79 offset:9216
    s_waitcnt lgkmcnt(4)
    v_mfma_f32_16x16x32_bf16 v[120:123], v[56:59], v[176:179], v[120:123]
    buffer_load_dwordx4 v4, s[16:19], s57 offen offset:2048  lds
    v_mfma_f32_16x16x32_bf16 v[136:139], v[56:59], v[180:183], v[136:139]
    v_mfma_f32_16x16x32_bf16 v[124:127], v[60:63], v[176:179], v[124:127]
    buffer_load_dwordx4 v5, s[16:19], s57 offen offset:3072  lds
    v_mfma_f32_16x16x32_bf16 v[140:143], v[60:63], v[180:183], v[140:143]
    s_waitcnt lgkmcnt(0)
    v_mfma_f32_16x16x32_bf16 v[96:99], v[64:67], v[168:171], v[96:99]
    v_mfma_f32_16x16x32_bf16 v[112:115], v[64:67], v[172:175], v[112:115]
    s_waitcnt vmcnt(8)
    s_barrier
    ds_read_b64_tr_b16 v[56:57], v76 offset:16384
    ds_read_b64_tr_b16 v[58:59], v76 offset:17408
    v_mfma_f32_16x16x32_bf16 v[100:103], v[68:71], v[168:171], v[100:103]
    ds_read_b128 v[152:155], v72 offset:16384
    ds_read_b128 v[156:159], v72 offset:18432
    v_mfma_f32_16x16x32_bf16 v[116:119], v[68:71], v[172:175], v[116:119]
    ds_read_b64_tr_b16 v[60:61], v77 offset:16384
    v_mfma_f32_16x16x32_bf16 v[128:131], v[64:67], v[176:179], v[128:131]
    ds_read_b64_tr_b16 v[62:63], v77 offset:17408
    ds_read_b128 v[160:163], v73 offset:16384
    v_mfma_f32_16x16x32_bf16 v[144:147], v[64:67], v[180:183], v[144:147]
    ds_read_b128 v[164:167], v73 offset:18432
    s_xor_b32 s56, s59, 12
    s_add_u32 m0, s14, 114688
    s_lshl_b32 s58, s56, 19
    buffer_load_dwordx4 v6, s[20:23], s58 offen offset:0  lds
    v_mfma_f32_16x16x32_bf16 v[132:135], v[68:71], v[176:179], v[132:135]
    buffer_load_dwordx4 v7, s[20:23], s58 offen offset:1024  lds
    v_mfma_f32_16x16x32_bf16 v[148:151], v[68:71], v[180:183], v[148:151]
    s_waitcnt lgkmcnt(4)
    v_mfma_f32_16x16x32_bf16 v[88:91], v[56:59], v[152:155], v[88:91]
    ds_read_b64_tr_b16 v[64:65], v78 offset:16384
    v_mfma_f32_16x16x32_bf16 v[104:107], v[56:59], v[156:159], v[104:107]
    ds_read_b64_tr_b16 v[66:67], v78 offset:17408
    s_waitcnt lgkmcnt(4)
    v_mfma_f32_16x16x32_bf16 v[92:95], v[60:63], v[152:155], v[92:95]
    ds_read_b64_tr_b16 v[68:69], v79 offset:16384
    v_mfma_f32_16x16x32_bf16 v[108:111], v[60:63], v[156:159], v[108:111]
    ds_read_b64_tr_b16 v[70:71], v79 offset:17408
    s_waitcnt lgkmcnt(4)
    v_mfma_f32_16x16x32_bf16 v[120:123], v[56:59], v[160:163], v[120:123]
    buffer_load_dwordx4 v8, s[20:23], s58 offen offset:2048  lds
    v_mfma_f32_16x16x32_bf16 v[136:139], v[56:59], v[164:167], v[136:139]
    v_mfma_f32_16x16x32_bf16 v[124:127], v[60:63], v[160:163], v[124:127]
    buffer_load_dwordx4 v9, s[20:23], s58 offen offset:3072  lds
    v_mfma_f32_16x16x32_bf16 v[140:143], v[60:63], v[164:167], v[140:143]
    s_waitcnt lgkmcnt(0)
    v_mfma_f32_16x16x32_bf16 v[96:99], v[64:67], v[152:155], v[96:99]
    ds_read_b64_tr_b16 v[56:57], v76 offset:24576
    ds_read_b64_tr_b16 v[58:59], v76 offset:25600
    v_mfma_f32_16x16x32_bf16 v[112:115], v[64:67], v[156:159], v[112:115]
    ds_read_b128 v[168:171], v74 offset:16384
    ds_read_b128 v[172:175], v74 offset:18432
    v_mfma_f32_16x16x32_bf16 v[100:103], v[68:71], v[152:155], v[100:103]
    ds_read_b64_tr_b16 v[60:61], v77 offset:24576
    v_mfma_f32_16x16x32_bf16 v[116:119], v[68:71], v[156:159], v[116:119]
    ds_read_b64_tr_b16 v[62:63], v77 offset:25600
    ds_read_b128 v[176:179], v75 offset:16384
    v_mfma_f32_16x16x32_bf16 v[128:131], v[64:67], v[160:163], v[128:131]
    ds_read_b128 v[180:183], v75 offset:18432
    v_mfma_f32_16x16x32_bf16 v[144:147], v[64:67], v[164:167], v[144:147]
    s_add_u32 m0, s14, 65536
    s_lshl_b32 s57, s56, 7
    buffer_load_dwordx4 v2, s[16:19], s57 offen offset:0  lds
    v_mfma_f32_16x16x32_bf16 v[132:135], v[68:71], v[160:163], v[132:135]
    buffer_load_dwordx4 v3, s[16:19], s57 offen offset:1024  lds
    v_mfma_f32_16x16x32_bf16 v[148:151], v[68:71], v[164:167], v[148:151]
    s_waitcnt lgkmcnt(4)
    v_mfma_f32_16x16x32_bf16 v[88:91], v[56:59], v[168:171], v[88:91]
    ds_read_b64_tr_b16 v[64:65], v78 offset:24576
    v_mfma_f32_16x16x32_bf16 v[104:107], v[56:59], v[172:175], v[104:107]
    ds_read_b64_tr_b16 v[66:67], v78 offset:25600
    s_waitcnt lgkmcnt(4)
    v_mfma_f32_16x16x32_bf16 v[92:95], v[60:63], v[168:171], v[92:95]
    ds_read_b64_tr_b16 v[68:69], v79 offset:24576
    v_mfma_f32_16x16x32_bf16 v[108:111], v[60:63], v[172:175], v[108:111]
    ds_read_b64_tr_b16 v[70:71], v79 offset:25600
    s_waitcnt lgkmcnt(4)
    v_mfma_f32_16x16x32_bf16 v[120:123], v[56:59], v[176:179], v[120:123]
    buffer_load_dwordx4 v4, s[16:19], s57 offen offset:2048  lds
    v_mfma_f32_16x16x32_bf16 v[136:139], v[56:59], v[180:183], v[136:139]
    v_mfma_f32_16x16x32_bf16 v[124:127], v[60:63], v[176:179], v[124:127]
    buffer_load_dwordx4 v5, s[16:19], s57 offen offset:3072  lds
    v_mfma_f32_16x16x32_bf16 v[140:143], v[60:63], v[180:183], v[140:143]
    s_waitcnt lgkmcnt(0)
    v_mfma_f32_16x16x32_bf16 v[96:99], v[64:67], v[168:171], v[96:99]
    v_mfma_f32_16x16x32_bf16 v[112:115], v[64:67], v[172:175], v[112:115]
    s_waitcnt vmcnt(8)
    s_barrier
    ds_read_b64_tr_b16 v[56:57], v76 offset:32768
    ds_read_b64_tr_b16 v[58:59], v76 offset:33792
    v_mfma_f32_16x16x32_bf16 v[100:103], v[68:71], v[168:171], v[100:103]
    ds_read_b128 v[152:155], v72 offset:32768
    ds_read_b128 v[156:159], v72 offset:34816
    v_mfma_f32_16x16x32_bf16 v[116:119], v[68:71], v[172:175], v[116:119]
    ds_read_b64_tr_b16 v[60:61], v77 offset:32768
    v_mfma_f32_16x16x32_bf16 v[128:131], v[64:67], v[176:179], v[128:131]
    ds_read_b64_tr_b16 v[62:63], v77 offset:33792
    ds_read_b128 v[160:163], v73 offset:32768
    v_mfma_f32_16x16x32_bf16 v[144:147], v[64:67], v[180:183], v[144:147]
    ds_read_b128 v[164:167], v73 offset:34816
    s_xor_b32 s56, s59, 13
    s_add_u32 m0, s14, 131072
    s_lshl_b32 s58, s56, 19
    buffer_load_dwordx4 v6, s[20:23], s58 offen offset:0  lds
    v_mfma_f32_16x16x32_bf16 v[132:135], v[68:71], v[176:179], v[132:135]
    buffer_load_dwordx4 v7, s[20:23], s58 offen offset:1024  lds
    v_mfma_f32_16x16x32_bf16 v[148:151], v[68:71], v[180:183], v[148:151]
    buffer_load_dwordx4 v8, s[20:23], s58 offen offset:2048  lds
    s_waitcnt lgkmcnt(4)
    v_mfma_f32_16x16x32_bf16 v[88:91], v[56:59], v[152:155], v[88:91]
    ds_read_b64_tr_b16 v[64:65], v78 offset:32768
    v_mfma_f32_16x16x32_bf16 v[104:107], v[56:59], v[156:159], v[104:107]
    ds_read_b64_tr_b16 v[66:67], v78 offset:33792
    s_waitcnt lgkmcnt(4)
    v_mfma_f32_16x16x32_bf16 v[92:95], v[60:63], v[152:155], v[92:95]
    ds_read_b64_tr_b16 v[68:69], v79 offset:32768
    v_mfma_f32_16x16x32_bf16 v[108:111], v[60:63], v[156:159], v[108:111]
    ds_read_b64_tr_b16 v[70:71], v79 offset:33792
    s_waitcnt lgkmcnt(4)
    v_mfma_f32_16x16x32_bf16 v[120:123], v[56:59], v[160:163], v[120:123]
    buffer_load_dwordx4 v9, s[20:23], s58 offen offset:3072  lds
    v_mfma_f32_16x16x32_bf16 v[136:139], v[56:59], v[164:167], v[136:139]
    v_mfma_f32_16x16x32_bf16 v[124:127], v[60:63], v[160:163], v[124:127]
    s_add_u32 m0, s14, 81920
    s_lshl_b32 s57, s56, 7
    buffer_load_dwordx4 v2, s[16:19], s57 offen offset:0  lds
    v_mfma_f32_16x16x32_bf16 v[140:143], v[60:63], v[164:167], v[140:143]
    s_waitcnt lgkmcnt(0)
    v_mfma_f32_16x16x32_bf16 v[96:99], v[64:67], v[152:155], v[96:99]
    ds_read_b64_tr_b16 v[56:57], v76 offset:40960
    ds_read_b64_tr_b16 v[58:59], v76 offset:41984
    v_mfma_f32_16x16x32_bf16 v[112:115], v[64:67], v[156:159], v[112:115]
    ds_read_b128 v[168:171], v74 offset:32768
    ds_read_b128 v[172:175], v74 offset:34816
    v_mfma_f32_16x16x32_bf16 v[100:103], v[68:71], v[152:155], v[100:103]
    ds_read_b64_tr_b16 v[60:61], v77 offset:40960
    v_mfma_f32_16x16x32_bf16 v[116:119], v[68:71], v[156:159], v[116:119]
    ds_read_b64_tr_b16 v[62:63], v77 offset:41984
    ds_read_b128 v[176:179], v75 offset:32768
    v_mfma_f32_16x16x32_bf16 v[128:131], v[64:67], v[160:163], v[128:131]
    ds_read_b128 v[180:183], v75 offset:34816
    v_mfma_f32_16x16x32_bf16 v[144:147], v[64:67], v[164:167], v[144:147]
    buffer_load_dwordx4 v3, s[16:19], s57 offen offset:1024  lds
    v_mfma_f32_16x16x32_bf16 v[132:135], v[68:71], v[160:163], v[132:135]
    buffer_load_dwordx4 v4, s[16:19], s57 offen offset:2048  lds
    v_mfma_f32_16x16x32_bf16 v[148:151], v[68:71], v[164:167], v[148:151]
    s_waitcnt lgkmcnt(4)
    v_mfma_f32_16x16x32_bf16 v[88:91], v[56:59], v[168:171], v[88:91]
    ds_read_b64_tr_b16 v[64:65], v78 offset:40960
    v_mfma_f32_16x16x32_bf16 v[104:107], v[56:59], v[172:175], v[104:107]
    ds_read_b64_tr_b16 v[66:67], v78 offset:41984
    s_waitcnt lgkmcnt(4)
    v_mfma_f32_16x16x32_bf16 v[92:95], v[60:63], v[168:171], v[92:95]
    ds_read_b64_tr_b16 v[68:69], v79 offset:40960
    v_mfma_f32_16x16x32_bf16 v[108:111], v[60:63], v[172:175], v[108:111]
    ds_read_b64_tr_b16 v[70:71], v79 offset:41984
    s_waitcnt lgkmcnt(4)
    v_mfma_f32_16x16x32_bf16 v[120:123], v[56:59], v[176:179], v[120:123]
    buffer_load_dwordx4 v5, s[16:19], s57 offen offset:3072  lds
    v_mfma_f32_16x16x32_bf16 v[136:139], v[56:59], v[180:183], v[136:139]
    v_mfma_f32_16x16x32_bf16 v[124:127], v[60:63], v[176:179], v[124:127]
    global_load_dwordx4 v[248:251], v41, s[34:35]
    v_mfma_f32_16x16x32_bf16 v[140:143], v[60:63], v[180:183], v[140:143]
    s_waitcnt lgkmcnt(0)
    v_mfma_f32_16x16x32_bf16 v[96:99], v[64:67], v[168:171], v[96:99]
    v_mfma_f32_16x16x32_bf16 v[112:115], v[64:67], v[172:175], v[112:115]
    s_waitcnt vmcnt(9)
    s_barrier
    ds_read_b64_tr_b16 v[56:57], v76 offset:0
    ds_read_b64_tr_b16 v[58:59], v76 offset:1024
    v_mfma_f32_16x16x32_bf16 v[100:103], v[68:71], v[168:171], v[100:103]
    ds_read_b128 v[152:155], v72 offset:0
    ds_read_b128 v[156:159], v72 offset:2048
    v_mfma_f32_16x16x32_bf16 v[116:119], v[68:71], v[172:175], v[116:119]
    ds_read_b64_tr_b16 v[60:61], v77 offset:0
    v_mfma_f32_16x16x32_bf16 v[128:131], v[64:67], v[176:179], v[128:131]
    ds_read_b64_tr_b16 v[62:63], v77 offset:1024
    ds_read_b128 v[160:163], v73 offset:0
    v_mfma_f32_16x16x32_bf16 v[144:147], v[64:67], v[180:183], v[144:147]
    ds_read_b128 v[164:167], v73 offset:2048
    s_xor_b32 s56, s59, 14
    s_add_u32 m0, s14, 147456
    s_lshl_b32 s58, s56, 19
    buffer_load_dwordx4 v6, s[20:23], s58 offen offset:0  lds
    v_mfma_f32_16x16x32_bf16 v[132:135], v[68:71], v[176:179], v[132:135]
    buffer_load_dwordx4 v7, s[20:23], s58 offen offset:1024  lds
    v_mfma_f32_16x16x32_bf16 v[148:151], v[68:71], v[180:183], v[148:151]
    s_waitcnt lgkmcnt(4)
    v_mfma_f32_16x16x32_bf16 v[88:91], v[56:59], v[152:155], v[88:91]
    ds_read_b64_tr_b16 v[64:65], v78 offset:0
    v_mfma_f32_16x16x32_bf16 v[104:107], v[56:59], v[156:159], v[104:107]
    ds_read_b64_tr_b16 v[66:67], v78 offset:1024
    s_waitcnt lgkmcnt(4)
    v_mfma_f32_16x16x32_bf16 v[92:95], v[60:63], v[152:155], v[92:95]
    ds_read_b64_tr_b16 v[68:69], v79 offset:0
    v_mfma_f32_16x16x32_bf16 v[108:111], v[60:63], v[156:159], v[108:111]
    ds_read_b64_tr_b16 v[70:71], v79 offset:1024
    s_waitcnt lgkmcnt(4)
    v_mfma_f32_16x16x32_bf16 v[120:123], v[56:59], v[160:163], v[120:123]
    buffer_load_dwordx4 v8, s[20:23], s58 offen offset:2048  lds
    v_mfma_f32_16x16x32_bf16 v[136:139], v[56:59], v[164:167], v[136:139]
    v_mfma_f32_16x16x32_bf16 v[124:127], v[60:63], v[160:163], v[124:127]
    buffer_load_dwordx4 v9, s[20:23], s58 offen offset:3072  lds
    v_mfma_f32_16x16x32_bf16 v[140:143], v[60:63], v[164:167], v[140:143]
    s_waitcnt lgkmcnt(0)
    v_mfma_f32_16x16x32_bf16 v[96:99], v[64:67], v[152:155], v[96:99]
    ds_read_b64_tr_b16 v[56:57], v76 offset:8192
    ds_read_b64_tr_b16 v[58:59], v76 offset:9216
    v_mfma_f32_16x16x32_bf16 v[112:115], v[64:67], v[156:159], v[112:115]
    ds_read_b128 v[168:171], v74 offset:0
    ds_read_b128 v[172:175], v74 offset:2048
    v_mfma_f32_16x16x32_bf16 v[100:103], v[68:71], v[152:155], v[100:103]
    ds_read_b64_tr_b16 v[60:61], v77 offset:8192
    v_mfma_f32_16x16x32_bf16 v[116:119], v[68:71], v[156:159], v[116:119]
    ds_read_b64_tr_b16 v[62:63], v77 offset:9216
    ds_read_b128 v[176:179], v75 offset:0
    v_mfma_f32_16x16x32_bf16 v[128:131], v[64:67], v[160:163], v[128:131]
    ds_read_b128 v[180:183], v75 offset:2048
    v_mfma_f32_16x16x32_bf16 v[144:147], v[64:67], v[164:167], v[144:147]
    s_add_u32 m0, s14, 98304
    s_lshl_b32 s57, s56, 7
    buffer_load_dwordx4 v2, s[16:19], s57 offen offset:0  lds
    v_mfma_f32_16x16x32_bf16 v[132:135], v[68:71], v[160:163], v[132:135]
    buffer_load_dwordx4 v3, s[16:19], s57 offen offset:1024  lds
    v_mfma_f32_16x16x32_bf16 v[148:151], v[68:71], v[164:167], v[148:151]
    s_waitcnt lgkmcnt(4)
    v_mfma_f32_16x16x32_bf16 v[88:91], v[56:59], v[168:171], v[88:91]
    ds_read_b64_tr_b16 v[64:65], v78 offset:8192
    v_mfma_f32_16x16x32_bf16 v[104:107], v[56:59], v[172:175], v[104:107]
    ds_read_b64_tr_b16 v[66:67], v78 offset:9216
    s_waitcnt lgkmcnt(4)
    v_mfma_f32_16x16x32_bf16 v[92:95], v[60:63], v[168:171], v[92:95]
    ds_read_b64_tr_b16 v[68:69], v79 offset:8192
    v_mfma_f32_16x16x32_bf16 v[108:111], v[60:63], v[172:175], v[108:111]
    ds_read_b64_tr_b16 v[70:71], v79 offset:9216
    s_waitcnt lgkmcnt(4)
    v_mfma_f32_16x16x32_bf16 v[120:123], v[56:59], v[176:179], v[120:123]
    buffer_load_dwordx4 v4, s[16:19], s57 offen offset:2048  lds
    v_mfma_f32_16x16x32_bf16 v[136:139], v[56:59], v[180:183], v[136:139]
    v_mfma_f32_16x16x32_bf16 v[124:127], v[60:63], v[176:179], v[124:127]
    buffer_load_dwordx4 v5, s[16:19], s57 offen offset:3072  lds
    v_mfma_f32_16x16x32_bf16 v[140:143], v[60:63], v[180:183], v[140:143]
    s_waitcnt lgkmcnt(0)
    v_mfma_f32_16x16x32_bf16 v[96:99], v[64:67], v[168:171], v[96:99]
    v_mfma_f32_16x16x32_bf16 v[112:115], v[64:67], v[172:175], v[112:115]
    s_waitcnt vmcnt(9)
    s_barrier
    ds_read_b64_tr_b16 v[56:57], v76 offset:16384
    ds_read_b64_tr_b16 v[58:59], v76 offset:17408
    v_mfma_f32_16x16x32_bf16 v[100:103], v[68:71], v[168:171], v[100:103]
    ds_read_b128 v[152:155], v72 offset:16384
    ds_read_b128 v[156:159], v72 offset:18432
    v_mfma_f32_16x16x32_bf16 v[116:119], v[68:71], v[172:175], v[116:119]
    ds_read_b64_tr_b16 v[60:61], v77 offset:16384
    v_mfma_f32_16x16x32_bf16 v[128:131], v[64:67], v[176:179], v[128:131]
    ds_read_b64_tr_b16 v[62:63], v77 offset:17408
    ds_read_b128 v[160:163], v73 offset:16384
    v_mfma_f32_16x16x32_bf16 v[144:147], v[64:67], v[180:183], v[144:147]
    ds_read_b128 v[164:167], v73 offset:18432
    s_xor_b32 s56, s59, 15
    s_add_u32 m0, s14, 114688
    s_lshl_b32 s58, s56, 19
    buffer_load_dwordx4 v6, s[20:23], s58 offen offset:0  lds
    v_mfma_f32_16x16x32_bf16 v[132:135], v[68:71], v[176:179], v[132:135]
    buffer_load_dwordx4 v7, s[20:23], s58 offen offset:1024  lds
    v_mfma_f32_16x16x32_bf16 v[148:151], v[68:71], v[180:183], v[148:151]
    s_waitcnt lgkmcnt(4)
    v_mfma_f32_16x16x32_bf16 v[88:91], v[56:59], v[152:155], v[88:91]
    ds_read_b64_tr_b16 v[64:65], v78 offset:16384
    v_mfma_f32_16x16x32_bf16 v[104:107], v[56:59], v[156:159], v[104:107]
    ds_read_b64_tr_b16 v[66:67], v78 offset:17408
    s_waitcnt lgkmcnt(4)
    v_mfma_f32_16x16x32_bf16 v[92:95], v[60:63], v[152:155], v[92:95]
    ds_read_b64_tr_b16 v[68:69], v79 offset:16384
    v_mfma_f32_16x16x32_bf16 v[108:111], v[60:63], v[156:159], v[108:111]
    ds_read_b64_tr_b16 v[70:71], v79 offset:17408
    s_waitcnt lgkmcnt(4)
    v_mfma_f32_16x16x32_bf16 v[120:123], v[56:59], v[160:163], v[120:123]
    buffer_load_dwordx4 v8, s[20:23], s58 offen offset:2048  lds
    v_mfma_f32_16x16x32_bf16 v[136:139], v[56:59], v[164:167], v[136:139]
    v_mfma_f32_16x16x32_bf16 v[124:127], v[60:63], v[160:163], v[124:127]
    buffer_load_dwordx4 v9, s[20:23], s58 offen offset:3072  lds
    v_mfma_f32_16x16x32_bf16 v[140:143], v[60:63], v[164:167], v[140:143]
    s_waitcnt lgkmcnt(0)
    v_mfma_f32_16x16x32_bf16 v[96:99], v[64:67], v[152:155], v[96:99]
    ds_read_b64_tr_b16 v[56:57], v76 offset:24576
    ds_read_b64_tr_b16 v[58:59], v76 offset:25600
    v_mfma_f32_16x16x32_bf16 v[112:115], v[64:67], v[156:159], v[112:115]
    ds_read_b128 v[168:171], v74 offset:16384
    ds_read_b128 v[172:175], v74 offset:18432
    v_mfma_f32_16x16x32_bf16 v[100:103], v[68:71], v[152:155], v[100:103]
    ds_read_b64_tr_b16 v[60:61], v77 offset:24576
    v_mfma_f32_16x16x32_bf16 v[116:119], v[68:71], v[156:159], v[116:119]
    ds_read_b64_tr_b16 v[62:63], v77 offset:25600
    ds_read_b128 v[176:179], v75 offset:16384
    v_mfma_f32_16x16x32_bf16 v[128:131], v[64:67], v[160:163], v[128:131]
    ds_read_b128 v[180:183], v75 offset:18432
    v_mfma_f32_16x16x32_bf16 v[144:147], v[64:67], v[164:167], v[144:147]
    s_add_u32 m0, s14, 65536
    s_lshl_b32 s57, s56, 7
    buffer_load_dwordx4 v2, s[16:19], s57 offen offset:0  lds
    v_mfma_f32_16x16x32_bf16 v[132:135], v[68:71], v[160:163], v[132:135]
    buffer_load_dwordx4 v3, s[16:19], s57 offen offset:1024  lds
    v_mfma_f32_16x16x32_bf16 v[148:151], v[68:71], v[164:167], v[148:151]
    s_waitcnt lgkmcnt(4)
    v_mfma_f32_16x16x32_bf16 v[88:91], v[56:59], v[168:171], v[88:91]
    ds_read_b64_tr_b16 v[64:65], v78 offset:24576
    v_mfma_f32_16x16x32_bf16 v[104:107], v[56:59], v[172:175], v[104:107]
    ds_read_b64_tr_b16 v[66:67], v78 offset:25600
    s_waitcnt lgkmcnt(4)
    v_mfma_f32_16x16x32_bf16 v[92:95], v[60:63], v[168:171], v[92:95]
    ds_read_b64_tr_b16 v[68:69], v79 offset:24576
    v_mfma_f32_16x16x32_bf16 v[108:111], v[60:63], v[172:175], v[108:111]
    ds_read_b64_tr_b16 v[70:71], v79 offset:25600
    s_waitcnt lgkmcnt(4)
    v_mfma_f32_16x16x32_bf16 v[120:123], v[56:59], v[176:179], v[120:123]
    buffer_load_dwordx4 v4, s[16:19], s57 offen offset:2048  lds
    v_mfma_f32_16x16x32_bf16 v[136:139], v[56:59], v[180:183], v[136:139]
    v_mfma_f32_16x16x32_bf16 v[124:127], v[60:63], v[176:179], v[124:127]
    buffer_load_dwordx4 v5, s[16:19], s57 offen offset:3072  lds
    v_mfma_f32_16x16x32_bf16 v[140:143], v[60:63], v[180:183], v[140:143]
    s_waitcnt lgkmcnt(0)
    v_mfma_f32_16x16x32_bf16 v[96:99], v[64:67], v[168:171], v[96:99]
    v_mfma_f32_16x16x32_bf16 v[112:115], v[64:67], v[172:175], v[112:115]
    s_waitcnt vmcnt(8)
    s_barrier
    ds_read_b64_tr_b16 v[56:57], v76 offset:32768
    ds_read_b64_tr_b16 v[58:59], v76 offset:33792
    v_mfma_f32_16x16x32_bf16 v[100:103], v[68:71], v[168:171], v[100:103]
    ds_read_b128 v[152:155], v72 offset:32768
    ds_read_b128 v[156:159], v72 offset:34816
    v_mfma_f32_16x16x32_bf16 v[116:119], v[68:71], v[172:175], v[116:119]
    ds_read_b64_tr_b16 v[60:61], v77 offset:32768
    v_mfma_f32_16x16x32_bf16 v[128:131], v[64:67], v[176:179], v[128:131]
    ds_read_b64_tr_b16 v[62:63], v77 offset:33792
    ds_read_b128 v[160:163], v73 offset:32768
    v_mfma_f32_16x16x32_bf16 v[144:147], v[64:67], v[180:183], v[144:147]
    ds_read_b128 v[164:167], v73 offset:34816
    s_add_u32 m0, s14, 81920
    s_xor_b32 s65, s12, 90112
    buffer_load_dwordx4 v10, s[24:27], s65 offen offset:0 nt lds
    v_mfma_f32_16x16x32_bf16 v[132:135], v[68:71], v[176:179], v[132:135]
    buffer_load_dwordx4 v11, s[24:27], s65 offen offset:1024 nt lds
    v_mfma_f32_16x16x32_bf16 v[148:151], v[68:71], v[180:183], v[148:151]
    s_waitcnt lgkmcnt(4)
    v_mfma_f32_16x16x32_bf16 v[88:91], v[56:59], v[152:155], v[88:91]
    ds_read_b64_tr_b16 v[64:65], v78 offset:32768
    v_mfma_f32_16x16x32_bf16 v[104:107], v[56:59], v[156:159], v[104:107]
    ds_read_b64_tr_b16 v[66:67], v78 offset:33792
    s_waitcnt lgkmcnt(4)
    v_mfma_f32_16x16x32_bf16 v[92:95], v[60:63], v[152:155], v[92:95]
    ds_read_b64_tr_b16 v[68:69], v79 offset:32768
    v_mfma_f32_16x16x32_bf16 v[108:111], v[60:63], v[156:159], v[108:111]
    ds_read_b64_tr_b16 v[70:71], v79 offset:33792
    s_waitcnt lgkmcnt(4)
    v_mfma_f32_16x16x32_bf16 v[120:123], v[56:59], v[160:163], v[120:123]
    buffer_load_dwordx4 v12, s[24:27], s65 offen offset:2048 nt lds
    v_mfma_f32_16x16x32_bf16 v[136:139], v[56:59], v[164:167], v[136:139]
    v_mfma_f32_16x16x32_bf16 v[124:127], v[60:63], v[160:163], v[124:127]
    buffer_load_dwordx4 v13, s[24:27], s65 offen offset:3072 nt lds
    v_mfma_f32_16x16x32_bf16 v[140:143], v[60:63], v[164:167], v[140:143]
    s_waitcnt lgkmcnt(0)
    v_mfma_f32_16x16x32_bf16 v[96:99], v[64:67], v[152:155], v[96:99]
    ds_read_b64_tr_b16 v[56:57], v76 offset:40960
    ds_read_b64_tr_b16 v[58:59], v76 offset:41984
    v_mfma_f32_16x16x32_bf16 v[112:115], v[64:67], v[156:159], v[112:115]
    ds_read_b128 v[168:171], v74 offset:32768
    ds_read_b128 v[172:175], v74 offset:34816
    v_mfma_f32_16x16x32_bf16 v[100:103], v[68:71], v[152:155], v[100:103]
    ds_read_b64_tr_b16 v[60:61], v77 offset:40960
    v_mfma_f32_16x16x32_bf16 v[116:119], v[68:71], v[156:159], v[116:119]
    ds_read_b64_tr_b16 v[62:63], v77 offset:41984
    ds_read_b128 v[176:179], v75 offset:32768
    v_mfma_f32_16x16x32_bf16 v[128:131], v[64:67], v[160:163], v[128:131]
    ds_read_b128 v[180:183], v75 offset:34816
    v_mfma_f32_16x16x32_bf16 v[144:147], v[64:67], v[164:167], v[144:147]
    s_add_u32 m0, s14, 131072
    s_xor_b32 s65, s12, 106496
    buffer_load_dwordx4 v10, s[24:27], s65 offen offset:0 nt lds
    v_mfma_f32_16x16x32_bf16 v[132:135], v[68:71], v[160:163], v[132:135]
    buffer_load_dwordx4 v11, s[24:27], s65 offen offset:1024 nt lds
    v_mfma_f32_16x16x32_bf16 v[148:151], v[68:71], v[164:167], v[148:151]
    s_waitcnt lgkmcnt(4)
    v_mfma_f32_16x16x32_bf16 v[88:91], v[56:59], v[168:171], v[88:91]
    ds_read_b64_tr_b16 v[64:65], v78 offset:40960
    v_mfma_f32_16x16x32_bf16 v[104:107], v[56:59], v[172:175], v[104:107]
    ds_read_b64_tr_b16 v[66:67], v78 offset:41984
    s_waitcnt lgkmcnt(4)
    v_mfma_f32_16x16x32_bf16 v[92:95], v[60:63], v[168:171], v[92:95]
    ds_read_b64_tr_b16 v[68:69], v79 offset:40960
    v_mfma_f32_16x16x32_bf16 v[108:111], v[60:63], v[172:175], v[108:111]
    ds_read_b64_tr_b16 v[70:71], v79 offset:41984
    s_waitcnt lgkmcnt(4)
    v_mfma_f32_16x16x32_bf16 v[120:123], v[56:59], v[176:179], v[120:123]
    buffer_load_dwordx4 v12, s[24:27], s65 offen offset:2048 nt lds
    v_mfma_f32_16x16x32_bf16 v[136:139], v[56:59], v[180:183], v[136:139]
    v_mfma_f32_16x16x32_bf16 v[124:127], v[60:63], v[176:179], v[124:127]
    buffer_load_dwordx4 v13, s[24:27], s65 offen offset:3072 nt lds
    v_mfma_f32_16x16x32_bf16 v[140:143], v[60:63], v[180:183], v[140:143]
    s_waitcnt lgkmcnt(0)
    v_mfma_f32_16x16x32_bf16 v[96:99], v[64:67], v[168:171], v[96:99]
    v_mfma_f32_16x16x32_bf16 v[112:115], v[64:67], v[172:175], v[112:115]
    s_waitcnt vmcnt(8)
    s_barrier
    ds_read_b64_tr_b16 v[56:57], v76 offset:0
    ds_read_b64_tr_b16 v[58:59], v76 offset:1024
    v_mfma_f32_16x16x32_bf16 v[100:103], v[68:71], v[168:171], v[100:103]
    ds_read_b128 v[152:155], v72 offset:0
    ds_read_b128 v[156:159], v72 offset:2048
    v_mfma_f32_16x16x32_bf16 v[116:119], v[68:71], v[172:175], v[116:119]
    ds_read_b64_tr_b16 v[60:61], v77 offset:0
    v_mfma_f32_16x16x32_bf16 v[128:131], v[64:67], v[176:179], v[128:131]
    ds_read_b64_tr_b16 v[62:63], v77 offset:1024
    ds_read_b128 v[160:163], v73 offset:0
    v_mfma_f32_16x16x32_bf16 v[144:147], v[64:67], v[180:183], v[144:147]
    ds_read_b128 v[164:167], v73 offset:2048
    s_add_u32 m0, s14, 98304
    s_xor_b32 s65, s12, 122880
    buffer_load_dwordx4 v10, s[24:27], s65 offen offset:0 nt lds
    v_mfma_f32_16x16x32_bf16 v[132:135], v[68:71], v[176:179], v[132:135]
    v_mfma_f32_16x16x32_bf16 v[148:151], v[68:71], v[180:183], v[148:151]
    s_waitcnt lgkmcnt(4)
    v_mfma_f32_16x16x32_bf16 v[88:91], v[56:59], v[152:155], v[88:91]
    ds_read_b64_tr_b16 v[64:65], v78 offset:0
    v_mfma_f32_16x16x32_bf16 v[104:107], v[56:59], v[156:159], v[104:107]
    ds_read_b64_tr_b16 v[66:67], v78 offset:1024
    s_waitcnt lgkmcnt(4)
    v_mfma_f32_16x16x32_bf16 v[92:95], v[60:63], v[152:155], v[92:95]
    ds_read_b64_tr_b16 v[68:69], v79 offset:0
    v_mfma_f32_16x16x32_bf16 v[108:111], v[60:63], v[156:159], v[108:111]
    ds_read_b64_tr_b16 v[70:71], v79 offset:1024
    s_waitcnt lgkmcnt(4)
    v_mfma_f32_16x16x32_bf16 v[120:123], v[56:59], v[160:163], v[120:123]
    buffer_load_dwordx4 v11, s[24:27], s65 offen offset:1024 nt lds
    v_mfma_f32_16x16x32_bf16 v[136:139], v[56:59], v[164:167], v[136:139]
    v_mfma_f32_16x16x32_bf16 v[124:127], v[60:63], v[160:163], v[124:127]
    v_mfma_f32_16x16x32_bf16 v[140:143], v[60:63], v[164:167], v[140:143]
    s_waitcnt lgkmcnt(0)
    v_mfma_f32_16x16x32_bf16 v[96:99], v[64:67], v[152:155], v[96:99]
    ds_read_b64_tr_b16 v[56:57], v76 offset:8192
    ds_read_b64_tr_b16 v[58:59], v76 offset:9216
    v_mfma_f32_16x16x32_bf16 v[112:115], v[64:67], v[156:159], v[112:115]
    ds_read_b128 v[168:171], v74 offset:0
    ds_read_b128 v[172:175], v74 offset:2048
    v_mfma_f32_16x16x32_bf16 v[100:103], v[68:71], v[152:155], v[100:103]
    ds_read_b64_tr_b16 v[60:61], v77 offset:8192
    v_mfma_f32_16x16x32_bf16 v[116:119], v[68:71], v[156:159], v[116:119]
    ds_read_b64_tr_b16 v[62:63], v77 offset:9216
    ds_read_b128 v[176:179], v75 offset:0
    v_mfma_f32_16x16x32_bf16 v[128:131], v[64:67], v[160:163], v[128:131]
    ds_read_b128 v[180:183], v75 offset:2048
    v_mfma_f32_16x16x32_bf16 v[144:147], v[64:67], v[164:167], v[144:147]
    buffer_load_dwordx4 v12, s[24:27], s65 offen offset:2048 nt lds
    v_mfma_f32_16x16x32_bf16 v[132:135], v[68:71], v[160:163], v[132:135]
    v_mfma_f32_16x16x32_bf16 v[148:151], v[68:71], v[164:167], v[148:151]
    s_waitcnt lgkmcnt(4)
    v_mfma_f32_16x16x32_bf16 v[88:91], v[56:59], v[168:171], v[88:91]
    ds_read_b64_tr_b16 v[64:65], v78 offset:8192
    v_mfma_f32_16x16x32_bf16 v[104:107], v[56:59], v[172:175], v[104:107]
    ds_read_b64_tr_b16 v[66:67], v78 offset:9216
    s_waitcnt lgkmcnt(4)
    v_mfma_f32_16x16x32_bf16 v[92:95], v[60:63], v[168:171], v[92:95]
    ds_read_b64_tr_b16 v[68:69], v79 offset:8192
    v_mfma_f32_16x16x32_bf16 v[108:111], v[60:63], v[172:175], v[108:111]
    ds_read_b64_tr_b16 v[70:71], v79 offset:9216
    s_waitcnt lgkmcnt(4)
    v_mfma_f32_16x16x32_bf16 v[120:123], v[56:59], v[176:179], v[120:123]
    buffer_load_dwordx4 v13, s[24:27], s65 offen offset:3072 nt lds
    v_mfma_f32_16x16x32_bf16 v[136:139], v[56:59], v[180:183], v[136:139]
    v_mfma_f32_16x16x32_bf16 v[124:127], v[60:63], v[176:179], v[124:127]
    v_mfma_f32_16x16x32_bf16 v[140:143], v[60:63], v[180:183], v[140:143]
    s_cmp_lg_u32 s54, 14
    s_cbranch_scc1 L_nohook_15
    s_call_b64 s[32:33], L_burst
L_nohook_15:
    s_waitcnt lgkmcnt(0)
    v_mfma_f32_16x16x32_bf16 v[96:99], v[64:67], v[168:171], v[96:99]
    v_mfma_f32_16x16x32_bf16 v[112:115], v[64:67], v[172:175], v[112:115]
    v_mfma_f32_16x16x32_bf16 v[100:103], v[68:71], v[168:171], v[100:103]
    v_mfma_f32_16x16x32_bf16 v[116:119], v[68:71], v[172:175], v[116:119]
    v_mfma_f32_16x16x32_bf16 v[128:131], v[64:67], v[176:179], v[128:131]
    v_mfma_f32_16x16x32_bf16 v[144:147], v[64:67], v[180:183], v[144:147]
    v_mfma_f32_16x16x32_bf16 v[132:135], v[68:71], v[176:179], v[132:135]
    v_mfma_f32_16x16x32_bf16 v[148:151], v[68:71], v[180:183], v[148:151]
    s_xor_b32 s63, s14, 4096
    s_add_u32 s63, s63, 0x24000
    v_add_u32 v37, s63, v36
    v_xor_b32 v72, 4096, v37
    v_cvt_pk_bf16_f32 v56, v120, v121
    v_cvt_pk_bf16_f32 v57, v122, v123
    v_cvt_pk_bf16_f32 v58, v124, v125
    v_cvt_pk_bf16_f32 v59, v126, v127
    v_cvt_pk_bf16_f32 v60, v128, v129
    v_cvt_pk_bf16_f32 v61, v130, v131
    v_cvt_pk_bf16_f32 v62, v132, v133
    v_cvt_pk_bf16_f32 v63, v134, v135
    v_permlane32_swap_b32 v56, v58
    v_permlane32_swap_b32 v57, v59
    v_permlane32_swap_b32 v60, v62
    v_permlane32_swap_b32 v61, v63
    v_permlane16_swap_b32 v56, v58
    v_permlane16_swap_b32 v57, v59
    v_permlane16_swap_b32 v60, v62
    v_permlane16_swap_b32 v61, v63
    ds_write_b128 v37, v[56:59] offset:0
    ds_write_b128 v37, v[60:63] offset:1024
    v_cvt_pk_bf16_f32 v64, v136, v137
    v_cvt_pk_bf16_f32 v65, v138, v139
    v_cvt_pk_bf16_f32 v66, v140, v141
    v_cvt_pk_bf16_f32 v67, v142, v143
    v_cvt_pk_bf16_f32 v68, v144, v145
    v_cvt_pk_bf16_f32 v69, v146, v147
    v_cvt_pk_bf16_f32 v70, v148, v149
    v_cvt_pk_bf16_f32 v71, v150, v151
    v_permlane32_swap_b32 v64, v66
    v_permlane32_swap_b32 v65, v67
    v_permlane32_swap_b32 v68, v70
    v_permlane32_swap_b32 v69, v71
    v_permlane16_swap_b32 v64, v66
    v_permlane16_swap_b32 v65, v67
    v_permlane16_swap_b32 v68, v70
    v_permlane16_swap_b32 v69, v71
    ds_write_b128 v37, v[64:67] offset:2048
    ds_write_b128 v37, v[68:71] offset:3072
    v_cvt_pk_bf16_f32 v152, v88, v89
    v_cvt_pk_bf16_f32 v153, v90, v91
    v_cvt_pk_bf16_f32 v154, v92, v93
    v_cvt_pk_bf16_f32 v155, v94, v95
    v_cvt_pk_bf16_f32 v156, v96, v97
    v_cvt_pk_bf16_f32 v157, v98, v99
    v_cvt_pk_bf16_f32 v158, v100, v101
    v_cvt_pk_bf16_f32 v159, v102, v103
    v_permlane32_swap_b32 v152, v154
    v_permlane32_swap_b32 v153, v155
    v_permlane32_swap_b32 v156, v158
    v_permlane32_swap_b32 v157, v159
    v_permlane16_swap_b32 v152, v154
    v_permlane16_swap_b32 v153, v155
    v_permlane16_swap_b32 v156, v158
    v_permlane16_swap_b32 v157, v159
    v_cvt_pk_bf16_f32 v168, v104, v105
    v_cvt_pk_bf16_f32 v169, v106, v107
    v_cvt_pk_bf16_f32 v170, v108, v109
    v_cvt_pk_bf16_f32 v171, v110, v111
    v_cvt_pk_bf16_f32 v172, v112, v113
    v_cvt_pk_bf16_f32 v173, v114, v115
    v_cvt_pk_bf16_f32 v174, v116, v117
    v_cvt_pk_bf16_f32 v175, v118, v119
    v_permlane32_swap_b32 v168, v170
    v_permlane32_swap_b32 v169, v171
    v_permlane32_swap_b32 v172, v174
    v_permlane32_swap_b32 v173, v175
    v_permlane16_swap_b32 v168, v170
    v_permlane16_swap_b32 v169, v171
    v_permlane16_swap_b32 v172, v174
    v_permlane16_swap_b32 v173, v175
    s_waitcnt lgkmcnt(0)
    v_mfma_f32_16x16x32_bf16 v[88:91], a[0:3], v[152:155], 0
    v_mfma_f32_16x16x32_bf16 v[96:99], a[0:3], v[168:171], 0
    s_barrier
    ds_read_b128 v[160:163], v72 offset:0
    ds_read_b128 v[164:167], v72 offset:1024
    ds_read_b128 v[176:179], v72 offset:2048
    ds_read_b128 v[180:183], v72 offset:3072
    v_mfma_f32_16x16x32_bf16 v[92:95], a[4:7], v[152:155], 0
    s_waitcnt vmcnt(7)
    s_add_u32 m0, s14, 65536
    s_xor_b32 s65, s13, 0
    buffer_load_dwordx4 v18, s[28:31], s65 offen offset:0 nt lds
    v_mfma_f32_16x16x32_bf16 v[100:103], a[4:7], v[168:171], 0
    v_mfma_f32_16x16x32_bf16 v[88:91], a[8:11], v[156:159], v[88:91]
    v_mfma_f32_16x16x32_bf16 v[96:99], a[8:11], v[172:175], v[96:99]
    v_mfma_f32_16x16x32_bf16 v[92:95], a[12:15], v[156:159], v[92:95]
    v_mfma_f32_16x16x32_bf16 v[100:103], a[12:15], v[172:175], v[100:103]
    s_waitcnt lgkmcnt(0)
    v_mfma_f32_16x16x32_bf16 v[88:91], a[16:19], v[160:163], v[88:91]
    v_mfma_f32_16x16x32_bf16 v[96:99], a[16:19], v[176:179], v[96:99]
    s_waitcnt vmcnt(7)
    buffer_load_dwordx4 v19, s[28:31], s65 offen offset:1024 nt lds
    v_mfma_f32_16x16x32_bf16 v[92:95], a[20:23], v[160:163], v[92:95]
    v_mfma_f32_16x16x32_bf16 v[100:103], a[20:23], v[176:179], v[100:103]
    v_mfma_f32_16x16x32_bf16 v[88:91], a[24:27], v[164:167], v[88:91]
    s_cmp_lg_u32 s3, 0
    s_cbranch_scc1 L_noadd
    s_lshr_b32 s61, s67, 1
    s_lshl_b32 s61, s61, 5
    v_mov_b32 v252, 1
    v_mov_b32 v253, 0
    s_mov_b64 exec, 1
    buffer_atomic_add v252, v253, s[92:95], s61 offen sc1
    s_mov_b64 exec, -1
L_noadd:
    v_mfma_f32_16x16x32_bf16 v[96:99], a[24:27], v[180:183], v[96:99]
    v_mfma_f32_16x16x32_bf16 v[92:95], a[28:31], v[164:167], v[92:95]
    v_mfma_f32_16x16x32_bf16 v[100:103], a[28:31], v[180:183], v[100:103]
    v_mfma_f32_16x16x32_bf16 v[104:107], v[216:219], v[152:155], 0
    v_mfma_f32_16x16x32_bf16 v[112:115], v[216:219], v[168:171], 0
    s_barrier
    v_mfma_f32_16x16x32_bf16 v[108:111], v[220:223], v[152:155], 0
    v_max3_f32 v42, v88, v89, v90
    s_nop 1
    v_max3_f32 v42, v42, v91, v92
    v_max3_f32 v42, v42, v93, v94
    v_max_f32 v42, v42, v95
    v_mov_b32 v56, v42
    s_nop 1
    v_permlane32_swap_b32 v42, v56
    s_waitcnt vmcnt(7)
    buffer_load_dwordx4 v20, s[28:31], s65 offen offset:2048 nt lds
    v_mfma_f32_16x16x32_bf16 v[116:119], v[220:223], v[168:171], 0
    v_max_f32 v42, v42, v56
    v_mov_b32 v56, v42
    s_nop 1
    v_permlane16_swap_b32 v42, v56
    v_max_f32 v42, v42, v56
    v_mul_f32 v42, s60, v42
    v_mfma_f32_16x16x32_bf16 v[104:107], v[224:227], v[156:159], v[104:107]
    v_ceil_f32 v42, v42
    v_sub_f32 v44, 0, v42
    v_max3_f32 v42, v96, v97, v98
    v_max3_f32 v42, v42, v99, v100
    v_max3_f32 v42, v42, v101, v102
    v_mfma_f32_16x16x32_bf16 v[112:115], v[224:227], v[172:175], v[112:115]
    v_max_f32 v42, v42, v103
    v_mov_b32 v56, v42
    s_nop 1
    v_permlane32_swap_b32 v42, v56
    v_max_f32 v42, v42, v56
    v_mov_b32 v56, v42
    s_nop 1
    v_permlane16_swap_b32 v42, v56
    v_mfma_f32_16x16x32_bf16 v[108:111], v[228:231], v[156:159], v[108:111]
    v_max_f32 v42, v42, v56
    v_mul_f32 v42, s60, v42
    v_ceil_f32 v42, v42
    v_sub_f32 v45, 0, v42
    v_fma_f32 v88, v88, s60, v44
    v_mfma_f32_16x16x32_bf16 v[116:119], v[228:231], v[172:175], v[116:119]
    v_fma_f32 v89, v89, s60, v44
    v_fma_f32 v90, v90, s60, v44
    v_fma_f32 v91, v91, s60, v44
    v_fma_f32 v92, v92, s60, v44
    v_fma_f32 v93, v93, s60, v44
    v_mfma_f32_16x16x32_bf16 v[104:107], v[232:235], v[160:163], v[104:107]
    v_fma_f32 v94, v94, s60, v44
    v_fma_f32 v95, v95, s60, v44
    v_fma_f32 v96, v96, s60, v45
    v_fma_f32 v97, v97, s60, v45
    v_fma_f32 v98, v98, s60, v45
    v_mfma_f32_16x16x32_bf16 v[112:115], v[232:235], v[176:179], v[112:115]
    v_fma_f32 v99, v99, s60, v45
    v_fma_f32 v100, v100, s60, v45
    v_fma_f32 v101, v101, s60, v45
    v_fma_f32 v102, v102, s60, v45
    v_fma_f32 v103, v103, s60, v45
    v_exp_f32 v88, v88
    s_waitcnt vmcnt(7)
    buffer_load_dwordx4 v21, s[28:31], s65 offen offset:3072 nt lds
    v_mfma_f32_16x16x32_bf16 v[108:111], v[236:239], v[160:163], v[108:111]
    v_exp_f32 v89, v89
    v_exp_f32 v90, v90
    v_exp_f32 v91, v91
    v_cvt_pk_bf16_f32 v80, v88, v89
    v_exp_f32 v92, v92
    v_mfma_f32_16x16x32_bf16 v[116:119], v[236:239], v[176:179], v[116:119]
    v_exp_f32 v93, v93
    v_cvt_pk_bf16_f32 v81, v90, v91
    v_accvgpr_write_b32 a0, v80
    v_exp_f32 v94, v94
    v_exp_f32 v95, v95
    v_mfma_f32_16x16x32_bf16 v[104:107], v[240:243], v[164:167], v[104:107]
    v_cvt_pk_bf16_f32 v82, v92, v93
    v_accvgpr_write_b32 a1, v81
    v_exp_f32 v96, v96
    v_exp_f32 v97, v97
    v_cvt_pk_bf16_f32 v83, v94, v95
    v_accvgpr_write_b32 a2, v82
    v_mfma_f32_16x16x32_bf16 v[112:115], v[240:243], v[180:183], v[112:115]
    v_exp_f32 v98, v98
    v_exp_f32 v99, v99
    v_cvt_pk_bf16_f32 v84, v96, v97
    v_accvgpr_write_b32 a3, v83
    v_exp_f32 v100, v100
    v_mfma_f32_16x16x32_bf16 v[108:111], v[244:247], v[164:167], v[108:111]
    v_exp_f32 v101, v101
    v_cvt_pk_bf16_f32 v85, v98, v99
    v_accvgpr_write_b32 a4, v84
    v_exp_f32 v102, v102
    v_exp_f32 v103, v103
    v_mfma_f32_16x16x32_bf16 v[116:119], v[244:247], v[180:183], v[116:119]
    v_cvt_pk_bf16_f32 v86, v100, v101
    v_accvgpr_write_b32 a5, v85
    v_cvt_pk_bf16_f32 v87, v102, v103
    v_accvgpr_write_b32 a6, v86
    v_accvgpr_write_b32 a7, v87
    v_mfma_f32_16x16x32_bf16 v[88:91], a[32:35], v[152:155], 0
    v_mfma_f32_16x16x32_bf16 v[96:99], a[32:35], v[168:171], 0
    s_barrier
    ds_read_b128 v[184:187], v22 offset:16384
    ds_read_b128 v[188:191], v22 offset:20480
    v_mfma_f32_16x16x32_bf16 v[92:95], a[36:39], v[152:155], 0
    ds_read_b128 v[192:195], v23 offset:16384
    v_fma_f32 v104, v104, s60, v44
    v_fma_f32 v105, v105, s60, v44
    v_fma_f32 v106, v106, s60, v44
    v_fma_f32 v107, v107, s60, v44
    v_max_f32 v42, v104, v105
    s_waitcnt vmcnt(7)
    s_add_u32 m0, s14, 114688
    s_xor_b32 s65, s13, 16384
    buffer_load_dwordx4 v18, s[28:31], s65 offen offset:0 nt lds
    v_mfma_f32_16x16x32_bf16 v[100:103], a[36:39], v[168:171], 0
    ds_read_b128 v[196:199], v23 offset:20480
    v_fma_f32 v108, v108, s60, v44
    v_fma_f32 v109, v109, s60, v44
    v_max3_f32 v42, v42, v106, v107
    v_fma_f32 v110, v110, s60, v44
    v_mfma_f32_16x16x32_bf16 v[88:91], a[40:43], v[156:159], v[88:91]
    ds_read_b128 v[200:203], v24 offset:16384
    v_fma_f32 v111, v111, s60, v44
    v_max3_f32 v42, v42, v108, v109
    v_fma_f32 v112, v112, s60, v45
    v_fma_f32 v113, v113, s60, v45
    v_mfma_f32_16x16x32_bf16 v[96:99], a[40:43], v[172:175], v[96:99]
    ds_read_b128 v[204:207], v24 offset:20480
    v_max3_f32 v42, v42, v110, v111
    v_fma_f32 v114, v114, s60, v45
    v_fma_f32 v115, v115, s60, v45
    v_max3_f32 v42, v42, v112, v113
    v_mfma_f32_16x16x32_bf16 v[92:95], a[44:47], v[156:159], v[92:95]
    ds_read_b128 v[208:211], v25 offset:16384
    v_fma_f32 v116, v116, s60, v45
    v_fma_f32 v117, v117, s60, v45
    v_max3_f32 v42, v42, v114, v115
    v_fma_f32 v118, v118, s60, v45
    v_mfma_f32_16x16x32_bf16 v[100:103], a[44:47], v[172:175], v[100:103]
    ds_read_b128 v[212:215], v25 offset:20480
    v_fma_f32 v119, v119, s60, v45
    v_max3_f32 v42, v42, v116, v117
    v_max3_f32 v42, v42, v118, v119
    v_cmp_lt_f32 vcc, 0x41000000, v42
    s_nop 0
    s_cbranch_vccnz L_rare_1
L_back_1:
    v_mfma_f32_16x16x32_bf16 v[88:91], a[48:51], v[160:163], v[88:91]
    v_exp_f32 v104, v104
    v_exp_f32 v105, v105
    v_exp_f32 v106, v106
    v_exp_f32 v107, v107
    v_mfma_f32_16x16x32_bf16 v[96:99], a[48:51], v[176:179], v[96:99]
    v_cvt_pk_bf16_f32 v80, v104, v105
    v_exp_f32 v108, v108
    v_exp_f32 v109, v109
    v_cvt_pk_bf16_f32 v81, v106, v107
    s_waitcnt vmcnt(7)
    buffer_load_dwordx4 v19, s[28:31], s65 offen offset:1024 nt lds
    v_mfma_f32_16x16x32_bf16 v[92:95], a[52:55], v[160:163], v[92:95]
    v_accvgpr_write_b32 a8, v80
    v_exp_f32 v110, v110
    v_exp_f32 v111, v111
    v_cvt_pk_bf16_f32 v82, v108, v109
    v_mfma_f32_16x16x32_bf16 v[100:103], a[52:55], v[176:179], v[100:103]
    v_accvgpr_write_b32 a9, v81
    v_exp_f32 v112, v112
    v_exp_f32 v113, v113
    v_cvt_pk_bf16_f32 v83, v110, v111
    v_mfma_f32_16x16x32_bf16 v[88:91], a[56:59], v[164:167], v[88:91]
    v_accvgpr_write_b32 a10, v82
    v_exp_f32 v114, v114
    v_exp_f32 v115, v115
    v_cvt_pk_bf16_f32 v84, v112, v113
    v_mfma_f32_16x16x32_bf16 v[96:99], a[56:59], v[180:183], v[96:99]
    v_accvgpr_write_b32 a11, v83
    v_exp_f32 v116, v116
    v_exp_f32 v117, v117
    v_cvt_pk_bf16_f32 v85, v114, v115
    v_mfma_f32_16x16x32_bf16 v[92:95], a[60:63], v[164:167], v[92:95]
    v_accvgpr_write_b32 a12, v84
    v_exp_f32 v118, v118
    v_exp_f32 v119, v119
    v_cvt_pk_bf16_f32 v86, v116, v117
    v_mfma_f32_16x16x32_bf16 v[100:103], a[60:63], v[180:183], v[100:103]
    v_accvgpr_write_b32 a13, v85
    v_cvt_pk_bf16_f32 v87, v118, v119
    v_accvgpr_write_b32 a14, v86
    v_accvgpr_write_b32 a15, v87
    s_waitcnt lgkmcnt(0)
    v_mfma_f32_16x16x32_bf16 v[104:107], v[184:187], v[152:155], 0
    v_mfma_f32_16x16x32_bf16 v[112:115], v[184:187], v[168:171], 0
    s_barrier
    v_mfma_f32_16x16x32_bf16 v[108:111], v[188:191], v[152:155], 0
    v_fma_f32 v88, v88, s60, v44
    v_fma_f32 v89, v89, s60, v44
    v_fma_f32 v90, v90, s60, v44
    v_fma_f32 v91, v91, s60, v44
    v_max_f32 v42, v88, v89
    s_waitcnt vmcnt(7)
    buffer_load_dwordx4 v20, s[28:31], s65 offen offset:2048 nt lds
    v_mfma_f32_16x16x32_bf16 v[116:119], v[188:191], v[168:171], 0
    v_fma_f32 v92, v92, s60, v44
    v_fma_f32 v93, v93, s60, v44
    v_max3_f32 v42, v42, v90, v91
    v_fma_f32 v94, v94, s60, v44
    v_mfma_f32_16x16x32_bf16 v[104:107], v[192:195], v[156:159], v[104:107]
    v_fma_f32 v95, v95, s60, v44
    v_max3_f32 v42, v42, v92, v93
    v_fma_f32 v96, v96, s60, v45
    v_fma_f32 v97, v97, s60, v45
    v_mfma_f32_16x16x32_bf16 v[112:115], v[192:195], v[172:175], v[112:115]
    v_max3_f32 v42, v42, v94, v95
    v_fma_f32 v98, v98, s60, v45
    v_fma_f32 v99, v99, s60, v45
    v_max3_f32 v42, v42, v96, v97
    v_mfma_f32_16x16x32_bf16 v[108:111], v[196:199], v[156:159], v[108:111]
    v_fma_f32 v100, v100, s60, v45
    v_fma_f32 v101, v101, s60, v45
    v_max3_f32 v42, v42, v98, v99
    v_fma_f32 v102, v102, s60, v45
    s_waitcnt vmcnt(7)
    buffer_load_dwordx4 v21, s[28:31], s65 offen offset:3072 nt lds
    v_mfma_f32_16x16x32_bf16 v[116:119], v[196:199], v[172:175], v[116:119]
    v_fma_f32 v103, v103, s60, v45
    v_max3_f32 v42, v42, v100, v101
    v_max3_f32 v42, v42, v102, v103
    v_cmp_lt_f32 vcc, 0x41000000, v42
    s_nop 0
    s_cbranch_vccnz L_rare_2
L_back_2:
    v_mfma_f32_16x16x32_bf16 v[104:107], v[200:203], v[160:163], v[104:107]
    v_exp_f32 v88, v88
    v_exp_f32 v89, v89
    v_exp_f32 v90, v90
    v_exp_f32 v91, v91
    v_mfma_f32_16x16x32_bf16 v[112:115], v[200:203], v[176:179], v[112:115]
    v_cvt_pk_bf16_f32 v80, v88, v89
    v_exp_f32 v92, v92
    v_exp_f32 v93, v93
    v_cvt_pk_bf16_f32 v81, v90, v91
    v_mfma_f32_16x16x32_bf16 v[108:111], v[204:207], v[160:163], v[108:111]
    v_accvgpr_write_b32 a16, v80
    v_exp_f32 v94, v94
    v_exp_f32 v95, v95
    v_cvt_pk_bf16_f32 v82, v92, v93
    v_mfma_f32_16x16x32_bf16 v[116:119], v[204:207], v[176:179], v[116:119]
    v_accvgpr_write_b32 a17, v81
    v_exp_f32 v96, v96
    v_exp_f32 v97, v97
    v_cvt_pk_bf16_f32 v83, v94, v95
    global_load_dwordx4 v[248:251], v41, s[34:35]
    v_mfma_f32_16x16x32_bf16 v[104:107], v[208:211], v[164:167], v[104:107]
    v_accvgpr_write_b32 a18, v82
    v_exp_f32 v98, v98
    v_exp_f32 v99, v99
    v_cvt_pk_bf16_f32 v84, v96, v97
    v_mfma_f32_16x16x32_bf16 v[112:115], v[208:211], v[180:183], v[112:115]
    v_accvgpr_write_b32 a19, v83
    v_exp_f32 v100, v100
    v_exp_f32 v101, v101
    v_cvt_pk_bf16_f32 v85, v98, v99
    v_mfma_f32_16x16x32_bf16 v[108:111], v[212:215], v[164:167], v[108:111]
    v_accvgpr_write_b32 a20, v84
    v_exp_f32 v102, v102
    v_exp_f32 v103, v103
    v_cvt_pk_bf16_f32 v86, v100, v101
    v_mfma_f32_16x16x32_bf16 v[116:119], v[212:215], v[180:183], v[116:119]
    v_accvgpr_write_b32 a21, v85
    v_cvt_pk_bf16_f32 v87, v102, v103
    v_accvgpr_write_b32 a22, v86
    v_accvgpr_write_b32 a23, v87
    v_mfma_f32_16x16x32_bf16 v[88:91], a[64:67], v[152:155], 0
    v_mfma_f32_16x16x32_bf16 v[96:99], a[64:67], v[168:171], 0
    s_barrier
    ds_read_b128 v[216:219], v22 offset:32768
    ds_read_b128 v[220:223], v22 offset:36864
    v_mfma_f32_16x16x32_bf16 v[92:95], a[68:71], v[152:155], 0
    ds_read_b128 v[224:227], v23 offset:32768
    v_fma_f32 v104, v104, s60, v44
    v_fma_f32 v105, v105, s60, v44
    v_fma_f32 v106, v106, s60, v44
    v_fma_f32 v107, v107, s60, v44
    v_max_f32 v42, v104, v105
    s_waitcnt vmcnt(7)
    s_add_u32 m0, s14, 16384
    s_xor_b32 s65, s13, 32768
    buffer_load_dwordx4 v18, s[28:31], s65 offen offset:0 nt lds
    v_mfma_f32_16x16x32_bf16 v[100:103], a[68:71], v[168:171], 0
    ds_read_b128 v[228:231], v23 offset:36864
    v_fma_f32 v108, v108, s60, v44
    v_fma_f32 v109, v109, s60, v44
    v_max3_f32 v42, v42, v106, v107
    v_fma_f32 v110, v110, s60, v44
    v_mfma_f32_16x16x32_bf16 v[88:91], a[72:75], v[156:159], v[88:91]
    ds_read_b128 v[232:235], v24 offset:32768
    v_fma_f32 v111, v111, s60, v44
    v_max3_f32 v42, v42, v108, v109
    v_fma_f32 v112, v112, s60, v45
    v_fma_f32 v113, v113, s60, v45
    v_mfma_f32_16x16x32_bf16 v[96:99], a[72:75], v[172:175], v[96:99]
    ds_read_b128 v[236:239], v24 offset:36864
    v_max3_f32 v42, v42, v110, v111
    v_fma_f32 v114, v114, s60, v45
    v_fma_f32 v115, v115, s60, v45
    v_max3_f32 v42, v42, v112, v113
    v_mfma_f32_16x16x32_bf16 v[92:95], a[76:79], v[156:159], v[92:95]
    ds_read_b128 v[240:243], v25 offset:32768
    v_fma_f32 v116, v116, s60, v45
    v_fma_f32 v117, v117, s60, v45
    v_max3_f32 v42, v42, v114, v115
    v_fma_f32 v118, v118, s60, v45
    s_waitcnt vmcnt(7)
    buffer_load_dwordx4 v19, s[28:31], s65 offen offset:1024 nt lds
    v_mfma_f32_16x16x32_bf16 v[100:103], a[76:79], v[172:175], v[100:103]
    ds_read_b128 v[244:247], v25 offset:36864
    v_fma_f32 v119, v119, s60, v45
    v_max3_f32 v42, v42, v116, v117
    v_max3_f32 v42, v42, v118, v119
    v_cmp_lt_f32 vcc, 0x41000000, v42
    s_nop 0
    s_cbranch_vccnz L_rare_3
L_back_3:
    v_mfma_f32_16x16x32_bf16 v[88:91], a[80:83], v[160:163], v[88:91]
    v_exp_f32 v104, v104
    v_exp_f32 v105, v105
    v_exp_f32 v106, v106
    v_exp_f32 v107, v107
    v_mfma_f32_16x16x32_bf16 v[96:99], a[80:83], v[176:179], v[96:99]
    v_cvt_pk_bf16_f32 v80, v104, v105
    v_exp_f32 v108, v108
    v_exp_f32 v109, v109
    v_cvt_pk_bf16_f32 v81, v106, v107
    v_mfma_f32_16x16x32_bf16 v[92:95], a[84:87], v[160:163], v[92:95]
    v_accvgpr_write_b32 a24, v80
    v_exp_f32 v110, v110
    v_exp_f32 v111, v111
    v_cvt_pk_bf16_f32 v82, v108, v109
    v_mfma_f32_16x16x32_bf16 v[100:103], a[84:87], v[176:179], v[100:103]
    v_accvgpr_write_b32 a25, v81
    v_exp_f32 v112, v112
    v_exp_f32 v113, v113
    v_cvt_pk_bf16_f32 v83, v110, v111
    s_waitcnt vmcnt(7)
    buffer_load_dwordx4 v20, s[28:31], s65 offen offset:2048 nt lds
    v_mfma_f32_16x16x32_bf16 v[88:91], a[88:91], v[164:167], v[88:91]
    v_accvgpr_write_b32 a26, v82
    v_exp_f32 v114, v114
    v_exp_f32 v115, v115
    v_cvt_pk_bf16_f32 v84, v112, v113
    v_mfma_f32_16x16x32_bf16 v[96:99], a[88:91], v[180:183], v[96:99]
    v_accvgpr_write_b32 a27, v83
    v_exp_f32 v116, v116
    v_exp_f32 v117, v117
    v_cvt_pk_bf16_f32 v85, v114, v115
    v_mfma_f32_16x16x32_bf16 v[92:95], a[92:95], v[164:167], v[92:95]
    v_accvgpr_write_b32 a28, v84
    v_exp_f32 v118, v118
    v_exp_f32 v119, v119
    v_cvt_pk_bf16_f32 v86, v116, v117
    v_mfma_f32_16x16x32_bf16 v[100:103], a[92:95], v[180:183], v[100:103]
    v_accvgpr_write_b32 a29, v85
    v_cvt_pk_bf16_f32 v87, v118, v119
    v_accvgpr_write_b32 a30, v86
    v_accvgpr_write_b32 a31, v87
    s_waitcnt lgkmcnt(0)
    v_mfma_f32_16x16x32_bf16 v[104:107], v[216:219], v[152:155], 0
    v_mfma_f32_16x16x32_bf16 v[112:115], v[216:219], v[168:171], 0
    s_barrier
    v_mfma_f32_16x16x32_bf16 v[108:111], v[220:223], v[152:155], 0
    v_fma_f32 v88, v88, s60, v44
    v_fma_f32 v89, v89, s60, v44
    v_fma_f32 v90, v90, s60, v44
    v_fma_f32 v91, v91, s60, v44
    v_max_f32 v42, v88, v89
    s_waitcnt vmcnt(7)
    buffer_load_dwordx4 v21, s[28:31], s65 offen offset:3072 nt lds
    v_mfma_f32_16x16x32_bf16 v[116:119], v[220:223], v[168:171], 0
    v_fma_f32 v92, v92, s60, v44
    v_fma_f32 v93, v93, s60, v44
    v_max3_f32 v42, v42, v90, v91
    v_fma_f32 v94, v94, s60, v44
    v_mfma_f32_16x16x32_bf16 v[104:107], v[224:227], v[156:159], v[104:107]
    v_fma_f32 v95, v95, s60, v44
    v_max3_f32 v42, v42, v92, v93
    v_fma_f32 v96, v96, s60, v45
    v_fma_f32 v97, v97, s60, v45
    v_mfma_f32_16x16x32_bf16 v[112:115], v[224:227], v[172:175], v[112:115]
    v_max3_f32 v42, v42, v94, v95
    v_fma_f32 v98, v98, s60, v45
    v_fma_f32 v99, v99, s60, v45
    v_max3_f32 v42, v42, v96, v97
    v_mfma_f32_16x16x32_bf16 v[108:111], v[228:231], v[156:159], v[108:111]
    v_fma_f32 v100, v100, s60, v45
    v_fma_f32 v101, v101, s60, v45
    v_max3_f32 v42, v42, v98, v99
    v_fma_f32 v102, v102, s60, v45
    v_mfma_f32_16x16x32_bf16 v[116:119], v[228:231], v[172:175], v[116:119]
    v_fma_f32 v103, v103, s60, v45
    v_max3_f32 v42, v42, v100, v101
    v_max3_f32 v42, v42, v102, v103
    v_cmp_lt_f32 vcc, 0x41000000, v42
    s_nop 0
    s_cbranch_vccnz L_rare_4
L_back_4:
    v_mfma_f32_16x16x32_bf16 v[104:107], v[232:235], v[160:163], v[104:107]
    v_exp_f32 v88, v88
    v_exp_f32 v89, v89
    v_exp_f32 v90, v90
    v_exp_f32 v91, v91
    v_mfma_f32_16x16x32_bf16 v[112:115], v[232:235], v[176:179], v[112:115]
    v_cvt_pk_bf16_f32 v80, v88, v89
    v_exp_f32 v92, v92
    v_exp_f32 v93, v93
    v_cvt_pk_bf16_f32 v81, v90, v91
    s_waitcnt vmcnt(7)
    s_add_u32 m0, s14, 32768
    s_xor_b32 s65, s13, 49152
    buffer_load_dwordx4 v18, s[28:31], s65 offen offset:0 nt lds
    v_mfma_f32_16x16x32_bf16 v[108:111], v[236:239], v[160:163], v[108:111]
    v_accvgpr_write_b32 a32, v80
    v_exp_f32 v94, v94
    v_exp_f32 v95, v95
    v_cvt_pk_bf16_f32 v82, v92, v93
    v_mfma_f32_16x16x32_bf16 v[116:119], v[236:239], v[176:179], v[116:119]
    v_accvgpr_write_b32 a33, v81
    v_exp_f32 v96, v96
    v_exp_f32 v97, v97
    v_cvt_pk_bf16_f32 v83, v94, v95
    v_mfma_f32_16x16x32_bf16 v[104:107], v[240:243], v[164:167], v[104:107]
    v_accvgpr_write_b32 a34, v82
    v_exp_f32 v98, v98
    v_exp_f32 v99, v99
    v_cvt_pk_bf16_f32 v84, v96, v97
    v_mfma_f32_16x16x32_bf16 v[112:115], v[240:243], v[180:183], v[112:115]
    v_accvgpr_write_b32 a35, v83
    v_exp_f32 v100, v100
    v_exp_f32 v101, v101
    v_cvt_pk_bf16_f32 v85, v98, v99
    v_mfma_f32_16x16x32_bf16 v[108:111], v[244:247], v[164:167], v[108:111]
    v_accvgpr_write_b32 a36, v84
    v_exp_f32 v102, v102
    v_exp_f32 v103, v103
    v_cvt_pk_bf16_f32 v86, v100, v101
    v_mfma_f32_16x16x32_bf16 v[116:119], v[244:247], v[180:183], v[116:119]
    v_accvgpr_write_b32 a37, v85
    v_cvt_pk_bf16_f32 v87, v102, v103
    v_accvgpr_write_b32 a38, v86
    v_accvgpr_write_b32 a39, v87
    v_mfma_f32_16x16x32_bf16 v[88:91], a[96:99], v[152:155], 0
    v_mfma_f32_16x16x32_bf16 v[96:99], a[96:99], v[168:171], 0
    s_barrier
    ds_read_b128 v[184:187], v22 offset:49152
    ds_read_b128 v[188:191], v22 offset:53248
    v_mfma_f32_16x16x32_bf16 v[92:95], a[100:103], v[152:155], 0
    ds_read_b128 v[192:195], v23 offset:49152
    v_fma_f32 v104, v104, s60, v44
    v_fma_f32 v105, v105, s60, v44
    v_fma_f32 v106, v106, s60, v44
    v_fma_f32 v107, v107, s60, v44
    v_max_f32 v42, v104, v105
    s_waitcnt vmcnt(7)
    buffer_load_dwordx4 v19, s[28:31], s65 offen offset:1024 nt lds
    v_mfma_f32_16x16x32_bf16 v[100:103], a[100:103], v[168:171], 0
    ds_read_b128 v[196:199], v23 offset:53248
    v_fma_f32 v108, v108, s60, v44
    v_fma_f32 v109, v109, s60, v44
    v_max3_f32 v42, v42, v106, v107
    v_fma_f32 v110, v110, s60, v44
    v_mfma_f32_16x16x32_bf16 v[88:91], a[104:107], v[156:159], v[88:91]
    ds_read_b128 v[200:203], v24 offset:49152
    v_fma_f32 v111, v111, s60, v44
    v_max3_f32 v42, v42, v108, v109
    v_fma_f32 v112, v112, s60, v45
    v_fma_f32 v113, v113, s60, v45
    v_mfma_f32_16x16x32_bf16 v[96:99], a[104:107], v[172:175], v[96:99]
    ds_read_b128 v[204:207], v24 offset:53248
    v_max3_f32 v42, v42, v110, v111
    v_fma_f32 v114, v114, s60, v45
    v_fma_f32 v115, v115, s60, v45
    v_max3_f32 v42, v42, v112, v113
    v_mfma_f32_16x16x32_bf16 v[92:95], a[108:111], v[156:159], v[92:95]
    ds_read_b128 v[208:211], v25 offset:49152
    v_fma_f32 v116, v116, s60, v45
    v_fma_f32 v117, v117, s60, v45
    v_max3_f32 v42, v42, v114, v115
    v_fma_f32 v118, v118, s60, v45
    v_mfma_f32_16x16x32_bf16 v[100:103], a[108:111], v[172:175], v[100:103]
    ds_read_b128 v[212:215], v25 offset:53248
    v_fma_f32 v119, v119, s60, v45
    v_max3_f32 v42, v42, v116, v117
    v_max3_f32 v42, v42, v118, v119
    v_cmp_lt_f32 vcc, 0x41000000, v42
    s_nop 0
    s_cbranch_vccnz L_rare_5
L_back_5:
    v_mfma_f32_16x16x32_bf16 v[88:91], a[112:115], v[160:163], v[88:91]
    v_exp_f32 v104, v104
    v_exp_f32 v105, v105
    v_exp_f32 v106, v106
    v_exp_f32 v107, v107
    v_mfma_f32_16x16x32_bf16 v[96:99], a[112:115], v[176:179], v[96:99]
    v_cvt_pk_bf16_f32 v80, v104, v105
    v_exp_f32 v108, v108
    v_exp_f32 v109, v109
    v_cvt_pk_bf16_f32 v81, v106, v107
    s_waitcnt vmcnt(7)
    buffer_load_dwordx4 v20, s[28:31], s65 offen offset:2048 nt lds
    v_mfma_f32_16x16x32_bf16 v[92:95], a[116:119], v[160:163], v[92:95]
    v_accvgpr_write_b32 a40, v80
    v_exp_f32 v110, v110
    v_exp_f32 v111, v111
    v_cvt_pk_bf16_f32 v82, v108, v109
    v_mfma_f32_16x16x32_bf16 v[100:103], a[116:119], v[176:179], v[100:103]
    v_accvgpr_write_b32 a41, v81
    v_exp_f32 v112, v112
    v_exp_f32 v113, v113
    v_cvt_pk_bf16_f32 v83, v110, v111
    v_mfma_f32_16x16x32_bf16 v[88:91], a[120:123], v[164:167], v[88:91]
    v_accvgpr_write_b32 a42, v82
    v_exp_f32 v114, v114
    v_exp_f32 v115, v115
    v_cvt_pk_bf16_f32 v84, v112, v113
    v_mfma_f32_16x16x32_bf16 v[96:99], a[120:123], v[180:183], v[96:99]
    v_accvgpr_write_b32 a43, v83
    v_exp_f32 v116, v116
    v_exp_f32 v117, v117
    v_cvt_pk_bf16_f32 v85, v114, v115
    v_mfma_f32_16x16x32_bf16 v[92:95], a[124:127], v[164:167], v[92:95]
    v_accvgpr_write_b32 a44, v84
    v_exp_f32 v118, v118
    v_exp_f32 v119, v119
    v_cvt_pk_bf16_f32 v86, v116, v117
    v_mfma_f32_16x16x32_bf16 v[100:103], a[124:127], v[180:183], v[100:103]
    v_accvgpr_write_b32 a45, v85
    v_cvt_pk_bf16_f32 v87, v118, v119
    v_accvgpr_write_b32 a46, v86
    v_accvgpr_write_b32 a47, v87
    s_waitcnt lgkmcnt(0)
    v_mfma_f32_16x16x32_bf16 v[104:107], v[184:187], v[152:155], 0
    v_mfma_f32_16x16x32_bf16 v[112:115], v[184:187], v[168:171], 0
    s_barrier
    v_mfma_f32_16x16x32_bf16 v[108:111], v[188:191], v[152:155], 0
    v_fma_f32 v88, v88, s60, v44
    v_fma_f32 v89, v89, s60, v44
    v_fma_f32 v90, v90, s60, v44
    v_fma_f32 v91, v91, s60, v44
    v_max_f32 v42, v88, v89
    s_waitcnt vmcnt(7)
    buffer_load_dwordx4 v21, s[28:31], s65 offen offset:3072 nt lds
    v_mfma_f32_16x16x32_bf16 v[116:119], v[188:191], v[168:171], 0
    v_fma_f32 v92, v92, s60, v44
    v_fma_f32 v93, v93, s60, v44
    v_max3_f32 v42, v42, v90, v91
    v_fma_f32 v94, v94, s60, v44
    v_mfma_f32_16x16x32_bf16 v[104:107], v[192:195], v[156:159], v[104:107]
    v_fma_f32 v95, v95, s60, v44
    v_max3_f32 v42, v42, v92, v93
    v_fma_f32 v96, v96, s60, v45
    v_fma_f32 v97, v97, s60, v45
    v_mfma_f32_16x16x32_bf16 v[112:115], v[192:195], v[172:175], v[112:115]
    v_max3_f32 v42, v42, v94, v95
    v_fma_f32 v98, v98, s60, v45
    v_fma_f32 v99, v99, s60, v45
    v_max3_f32 v42, v42, v96, v97
    v_mfma_f32_16x16x32_bf16 v[108:111], v[196:199], v[156:159], v[108:111]
    v_fma_f32 v100, v100, s60, v45
    v_fma_f32 v101, v101, s60, v45
    v_max3_f32 v42, v42, v98, v99
    v_fma_f32 v102, v102, s60, v45
    v_mfma_f32_16x16x32_bf16 v[116:119], v[196:199], v[172:175], v[116:119]
    v_fma_f32 v103, v103, s60, v45
    v_max3_f32 v42, v42, v100, v101
    v_max3_f32 v42, v42, v102, v103
    v_cmp_lt_f32 vcc, 0x41000000, v42
    s_nop 0
    s_cbranch_vccnz L_rare_6
L_back_6:
    v_mfma_f32_16x16x32_bf16 v[104:107], v[200:203], v[160:163], v[104:107]
    v_exp_f32 v88, v88
    v_exp_f32 v89, v89
    v_exp_f32 v90, v90
    v_exp_f32 v91, v91
    v_mfma_f32_16x16x32_bf16 v[112:115], v[200:203], v[176:179], v[112:115]
    v_cvt_pk_bf16_f32 v80, v88, v89
    v_exp_f32 v92, v92
    v_exp_f32 v93, v93
    v_cvt_pk_bf16_f32 v81, v90, v91
    s_waitcnt vmcnt(7)
    s_add_u32 m0, s14, 49152
    s_xor_b32 s65, s13, 65536
    buffer_load_dwordx4 v18, s[28:31], s65 offen offset:0 nt lds
    v_mfma_f32_16x16x32_bf16 v[108:111], v[204:207], v[160:163], v[108:111]
    v_accvgpr_write_b32 a48, v80
    v_exp_f32 v94, v94
    v_exp_f32 v95, v95
    v_cvt_pk_bf16_f32 v82, v92, v93
    v_mfma_f32_16x16x32_bf16 v[116:119], v[204:207], v[176:179], v[116:119]
    v_accvgpr_write_b32 a49, v81
    v_exp_f32 v96, v96
    v_exp_f32 v97, v97
    v_cvt_pk_bf16_f32 v83, v94, v95
    v_mfma_f32_16x16x32_bf16 v[104:107], v[208:211], v[164:167], v[104:107]
    v_accvgpr_write_b32 a50, v82
    v_exp_f32 v98, v98
    v_exp_f32 v99, v99
    v_cvt_pk_bf16_f32 v84, v96, v97
    v_mfma_f32_16x16x32_bf16 v[112:115], v[208:211], v[180:183], v[112:115]
    v_accvgpr_write_b32 a51, v83
    v_exp_f32 v100, v100
    v_exp_f32 v101, v101
    v_cvt_pk_bf16_f32 v85, v98, v99
    v_mfma_f32_16x16x32_bf16 v[108:111], v[212:215], v[164:167], v[108:111]
    v_accvgpr_write_b32 a52, v84
    v_exp_f32 v102, v102
    v_exp_f32 v103, v103
    v_cvt_pk_bf16_f32 v86, v100, v101
    v_mfma_f32_16x16x32_bf16 v[116:119], v[212:215], v[180:183], v[116:119]
    v_accvgpr_write_b32 a53, v85
    v_cvt_pk_bf16_f32 v87, v102, v103
    v_accvgpr_write_b32 a54, v86
    v_accvgpr_write_b32 a55, v87
    v_mfma_f32_16x16x32_bf16 v[88:91], a[128:131], v[152:155], 0
    v_mfma_f32_16x16x32_bf16 v[96:99], a[128:131], v[168:171], 0
    s_barrier
    ds_read_b128 v[216:219], v22 offset:0
    ds_read_b128 v[220:223], v22 offset:4096
    v_mfma_f32_16x16x32_bf16 v[92:95], a[132:135], v[152:155], 0
    ds_read_b128 v[224:227], v23 offset:0
    v_fma_f32 v104, v104, s60, v44
    v_fma_f32 v105, v105, s60, v44
    v_fma_f32 v106, v106, s60, v44
    v_fma_f32 v107, v107, s60, v44
    v_max_f32 v42, v104, v105
    s_waitcnt vmcnt(7)
    buffer_load_dwordx4 v19, s[28:31], s65 offen offset:1024 nt lds
    v_mfma_f32_16x16x32_bf16 v[100:103], a[132:135], v[168:171], 0
    ds_read_b128 v[228:231], v23 offset:4096
    v_fma_f32 v108, v108, s60, v44
    v_fma_f32 v109, v109, s60, v44
    v_max3_f32 v42, v42, v106, v107
    v_fma_f32 v110, v110, s60, v44
    v_mfma_f32_16x16x32_bf16 v[88:91], a[136:139], v[156:159], v[88:91]
    ds_read_b128 v[232:235], v24 offset:0
    v_fma_f32 v111, v111, s60, v44
    v_max3_f32 v42, v42, v108, v109
    v_fma_f32 v112, v112, s60, v45
    v_fma_f32 v113, v113, s60, v45
    v_mfma_f32_16x16x32_bf16 v[96:99], a[136:139], v[172:175], v[96:99]
    ds_read_b128 v[236:239], v24 offset:4096
    v_max3_f32 v42, v42, v110, v111
    v_fma_f32 v114, v114, s60, v45
    v_fma_f32 v115, v115, s60, v45
    v_max3_f32 v42, v42, v112, v113
    v_mfma_f32_16x16x32_bf16 v[92:95], a[140:143], v[156:159], v[92:95]
    ds_read_b128 v[240:243], v25 offset:0
    v_fma_f32 v116, v116, s60, v45
    v_fma_f32 v117, v117, s60, v45
    v_max3_f32 v42, v42, v114, v115
    v_fma_f32 v118, v118, s60, v45
    s_waitcnt vmcnt(7)
    buffer_load_dwordx4 v20, s[28:31], s65 offen offset:2048 nt lds
    v_mfma_f32_16x16x32_bf16 v[100:103], a[140:143], v[172:175], v[100:103]
    ds_read_b128 v[244:247], v25 offset:4096
    v_fma_f32 v119, v119, s60, v45
    v_max3_f32 v42, v42, v116, v117
    v_max3_f32 v42, v42, v118, v119
    v_cmp_lt_f32 vcc, 0x41000000, v42
    s_nop 0
    s_cbranch_vccnz L_rare_7
L_back_7:
    v_mfma_f32_16x16x32_bf16 v[88:91], a[144:147], v[160:163], v[88:91]
    v_exp_f32 v104, v104
    v_exp_f32 v105, v105
    v_exp_f32 v106, v106
    v_exp_f32 v107, v107
    v_mfma_f32_16x16x32_bf16 v[96:99], a[144:147], v[176:179], v[96:99]
    v_cvt_pk_bf16_f32 v80, v104, v105
    v_exp_f32 v108, v108
    v_exp_f32 v109, v109
    v_cvt_pk_bf16_f32 v81, v106, v107
    v_mfma_f32_16x16x32_bf16 v[92:95], a[148:151], v[160:163], v[92:95]
    v_accvgpr_write_b32 a56, v80
    v_exp_f32 v110, v110
    v_exp_f32 v111, v111
    v_cvt_pk_bf16_f32 v82, v108, v109
    v_mfma_f32_16x16x32_bf16 v[100:103], a[148:151], v[176:179], v[100:103]
    v_accvgpr_write_b32 a57, v81
    v_exp_f32 v112, v112
    v_exp_f32 v113, v113
    v_cvt_pk_bf16_f32 v83, v110, v111
    s_waitcnt vmcnt(7)
    buffer_load_dwordx4 v21, s[28:31], s65 offen offset:3072 nt lds
    v_mfma_f32_16x16x32_bf16 v[88:91], a[152:155], v[164:167], v[88:91]
    v_accvgpr_write_b32 a58, v82
    v_exp_f32 v114, v114
    v_exp_f32 v115, v115
    v_cvt_pk_bf16_f32 v84, v112, v113
    v_mfma_f32_16x16x32_bf16 v[96:99], a[152:155], v[180:183], v[96:99]
    v_accvgpr_write_b32 a59, v83
    v_exp_f32 v116, v116
    v_exp_f32 v117, v117
    v_cvt_pk_bf16_f32 v85, v114, v115
    v_mfma_f32_16x16x32_bf16 v[92:95], a[156:159], v[164:167], v[92:95]
    v_accvgpr_write_b32 a60, v84
    v_exp_f32 v118, v118
    v_exp_f32 v119, v119
    v_cvt_pk_bf16_f32 v86, v116, v117
    v_mfma_f32_16x16x32_bf16 v[100:103], a[156:159], v[180:183], v[100:103]
    v_accvgpr_write_b32 a61, v85
    v_cvt_pk_bf16_f32 v87, v118, v119
    v_accvgpr_write_b32 a62, v86
    v_accvgpr_write_b32 a63, v87
    s_waitcnt lgkmcnt(0)
    v_mfma_f32_16x16x32_bf16 v[104:107], v[216:219], v[152:155], 0
    v_mfma_f32_16x16x32_bf16 v[112:115], v[216:219], v[168:171], 0
    s_barrier
    v_mfma_f32_16x16x32_bf16 v[108:111], v[220:223], v[152:155], 0
    v_fma_f32 v88, v88, s60, v44
    v_fma_f32 v89, v89, s60, v44
    v_fma_f32 v90, v90, s60, v44
    v_fma_f32 v91, v91, s60, v44
    v_max_f32 v42, v88, v89
    s_waitcnt vmcnt(7)
    s_add_u32 m0, s14, 0
    s_xor_b32 s65, s13, 81920
    buffer_load_dwordx4 v18, s[28:31], s65 offen offset:0 nt lds
    v_mfma_f32_16x16x32_bf16 v[116:119], v[220:223], v[168:171], 0
    v_fma_f32 v92, v92, s60, v44
    v_fma_f32 v93, v93, s60, v44
    v_max3_f32 v42, v42, v90, v91
    v_fma_f32 v94, v94, s60, v44
    v_mfma_f32_16x16x32_bf16 v[104:107], v[224:227], v[156:159], v[104:107]
    v_fma_f32 v95, v95, s60, v44
    v_max3_f32 v42, v42, v92, v93
    v_fma_f32 v96, v96, s60, v45
    v_fma_f32 v97, v97, s60, v45
    v_mfma_f32_16x16x32_bf16 v[112:115], v[224:227], v[172:175], v[112:115]
    v_max3_f32 v42, v42, v94, v95
    v_fma_f32 v98, v98, s60, v45
    v_fma_f32 v99, v99, s60, v45
    v_max3_f32 v42, v42, v96, v97
    v_mfma_f32_16x16x32_bf16 v[108:111], v[228:231], v[156:159], v[108:111]
    v_fma_f32 v100, v100, s60, v45
    v_fma_f32 v101, v101, s60, v45
    v_max3_f32 v42, v42, v98, v99
    v_fma_f32 v102, v102, s60, v45
    v_mfma_f32_16x16x32_bf16 v[116:119], v[228:231], v[172:175], v[116:119]
    v_fma_f32 v103, v103, s60, v45
    v_max3_f32 v42, v42, v100, v101
    v_max3_f32 v42, v42, v102, v103
    v_cmp_lt_f32 vcc, 0x41000000, v42
    s_nop 0
    s_cbranch_vccnz L_rare_8
L_back_8:
    v_mfma_f32_16x16x32_bf16 v[104:107], v[232:235], v[160:163], v[104:107]
    v_exp_f32 v88, v88
    v_exp_f32 v89, v89
    v_exp_f32 v90, v90
    v_exp_f32 v91, v91
    v_mfma_f32_16x16x32_bf16 v[112:115], v[232:235], v[176:179], v[112:115]
    v_cvt_pk_bf16_f32 v80, v88, v89
    v_exp_f32 v92, v92
    v_exp_f32 v93, v93
    v_cvt_pk_bf16_f32 v81, v90, v91
    s_waitcnt vmcnt(7)
    buffer_load_dwordx4 v19, s[28:31], s65 offen offset:1024 nt lds
    v_mfma_f32_16x16x32_bf16 v[108:111], v[236:239], v[160:163], v[108:111]
    v_accvgpr_write_b32 a64, v80
    v_exp_f32 v94, v94
    v_exp_f32 v95, v95
    v_cvt_pk_bf16_f32 v82, v92, v93
    v_mfma_f32_16x16x32_bf16 v[116:119], v[236:239], v[176:179], v[116:119]
    v_accvgpr_write_b32 a65, v81
    v_exp_f32 v96, v96
    v_exp_f32 v97, v97
    v_cvt_pk_bf16_f32 v83, v94, v95
    v_mfma_f32_16x16x32_bf16 v[104:107], v[240:243], v[164:167], v[104:107]
    v_accvgpr_write_b32 a66, v82
    v_exp_f32 v98, v98
    v_exp_f32 v99, v99
    v_cvt_pk_bf16_f32 v84, v96, v97
    v_mfma_f32_16x16x32_bf16 v[112:115], v[240:243], v[180:183], v[112:115]
    v_accvgpr_write_b32 a67, v83
    v_exp_f32 v100, v100
    v_exp_f32 v101, v101
    v_cvt_pk_bf16_f32 v85, v98, v99
    v_mfma_f32_16x16x32_bf16 v[108:111], v[244:247], v[164:167], v[108:111]
    v_accvgpr_write_b32 a68, v84
    v_exp_f32 v102, v102
    v_exp_f32 v103, v103
    v_cvt_pk_bf16_f32 v86, v100, v101
    v_mfma_f32_16x16x32_bf16 v[116:119], v[244:247], v[180:183], v[116:119]
    v_accvgpr_write_b32 a69, v85
    v_cvt_pk_bf16_f32 v87, v102, v103
    v_accvgpr_write_b32 a70, v86
    v_accvgpr_write_b32 a71, v87
    v_mfma_f32_16x16x32_bf16 v[88:91], a[160:163], v[152:155], 0
    v_mfma_f32_16x16x32_bf16 v[96:99], a[160:163], v[168:171], 0
    s_barrier
    v_add_u32 v22, 0x14000, v22
    v_add_u32 v23, 0x14000, v23
    v_add_u32 v24, 0x14000, v24
    v_add_u32 v25, 0x14000, v25
    ds_read_b128 v[184:187], v22 offset:0
    ds_read_b128 v[188:191], v22 offset:4096
    v_mfma_f32_16x16x32_bf16 v[92:95], a[164:167], v[152:155], 0
    ds_read_b128 v[192:195], v23 offset:0
    v_fma_f32 v104, v104, s60, v44
    v_fma_f32 v105, v105, s60, v44
    v_fma_f32 v106, v106, s60, v44
    v_fma_f32 v107, v107, s60, v44
    v_max_f32 v42, v104, v105
    s_waitcnt vmcnt(7)
    buffer_load_dwordx4 v20, s[28:31], s65 offen offset:2048 nt lds
    v_mfma_f32_16x16x32_bf16 v[100:103], a[164:167], v[168:171], 0
    ds_read_b128 v[196:199], v23 offset:4096
    v_fma_f32 v108, v108, s60, v44
    v_fma_f32 v109, v109, s60, v44
    v_max3_f32 v42, v42, v106, v107
    v_fma_f32 v110, v110, s60, v44
    v_mfma_f32_16x16x32_bf16 v[88:91], a[168:171], v[156:159], v[88:91]
    ds_read_b128 v[200:203], v24 offset:0
    v_fma_f32 v111, v111, s60, v44
    v_max3_f32 v42, v42, v108, v109
    v_fma_f32 v112, v112, s60, v45
    v_fma_f32 v113, v113, s60, v45
    v_mfma_f32_16x16x32_bf16 v[96:99], a[168:171], v[172:175], v[96:99]
    ds_read_b128 v[204:207], v24 offset:4096
    v_max3_f32 v42, v42, v110, v111
    v_fma_f32 v114, v114, s60, v45
    v_fma_f32 v115, v115, s60, v45
    v_max3_f32 v42, v42, v112, v113
    v_mfma_f32_16x16x32_bf16 v[92:95], a[172:175], v[156:159], v[92:95]
    ds_read_b128 v[208:211], v25 offset:0
    v_fma_f32 v116, v116, s60, v45
    v_fma_f32 v117, v117, s60, v45
    v_max3_f32 v42, v42, v114, v115
    v_fma_f32 v118, v118, s60, v45
    v_mfma_f32_16x16x32_bf16 v[100:103], a[172:175], v[172:175], v[100:103]
    ds_read_b128 v[212:215], v25 offset:4096
    v_fma_f32 v119, v119, s60, v45
    v_max3_f32 v42, v42, v116, v117
    v_max3_f32 v42, v42, v118, v119
    v_cmp_lt_f32 vcc, 0x41000000, v42
    s_nop 0
    s_cbranch_vccnz L_rare_9
L_back_9:
    v_mfma_f32_16x16x32_bf16 v[88:91], a[176:179], v[160:163], v[88:91]
    v_exp_f32 v104, v104
    v_exp_f32 v105, v105
    v_exp_f32 v106, v106
    v_exp_f32 v107, v107
    v_mfma_f32_16x16x32_bf16 v[96:99], a[176:179], v[176:179], v[96:99]
    v_cvt_pk_bf16_f32 v80, v104, v105
    v_exp_f32 v108, v108
    v_exp_f32 v109, v109
    v_cvt_pk_bf16_f32 v81, v106, v107
    s_waitcnt vmcnt(7)
    buffer_load_dwordx4 v21, s[28:31], s65 offen offset:3072 nt lds
    v_mfma_f32_16x16x32_bf16 v[92:95], a[180:183], v[160:163], v[92:95]
    v_accvgpr_write_b32 a72, v80
    v_exp_f32 v110, v110
    v_exp_f32 v111, v111
    v_cvt_pk_bf16_f32 v82, v108, v109
    v_mfma_f32_16x16x32_bf16 v[100:103], a[180:183], v[176:179], v[100:103]
    v_accvgpr_write_b32 a73, v81
    v_exp_f32 v112, v112
    v_exp_f32 v113, v113
    v_cvt_pk_bf16_f32 v83, v110, v111
    v_mfma_f32_16x16x32_bf16 v[88:91], a[184:187], v[164:167], v[88:91]
    v_accvgpr_write_b32 a74, v82
    v_exp_f32 v114, v114
    v_exp_f32 v115, v115
    v_cvt_pk_bf16_f32 v84, v112, v113
    v_mfma_f32_16x16x32_bf16 v[96:99], a[184:187], v[180:183], v[96:99]
    v_accvgpr_write_b32 a75, v83
    v_exp_f32 v116, v116
    v_exp_f32 v117, v117
    v_cvt_pk_bf16_f32 v85, v114, v115
    v_mfma_f32_16x16x32_bf16 v[92:95], a[188:191], v[164:167], v[92:95]
    v_accvgpr_write_b32 a76, v84
    v_exp_f32 v118, v118
    v_exp_f32 v119, v119
    v_cvt_pk_bf16_f32 v86, v116, v117
    v_mfma_f32_16x16x32_bf16 v[100:103], a[188:191], v[180:183], v[100:103]
    v_accvgpr_write_b32 a77, v85
    v_cvt_pk_bf16_f32 v87, v118, v119
    v_accvgpr_write_b32 a78, v86
    v_accvgpr_write_b32 a79, v87
    s_waitcnt lgkmcnt(0)
    v_mfma_f32_16x16x32_bf16 v[104:107], v[184:187], v[152:155], 0
    v_mfma_f32_16x16x32_bf16 v[112:115], v[184:187], v[168:171], 0
    s_barrier
    v_mfma_f32_16x16x32_bf16 v[108:111], v[188:191], v[152:155], 0
    v_fma_f32 v88, v88, s60, v44
    v_fma_f32 v89, v89, s60, v44
    v_fma_f32 v90, v90, s60, v44
    v_fma_f32 v91, v91, s60, v44
    v_max_f32 v42, v88, v89
    s_waitcnt vmcnt(7)
    s_add_u32 m0, s14, 81920
    s_xor_b32 s65, s13, 98304
    buffer_load_dwordx4 v18, s[28:31], s65 offen offset:0 nt lds
    v_mfma_f32_16x16x32_bf16 v[116:119], v[188:191], v[168:171], 0
    v_fma_f32 v92, v92, s60, v44
    v_fma_f32 v93, v93, s60, v44
    v_max3_f32 v42, v42, v90, v91
    v_fma_f32 v94, v94, s60, v44
    v_mfma_f32_16x16x32_bf16 v[104:107], v[192:195], v[156:159], v[104:107]
    v_fma_f32 v95, v95, s60, v44
    v_max3_f32 v42, v42, v92, v93
    v_fma_f32 v96, v96, s60, v45
    v_fma_f32 v97, v97, s60, v45
    v_mfma_f32_16x16x32_bf16 v[112:115], v[192:195], v[172:175], v[112:115]
    v_max3_f32 v42, v42, v94, v95
    v_fma_f32 v98, v98, s60, v45
    v_fma_f32 v99, v99, s60, v45
    v_max3_f32 v42, v42, v96, v97
    v_mfma_f32_16x16x32_bf16 v[108:111], v[196:199], v[156:159], v[108:111]
    v_fma_f32 v100, v100, s60, v45
    v_fma_f32 v101, v101, s60, v45
    v_max3_f32 v42, v42, v98, v99
    v_fma_f32 v102, v102, s60, v45
    v_mfma_f32_16x16x32_bf16 v[116:119], v[196:199], v[172:175], v[116:119]
    v_fma_f32 v103, v103, s60, v45
    v_max3_f32 v42, v42, v100, v101
    v_max3_f32 v42, v42, v102, v103
    v_cmp_lt_f32 vcc, 0x41000000, v42
    s_nop 0
    s_cbranch_vccnz L_rare_10
L_back_10:
    v_mfma_f32_16x16x32_bf16 v[104:107], v[200:203], v[160:163], v[104:107]
    v_exp_f32 v88, v88
    v_exp_f32 v89, v89
    v_exp_f32 v90, v90
    v_exp_f32 v91, v91
    v_mfma_f32_16x16x32_bf16 v[112:115], v[200:203], v[176:179], v[112:115]
    v_cvt_pk_bf16_f32 v80, v88, v89
    v_exp_f32 v92, v92
    v_exp_f32 v93, v93
    v_cvt_pk_bf16_f32 v81, v90, v91
    s_waitcnt vmcnt(7)
    buffer_load_dwordx4 v19, s[28:31], s65 offen offset:1024 nt lds
    v_mfma_f32_16x16x32_bf16 v[108:111], v[204:207], v[160:163], v[108:111]
    v_accvgpr_write_b32 a80, v80
    v_exp_f32 v94, v94
    v_exp_f32 v95, v95
    v_cvt_pk_bf16_f32 v82, v92, v93
    v_mfma_f32_16x16x32_bf16 v[116:119], v[204:207], v[176:179], v[116:119]
    v_accvgpr_write_b32 a81, v81
    v_exp_f32 v96, v96
    v_exp_f32 v97, v97
    v_cvt_pk_bf16_f32 v83, v94, v95
    v_mfma_f32_16x16x32_bf16 v[104:107], v[208:211], v[164:167], v[104:107]
    v_accvgpr_write_b32 a82, v82
    v_exp_f32 v98, v98
    v_exp_f32 v99, v99
    v_cvt_pk_bf16_f32 v84, v96, v97
    v_mfma_f32_16x16x32_bf16 v[112:115], v[208:211], v[180:183], v[112:115]
    v_accvgpr_write_b32 a83, v83
    v_exp_f32 v100, v100
    v_exp_f32 v101, v101
    v_cvt_pk_bf16_f32 v85, v98, v99
    v_mfma_f32_16x16x32_bf16 v[108:111], v[212:215], v[164:167], v[108:111]
    v_accvgpr_write_b32 a84, v84
    v_exp_f32 v102, v102
    v_exp_f32 v103, v103
    v_cvt_pk_bf16_f32 v86, v100, v101
    v_mfma_f32_16x16x32_bf16 v[116:119], v[212:215], v[180:183], v[116:119]
    v_accvgpr_write_b32 a85, v85
    v_cvt_pk_bf16_f32 v87, v102, v103
    v_accvgpr_write_b32 a86, v86
    v_accvgpr_write_b32 a87, v87
    v_mfma_f32_16x16x32_bf16 v[88:91], a[192:195], v[152:155], 0
    v_mfma_f32_16x16x32_bf16 v[96:99], a[192:195], v[168:171], 0
    s_barrier
    ds_read_b128 v[216:219], v22 offset:49152
    ds_read_b128 v[220:223], v22 offset:53248
    v_mfma_f32_16x16x32_bf16 v[92:95], a[196:199], v[152:155], 0
    ds_read_b128 v[224:227], v23 offset:49152
    v_fma_f32 v104, v104, s60, v44
    v_fma_f32 v105, v105, s60, v44
    v_fma_f32 v106, v106, s60, v44
    v_fma_f32 v107, v107, s60, v44
    v_max_f32 v42, v104, v105
    s_waitcnt vmcnt(7)
    buffer_load_dwordx4 v20, s[28:31], s65 offen offset:2048 nt lds
    v_mfma_f32_16x16x32_bf16 v[100:103], a[196:199], v[168:171], 0
    ds_read_b128 v[228:231], v23 offset:53248
    v_fma_f32 v108, v108, s60, v44
    v_fma_f32 v109, v109, s60, v44
    v_max3_f32 v42, v42, v106, v107
    v_fma_f32 v110, v110, s60, v44
    v_mfma_f32_16x16x32_bf16 v[88:91], a[200:203], v[156:159], v[88:91]
    ds_read_b128 v[232:235], v24 offset:49152
    v_fma_f32 v111, v111, s60, v44
    v_max3_f32 v42, v42, v108, v109
    v_fma_f32 v112, v112, s60, v45
    v_fma_f32 v113, v113, s60, v45
    v_mfma_f32_16x16x32_bf16 v[96:99], a[200:203], v[172:175], v[96:99]
    ds_read_b128 v[236:239], v24 offset:53248
    v_max3_f32 v42, v42, v110, v111
    v_fma_f32 v114, v114, s60, v45
    v_fma_f32 v115, v115, s60, v45
    v_max3_f32 v42, v42, v112, v113
    v_mfma_f32_16x16x32_bf16 v[92:95], a[204:207], v[156:159], v[92:95]
    ds_read_b128 v[240:243], v25 offset:49152
    v_fma_f32 v116, v116, s60, v45
    v_fma_f32 v117, v117, s60, v45
    v_max3_f32 v42, v42, v114, v115
    v_fma_f32 v118, v118, s60, v45
    v_mfma_f32_16x16x32_bf16 v[100:103], a[204:207], v[172:175], v[100:103]
    ds_read_b128 v[244:247], v25 offset:53248
    v_fma_f32 v119, v119, s60, v45
    v_max3_f32 v42, v42, v116, v117
    v_max3_f32 v42, v42, v118, v119
    v_cmp_lt_f32 vcc, 0x41000000, v42
    s_nop 0
    s_cbranch_vccnz L_rare_11
L_back_11:
    v_mfma_f32_16x16x32_bf16 v[88:91], a[208:211], v[160:163], v[88:91]
    v_exp_f32 v104, v104
    v_exp_f32 v105, v105
    v_exp_f32 v106, v106
    v_exp_f32 v107, v107
    v_mfma_f32_16x16x32_bf16 v[96:99], a[208:211], v[176:179], v[96:99]
    v_cvt_pk_bf16_f32 v80, v104, v105
    v_exp_f32 v108, v108
    v_exp_f32 v109, v109
    v_cvt_pk_bf16_f32 v81, v106, v107
    s_waitcnt vmcnt(7)
    buffer_load_dwordx4 v21, s[28:31], s65 offen offset:3072 nt lds
    v_mfma_f32_16x16x32_bf16 v[92:95], a[212:215], v[160:163], v[92:95]
    v_accvgpr_write_b32 a88, v80
    v_exp_f32 v110, v110
    v_exp_f32 v111, v111
    v_cvt_pk_bf16_f32 v82, v108, v109
    v_mfma_f32_16x16x32_bf16 v[100:103], a[212:215], v[176:179], v[100:103]
    v_accvgpr_write_b32 a89, v81
    v_exp_f32 v112, v112
    v_exp_f32 v113, v113
    v_cvt_pk_bf16_f32 v83, v110, v111
    v_mfma_f32_16x16x32_bf16 v[88:91], a[216:219], v[164:167], v[88:91]
    v_accvgpr_write_b32 a90, v82
    v_exp_f32 v114, v114
    v_exp_f32 v115, v115
    v_cvt_pk_bf16_f32 v84, v112, v113
    v_mfma_f32_16x16x32_bf16 v[96:99], a[216:219], v[180:183], v[96:99]
    v_accvgpr_write_b32 a91, v83
    v_exp_f32 v116, v116
    v_exp_f32 v117, v117
    v_cvt_pk_bf16_f32 v85, v114, v115
    v_mfma_f32_16x16x32_bf16 v[92:95], a[220:223], v[164:167], v[92:95]
    v_accvgpr_write_b32 a92, v84
    v_exp_f32 v118, v118
    v_exp_f32 v119, v119
    v_cvt_pk_bf16_f32 v86, v116, v117
    v_mfma_f32_16x16x32_bf16 v[100:103], a[220:223], v[180:183], v[100:103]
    v_accvgpr_write_b32 a93, v85
    v_cvt_pk_bf16_f32 v87, v118, v119
    v_accvgpr_write_b32 a94, v86
    v_accvgpr_write_b32 a95, v87
    s_waitcnt lgkmcnt(0)
    v_mfma_f32_16x16x32_bf16 v[104:107], v[216:219], v[152:155], 0
    v_mfma_f32_16x16x32_bf16 v[112:115], v[216:219], v[168:171], 0
    s_barrier
    v_mfma_f32_16x16x32_bf16 v[108:111], v[220:223], v[152:155], 0
    v_fma_f32 v88, v88, s60, v44
    v_fma_f32 v89, v89, s60, v44
    v_fma_f32 v90, v90, s60, v44
    v_fma_f32 v91, v91, s60, v44
    v_max_f32 v42, v88, v89
    s_waitcnt vmcnt(7)
    s_add_u32 m0, s14, 131072
    s_xor_b32 s65, s13, 114688
    buffer_load_dwordx4 v18, s[28:31], s65 offen offset:0 nt lds
    v_mfma_f32_16x16x32_bf16 v[116:119], v[220:223], v[168:171], 0
    v_fma_f32 v92, v92, s60, v44
    v_fma_f32 v93, v93, s60, v44
    v_max3_f32 v42, v42, v90, v91
    v_fma_f32 v94, v94, s60, v44
    v_mfma_f32_16x16x32_bf16 v[104:107], v[224:227], v[156:159], v[104:107]
    v_fma_f32 v95, v95, s60, v44
    v_max3_f32 v42, v42, v92, v93
    v_fma_f32 v96, v96, s60, v45
    v_fma_f32 v97, v97, s60, v45
    v_mfma_f32_16x16x32_bf16 v[112:115], v[224:227], v[172:175], v[112:115]
    v_max3_f32 v42, v42, v94, v95
    v_fma_f32 v98, v98, s60, v45
    v_fma_f32 v99, v99, s60, v45
    v_max3_f32 v42, v42, v96, v97
    v_mfma_f32_16x16x32_bf16 v[108:111], v[228:231], v[156:159], v[108:111]
    v_fma_f32 v100, v100, s60, v45
    v_fma_f32 v101, v101, s60, v45
    v_max3_f32 v42, v42, v98, v99
    v_fma_f32 v102, v102, s60, v45
    s_waitcnt vmcnt(7)
    buffer_load_dwordx4 v19, s[28:31], s65 offen offset:1024 nt lds
    v_mfma_f32_16x16x32_bf16 v[116:119], v[228:231], v[172:175], v[116:119]
    v_fma_f32 v103, v103, s60, v45
    v_max3_f32 v42, v42, v100, v101
    v_max3_f32 v42, v42, v102, v103
    v_cmp_lt_f32 vcc, 0x41000000, v42
    s_nop 0
    s_cbranch_vccnz L_rare_12
L_back_12:
    v_mfma_f32_16x16x32_bf16 v[104:107], v[232:235], v[160:163], v[104:107]
    v_exp_f32 v88, v88
    v_exp_f32 v89, v89
    v_exp_f32 v90, v90
    v_exp_f32 v91, v91
    v_mfma_f32_16x16x32_bf16 v[112:115], v[232:235], v[176:179], v[112:115]
    v_cvt_pk_bf16_f32 v80, v88, v89
    v_exp_f32 v92, v92
    v_exp_f32 v93, v93
    v_cvt_pk_bf16_f32 v81, v90, v91
    v_mfma_f32_16x16x32_bf16 v[108:111], v[236:239], v[160:163], v[108:111]
    v_accvgpr_write_b32 a96, v80
    v_exp_f32 v94, v94
    v_exp_f32 v95, v95
    v_cvt_pk_bf16_f32 v82, v92, v93
    v_mfma_f32_16x16x32_bf16 v[116:119], v[236:239], v[176:179], v[116:119]
    v_accvgpr_write_b32 a97, v81
    v_exp_f32 v96, v96
    v_exp_f32 v97, v97
    v_cvt_pk_bf16_f32 v83, v94, v95
    s_waitcnt vmcnt(7)
    buffer_load_dwordx4 v20, s[28:31], s65 offen offset:2048 nt lds
    v_mfma_f32_16x16x32_bf16 v[104:107], v[240:243], v[164:167], v[104:107]
    v_accvgpr_write_b32 a98, v82
    v_exp_f32 v98, v98
    v_exp_f32 v99, v99
    v_cvt_pk_bf16_f32 v84, v96, v97
    v_mfma_f32_16x16x32_bf16 v[112:115], v[240:243], v[180:183], v[112:115]
    v_accvgpr_write_b32 a99, v83
    v_exp_f32 v100, v100
    v_exp_f32 v101, v101
    v_cvt_pk_bf16_f32 v85, v98, v99
    v_mfma_f32_16x16x32_bf16 v[108:111], v[244:247], v[164:167], v[108:111]
    v_accvgpr_write_b32 a100, v84
    v_exp_f32 v102, v102
    v_exp_f32 v103, v103
    v_cvt_pk_bf16_f32 v86, v100, v101
    v_mfma_f32_16x16x32_bf16 v[116:119], v[244:247], v[180:183], v[116:119]
    v_accvgpr_write_b32 a101, v85
    v_cvt_pk_bf16_f32 v87, v102, v103
    v_accvgpr_write_b32 a102, v86
    v_accvgpr_write_b32 a103, v87
    v_mfma_f32_16x16x32_bf16 v[88:91], a[224:227], v[152:155], 0
    v_mfma_f32_16x16x32_bf16 v[96:99], a[224:227], v[168:171], 0
    s_barrier
    ds_read_b128 v[184:187], v22 offset:16384
    ds_read_b128 v[188:191], v22 offset:20480
    v_mfma_f32_16x16x32_bf16 v[92:95], a[228:231], v[152:155], 0
    ds_read_b128 v[192:195], v23 offset:16384
    v_fma_f32 v104, v104, s60, v44
    v_fma_f32 v105, v105, s60, v44
    v_fma_f32 v106, v106, s60, v44
    v_fma_f32 v107, v107, s60, v44
    v_max_f32 v42, v104, v105
    s_waitcnt vmcnt(7)
    buffer_load_dwordx4 v21, s[28:31], s65 offen offset:3072 nt lds
    v_mfma_f32_16x16x32_bf16 v[100:103], a[228:231], v[168:171], 0
    ds_read_b128 v[196:199], v23 offset:20480
    v_fma_f32 v108, v108, s60, v44
    v_fma_f32 v109, v109, s60, v44
    v_max3_f32 v42, v42, v106, v107
    v_fma_f32 v110, v110, s60, v44
    v_mfma_f32_16x16x32_bf16 v[88:91], a[232:235], v[156:159], v[88:91]
    ds_read_b128 v[200:203], v24 offset:16384
    v_fma_f32 v111, v111, s60, v44
    v_max3_f32 v42, v42, v108, v109
    v_fma_f32 v112, v112, s60, v45
    v_fma_f32 v113, v113, s60, v45
    v_mfma_f32_16x16x32_bf16 v[96:99], a[232:235], v[172:175], v[96:99]
    ds_read_b128 v[204:207], v24 offset:20480
    v_max3_f32 v42, v42, v110, v111
    v_fma_f32 v114, v114, s60, v45
    v_fma_f32 v115, v115, s60, v45
    v_max3_f32 v42, v42, v112, v113
    v_mfma_f32_16x16x32_bf16 v[92:95], a[236:239], v[156:159], v[92:95]
    ds_read_b128 v[208:211], v25 offset:16384
    v_fma_f32 v116, v116, s60, v45
    v_fma_f32 v117, v117, s60, v45
    v_max3_f32 v42, v42, v114, v115
    v_fma_f32 v118, v118, s60, v45
    v_mfma_f32_16x16x32_bf16 v[100:103], a[236:239], v[172:175], v[100:103]
    ds_read_b128 v[212:215], v25 offset:20480
    v_fma_f32 v119, v119, s60, v45
    v_max3_f32 v42, v42, v116, v117
    v_max3_f32 v42, v42, v118, v119
    v_cmp_lt_f32 vcc, 0x41000000, v42
    s_nop 0
    s_cbranch_vccnz L_rare_13
L_back_13:
    v_mfma_f32_16x16x32_bf16 v[88:91], a[240:243], v[160:163], v[88:91]
    v_exp_f32 v104, v104
    v_exp_f32 v105, v105
    v_exp_f32 v106, v106
    v_exp_f32 v107, v107
    v_mfma_f32_16x16x32_bf16 v[96:99], a[240:243], v[176:179], v[96:99]
    v_cvt_pk_bf16_f32 v80, v104, v105
    v_exp_f32 v108, v108
    v_exp_f32 v109, v109
    v_cvt_pk_bf16_f32 v81, v106, v107
    s_waitcnt vmcnt(7)
    s_add_u32 m0, s14, 147456
    s_xor_b32 s65, s13, 128
    buffer_load_dwordx4 v18, s[28:31], s65 offen offset:0 nt lds
    v_mfma_f32_16x16x32_bf16 v[92:95], a[244:247], v[160:163], v[92:95]
    v_accvgpr_write_b32 a104, v80
    v_exp_f32 v110, v110
    v_exp_f32 v111, v111
    v_cvt_pk_bf16_f32 v82, v108, v109
    v_mfma_f32_16x16x32_bf16 v[100:103], a[244:247], v[176:179], v[100:103]
    v_accvgpr_write_b32 a105, v81
    v_exp_f32 v112, v112
    v_exp_f32 v113, v113
    v_cvt_pk_bf16_f32 v83, v110, v111
    v_mfma_f32_16x16x32_bf16 v[88:91], a[248:251], v[164:167], v[88:91]
    v_accvgpr_write_b32 a106, v82
    v_exp_f32 v114, v114
    v_exp_f32 v115, v115
    v_cvt_pk_bf16_f32 v84, v112, v113
    v_mfma_f32_16x16x32_bf16 v[96:99], a[248:251], v[180:183], v[96:99]
    v_accvgpr_write_b32 a107, v83
    v_exp_f32 v116, v116
    v_exp_f32 v117, v117
    v_cvt_pk_bf16_f32 v85, v114, v115
    v_mfma_f32_16x16x32_bf16 v[92:95], a[252:255], v[164:167], v[92:95]
    v_accvgpr_write_b32 a108, v84
    v_exp_f32 v118, v118
    v_exp_f32 v119, v119
    v_cvt_pk_bf16_f32 v86, v116, v117
    v_mfma_f32_16x16x32_bf16 v[100:103], a[252:255], v[180:183], v[100:103]
    v_accvgpr_write_b32 a109, v85
    v_cvt_pk_bf16_f32 v87, v118, v119
    v_accvgpr_write_b32 a110, v86
    v_accvgpr_write_b32 a111, v87
    s_waitcnt lgkmcnt(0)
    v_mfma_f32_16x16x32_bf16 v[104:107], v[184:187], v[152:155], 0
    v_mfma_f32_16x16x32_bf16 v[112:115], v[184:187], v[168:171], 0
    s_barrier
    v_mfma_f32_16x16x32_bf16 v[108:111], v[188:191], v[152:155], 0
    v_fma_f32 v88, v88, s60, v44
    v_fma_f32 v89, v89, s60, v44
    v_fma_f32 v90, v90, s60, v44
    v_fma_f32 v91, v91, s60, v44
    v_max_f32 v42, v88, v89
    s_waitcnt vmcnt(7)
    buffer_load_dwordx4 v19, s[28:31], s65 offen offset:1024 nt lds
    v_mfma_f32_16x16x32_bf16 v[116:119], v[188:191], v[168:171], 0
    v_fma_f32 v92, v92, s60, v44
    v_fma_f32 v93, v93, s60, v44
    v_max3_f32 v42, v42, v90, v91
    v_fma_f32 v94, v94, s60, v44
    v_mfma_f32_16x16x32_bf16 v[104:107], v[192:195], v[156:159], v[104:107]
    v_fma_f32 v95, v95, s60, v44
    v_max3_f32 v42, v42, v92, v93
    v_fma_f32 v96, v96, s60, v45
    v_fma_f32 v97, v97, s60, v45
    v_mfma_f32_16x16x32_bf16 v[112:115], v[192:195], v[172:175], v[112:115]
    v_max3_f32 v42, v42, v94, v95
    v_fma_f32 v98, v98, s60, v45
    v_fma_f32 v99, v99, s60, v45
    v_max3_f32 v42, v42, v96, v97
    v_mfma_f32_16x16x32_bf16 v[108:111], v[196:199], v[156:159], v[108:111]
    v_fma_f32 v100, v100, s60, v45
    v_fma_f32 v101, v101, s60, v45
    v_max3_f32 v42, v42, v98, v99
    v_fma_f32 v102, v102, s60, v45
    v_mfma_f32_16x16x32_bf16 v[116:119], v[196:199], v[172:175], v[116:119]
    v_fma_f32 v103, v103, s60, v45
    v_max3_f32 v42, v42, v100, v101
    v_max3_f32 v42, v42, v102, v103
    v_cmp_lt_f32 vcc, 0x41000000, v42
    s_nop 0
    s_cbranch_vccnz L_rare_14
L_back_14:
    v_mfma_f32_16x16x32_bf16 v[104:107], v[200:203], v[160:163], v[104:107]
    v_exp_f32 v88, v88
    v_exp_f32 v89, v89
    v_exp_f32 v90, v90
    v_exp_f32 v91, v91
    v_mfma_f32_16x16x32_bf16 v[112:115], v[200:203], v[176:179], v[112:115]
    v_cvt_pk_bf16_f32 v80, v88, v89
    v_exp_f32 v92, v92
    v_exp_f32 v93, v93
    v_cvt_pk_bf16_f32 v81, v90, v91
    s_waitcnt vmcnt(7)
    buffer_load_dwordx4 v20, s[28:31], s65 offen offset:2048 nt lds
    v_mfma_f32_16x16x32_bf16 v[108:111], v[204:207], v[160:163], v[108:111]
    v_accvgpr_write_b32 a112, v80
    v_exp_f32 v94, v94
    v_exp_f32 v95, v95
    v_cvt_pk_bf16_f32 v82, v92, v93
    v_mfma_f32_16x16x32_bf16 v[116:119], v[204:207], v[176:179], v[116:119]
    v_accvgpr_write_b32 a113, v81
    v_exp_f32 v96, v96
    v_exp_f32 v97, v97
    v_cvt_pk_bf16_f32 v83, v94, v95
    v_mfma_f32_16x16x32_bf16 v[104:107], v[208:211], v[164:167], v[104:107]
    v_accvgpr_write_b32 a114, v82
    v_exp_f32 v98, v98
    v_exp_f32 v99, v99
    v_cvt_pk_bf16_f32 v84, v96, v97
    v_mfma_f32_16x16x32_bf16 v[112:115], v[208:211], v[180:183], v[112:115]
    v_accvgpr_write_b32 a115, v83
    v_exp_f32 v100, v100
    v_exp_f32 v101, v101
    v_cvt_pk_bf16_f32 v85, v98, v99
    v_mfma_f32_16x16x32_bf16 v[108:111], v[212:215], v[164:167], v[108:111]
    v_accvgpr_write_b32 a116, v84
    v_exp_f32 v102, v102
    v_exp_f32 v103, v103
    v_cvt_pk_bf16_f32 v86, v100, v101
    v_mfma_f32_16x16x32_bf16 v[116:119], v[212:215], v[180:183], v[116:119]
    v_accvgpr_write_b32 a117, v85
    v_cvt_pk_bf16_f32 v87, v102, v103
    v_accvgpr_write_b32 a118, v86
    v_accvgpr_write_b32 a119, v87
    v_mov_b32 v72, 0x3f803f80
    v_mov_b32 v73, 0x3f803f80
    v_mov_b32 v74, 0x3f803f80
    v_mov_b32 v75, 0x3f803f80
    s_lshl_b32 s59, s66, 1
    s_lshl_b32 s59, s59, 17
    s_lshl_b32 s66, s68, 1
    s_lshl_b32 s56, s66, 12
    v_fma_f32 v104, v104, s60, v44
    v_fma_f32 v105, v105, s60, v44
    v_fma_f32 v106, v106, s60, v44
    v_fma_f32 v107, v107, s60, v44
    v_max_f32 v42, v104, v105
    v_fma_f32 v108, v108, s60, v44
    v_fma_f32 v109, v109, s60, v44
    v_max3_f32 v42, v42, v106, v107
    v_fma_f32 v110, v110, s60, v44
    v_fma_f32 v111, v111, s60, v44
    v_max3_f32 v42, v42, v108, v109
    v_fma_f32 v112, v112, s60, v45
    v_fma_f32 v113, v113, s60, v45
    v_max3_f32 v42, v42, v110, v111
    v_fma_f32 v114, v114, s60, v45
    v_fma_f32 v115, v115, s60, v45
    v_max3_f32 v42, v42, v112, v113
    v_fma_f32 v116, v116, s60, v45
    v_fma_f32 v117, v117, s60, v45
    v_max3_f32 v42, v42, v114, v115
    v_fma_f32 v118, v118, s60, v45
    v_fma_f32 v119, v119, s60, v45
    v_max3_f32 v42, v42, v116, v117
    v_max3_f32 v42, v42, v118, v119
    v_cmp_lt_f32 vcc, 0x41000000, v42
    s_nop 0
    s_cbranch_vccnz L_rare_15
L_back_15:
    v_exp_f32 v104, v104
    v_exp_f32 v105, v105
    v_exp_f32 v106, v106
    v_exp_f32 v107, v107
    v_cvt_pk_bf16_f32 v80, v104, v105
    v_exp_f32 v108, v108
    v_exp_f32 v109, v109
    v_cvt_pk_bf16_f32 v81, v106, v107
    v_accvgpr_write_b32 a120, v80
    v_exp_f32 v110, v110
    v_exp_f32 v111, v111
    v_cvt_pk_bf16_f32 v82, v108, v109
    v_accvgpr_write_b32 a121, v81
    v_exp_f32 v112, v112
    v_exp_f32 v113, v113
    v_cvt_pk_bf16_f32 v83, v110, v111
    v_accvgpr_write_b32 a122, v82
    v_exp_f32 v114, v114
    v_exp_f32 v115, v115
    v_cvt_pk_bf16_f32 v84, v112, v113
    v_accvgpr_write_b32 a123, v83
    v_exp_f32 v116, v116
    v_exp_f32 v117, v117
    v_cvt_pk_bf16_f32 v85, v114, v115
    v_accvgpr_write_b32 a124, v84
    v_exp_f32 v118, v118
    v_exp_f32 v119, v119
    v_cvt_pk_bf16_f32 v86, v116, v117
    v_accvgpr_write_b32 a125, v85
    v_cvt_pk_bf16_f32 v87, v118, v119
    v_accvgpr_write_b32 a126, v86
    v_accvgpr_write_b32 a127, v87
    s_barrier
    v_add_u32 v26, 0x10000, v26
    v_add_u32 v27, 0x10000, v27
    v_add_u32 v28, 0x10000, v28
    v_add_u32 v29, 0x10000, v29
    ds_read_b64_tr_b16 v[184:185], v26 offset:0
    ds_read_b64_tr_b16 v[186:187], v26 offset:2048
    ds_read_b64_tr_b16 v[188:189], v27 offset:0
    ds_read_b64_tr_b16 v[190:191], v27 offset:2048
    ds_read_b64_tr_b16 v[192:193], v28 offset:0
    ds_read_b64_tr_b16 v[194:195], v28 offset:2048
    ds_read_b64_tr_b16 v[196:197], v29 offset:0
    ds_read_b64_tr_b16 v[198:199], v29 offset:2048
    v_add_u32 v2, 0x10000, v32
    v_add_u32 v3, 0x10000, v33
    v_add_u32 v4, 0x10000, v34
    v_add_u32 v5, 0x10000, v35
    v_add_u32 v10, 0x10000, v30
    v_add_u32 v11, 0x10000, v31
    v_add_u32 v6, 0x18000, v32
    v_add_u32 v7, 0x18000, v33
    v_mfma_f32_16x16x32_bf16 v[48:51], v[72:75], a[0:3], 0
    ds_read_b64_tr_b16 v[200:201], v26 offset:4096
    ds_read_b64_tr_b16 v[202:203], v26 offset:6144
    s_lshr_b32 s61, s67, 1
    s_lshl_b32 s61, s61, 5
    v_mov_b32 v42, 0
    buffer_load_dword v42, v42, s[92:95], s61 offen sc1
    v_add_u32 v8, 0x18000, v34
    v_mfma_f32_16x16x32_bf16 v[52:55], v[72:75], a[4:7], 0
    ds_read_b64_tr_b16 v[204:205], v27 offset:4096
    v_mfma_f32_16x16x32_bf16 v[48:51], v[72:75], a[8:11], v[48:51]
    ds_read_b64_tr_b16 v[206:207], v27 offset:6144
    v_mfma_f32_16x16x32_bf16 v[52:55], v[72:75], a[12:15], v[52:55]
    ds_read_b64_tr_b16 v[208:209], v28 offset:4096
    ds_read_b64_tr_b16 v[210:211], v28 offset:6144
    s_waitcnt lgkmcnt(12)
    v_mfma_f32_16x16x32_bf16 v[88:91], v[184:187], a[0:3], 0
    ds_read_b64_tr_b16 v[212:213], v29 offset:4096
    v_mfma_f32_16x16x32_bf16 v[92:95], v[184:187], a[4:7], 0
    ds_read_b64_tr_b16 v[214:215], v29 offset:6144
    s_waitcnt vmcnt(7)
    buffer_load_dwordx4 v21, s[28:31], s65 offen offset:3072 nt lds
    v_add_u32 v9, 0x18000, v35
    s_waitcnt lgkmcnt(12)
    v_mfma_f32_16x16x32_bf16 v[96:99], v[188:191], a[0:3], 0
    v_mfma_f32_16x16x32_bf16 v[100:103], v[188:191], a[4:7], 0
    s_waitcnt lgkmcnt(10)
    v_mfma_f32_16x16x32_bf16 v[104:107], v[192:195], a[0:3], 0
    v_mfma_f32_16x16x32_bf16 v[108:111], v[192:195], a[4:7], 0
    s_waitcnt lgkmcnt(8)
    v_mfma_f32_16x16x32_bf16 v[112:115], v[196:199], a[0:3], 0
    s_waitcnt vmcnt(7)
    s_add_u32 m0, s14, 98304
    s_xor_b32 s65, s13, 16512
    buffer_load_dwordx4 v18, s[28:31], s65 offen offset:0 nt lds
    v_add_u32 v12, 0x18000, v30
    v_mfma_f32_16x16x32_bf16 v[116:119], v[196:199], a[4:7], 0
    s_waitcnt lgkmcnt(6)
    v_mfma_f32_16x16x32_bf16 v[88:91], v[200:203], a[8:11], v[88:91]
    v_mfma_f32_16x16x32_bf16 v[92:95], v[200:203], a[12:15], v[92:95]
    s_waitcnt lgkmcnt(4)
    v_mfma_f32_16x16x32_bf16 v[96:99], v[204:207], a[8:11], v[96:99]
    v_mfma_f32_16x16x32_bf16 v[100:103], v[204:207], a[12:15], v[100:103]
    s_waitcnt vmcnt(7)
    buffer_load_dwordx4 v19, s[28:31], s65 offen offset:1024 nt lds
    v_add_u32 v13, 0x18000, v31
    s_waitcnt lgkmcnt(2)
    v_mfma_f32_16x16x32_bf16 v[104:107], v[208:211], a[8:11], v[104:107]
    v_mfma_f32_16x16x32_bf16 v[108:111], v[208:211], a[12:15], v[108:111]
    s_waitcnt lgkmcnt(0)
    v_mfma_f32_16x16x32_bf16 v[112:115], v[212:215], a[8:11], v[112:115]
    v_mfma_f32_16x16x32_bf16 v[116:119], v[212:215], a[12:15], v[116:119]
    s_barrier
    ds_read_b64_tr_b16 v[184:185], v26 offset:49152
    ds_read_b64_tr_b16 v[186:187], v26 offset:51200
    ds_read_b64_tr_b16 v[188:189], v27 offset:49152
    ds_read_b64_tr_b16 v[190:191], v27 offset:51200
    ds_read_b64_tr_b16 v[192:193], v28 offset:49152
    ds_read_b64_tr_b16 v[194:195], v28 offset:51200
    ds_read_b64_tr_b16 v[196:197], v29 offset:49152
    ds_read_b64_tr_b16 v[198:199], v29 offset:51200
    v_mfma_f32_16x16x32_bf16 v[48:51], v[72:75], a[16:19], v[48:51]
    ds_read_b64_tr_b16 v[200:201], v26 offset:53248
    ds_read_b64_tr_b16 v[202:203], v26 offset:55296
    s_waitcnt vmcnt(7)
    buffer_load_dwordx4 v20, s[28:31], s65 offen offset:2048 nt lds
    v_mfma_f32_16x16x32_bf16 v[52:55], v[72:75], a[20:23], v[52:55]
    ds_read_b64_tr_b16 v[204:205], v27 offset:53248
    v_mfma_f32_16x16x32_bf16 v[48:51], v[72:75], a[24:27], v[48:51]
    ds_read_b64_tr_b16 v[206:207], v27 offset:55296
    v_mfma_f32_16x16x32_bf16 v[52:55], v[72:75], a[28:31], v[52:55]
    ds_read_b64_tr_b16 v[208:209], v28 offset:53248
    ds_read_b64_tr_b16 v[210:211], v28 offset:55296
    s_waitcnt lgkmcnt(12)
    v_mfma_f32_16x16x32_bf16 v[88:91], v[184:187], a[16:19], v[88:91]
    ds_read_b64_tr_b16 v[212:213], v29 offset:53248
    v_mfma_f32_16x16x32_bf16 v[92:95], v[184:187], a[20:23], v[92:95]
    ds_read_b64_tr_b16 v[214:215], v29 offset:55296
    s_waitcnt lgkmcnt(12)
    v_mfma_f32_16x16x32_bf16 v[96:99], v[188:191], a[16:19], v[96:99]
    v_mfma_f32_16x16x32_bf16 v[100:103], v[188:191], a[20:23], v[100:103]
    s_waitcnt lgkmcnt(10)
    v_mfma_f32_16x16x32_bf16 v[104:107], v[192:195], a[16:19], v[104:107]
    v_mfma_f32_16x16x32_bf16 v[108:111], v[192:195], a[20:23], v[108:111]
    s_waitcnt lgkmcnt(8)
    v_mfma_f32_16x16x32_bf16 v[112:115], v[196:199], a[16:19], v[112:115]
    s_waitcnt vmcnt(7)
    buffer_load_dwordx4 v21, s[28:31], s65 offen offset:3072 nt lds
    v_mfma_f32_16x16x32_bf16 v[116:119], v[196:199], a[20:23], v[116:119]
    s_waitcnt lgkmcnt(6)
    v_mfma_f32_16x16x32_bf16 v[88:91], v[200:203], a[24:27], v[88:91]
    v_mfma_f32_16x16x32_bf16 v[92:95], v[200:203], a[28:31], v[92:95]
    s_waitcnt lgkmcnt(4)
    v_mfma_f32_16x16x32_bf16 v[96:99], v[204:207], a[24:27], v[96:99]
    v_mfma_f32_16x16x32_bf16 v[100:103], v[204:207], a[28:31], v[100:103]
    s_waitcnt lgkmcnt(2)
    v_mfma_f32_16x16x32_bf16 v[104:107], v[208:211], a[24:27], v[104:107]
    v_mfma_f32_16x16x32_bf16 v[108:111], v[208:211], a[28:31], v[108:111]
    s_waitcnt lgkmcnt(0)
    v_mfma_f32_16x16x32_bf16 v[112:115], v[212:215], a[24:27], v[112:115]
    v_mfma_f32_16x16x32_bf16 v[116:119], v[212:215], a[28:31], v[116:119]
    s_barrier
    v_subrev_u32 v26, 0xc000, v26
    v_subrev_u32 v27, 0xc000, v27
    v_subrev_u32 v28, 0xc000, v28
    v_subrev_u32 v29, 0xc000, v29
    ds_read_b64_tr_b16 v[184:185], v26 offset:0
    ds_read_b64_tr_b16 v[186:187], v26 offset:2048
    ds_read_b64_tr_b16 v[188:189], v27 offset:0
    ds_read_b64_tr_b16 v[190:191], v27 offset:2048
    ds_read_b64_tr_b16 v[192:193], v28 offset:0
    ds_read_b64_tr_b16 v[194:195], v28 offset:2048
    ds_read_b64_tr_b16 v[196:197], v29 offset:0
    ds_read_b64_tr_b16 v[198:199], v29 offset:2048
    v_mfma_f32_16x16x32_bf16 v[48:51], v[72:75], a[32:35], v[48:51]
    ds_read_b64_tr_b16 v[200:201], v26 offset:4096
    ds_read_b64_tr_b16 v[202:203], v26 offset:6144
    s_waitcnt vmcnt(7)
    s_add_u32 m0, s14, 65536
    s_xor_b32 s65, s13, 32896
    buffer_load_dwordx4 v18, s[28:31], s65 offen offset:0 nt lds
    v_mfma_f32_16x16x32_bf16 v[52:55], v[72:75], a[36:39], v[52:55]
    ds_read_b64_tr_b16 v[204:205], v27 offset:4096
    v_mfma_f32_16x16x32_bf16 v[48:51], v[72:75], a[40:43], v[48:51]
    ds_read_b64_tr_b16 v[206:207], v27 offset:6144
    v_mfma_f32_16x16x32_bf16 v[52:55], v[72:75], a[44:47], v[52:55]
    ds_read_b64_tr_b16 v[208:209], v28 offset:4096
    ds_read_b64_tr_b16 v[210:211], v28 offset:6144
    s_waitcnt lgkmcnt(12)
    v_mfma_f32_16x16x32_bf16 v[88:91], v[184:187], a[32:35], v[88:91]
    ds_read_b64_tr_b16 v[212:213], v29 offset:4096
    v_mfma_f32_16x16x32_bf16 v[92:95], v[184:187], a[36:39], v[92:95]
    ds_read_b64_tr_b16 v[214:215], v29 offset:6144
    s_waitcnt vmcnt(7)
    buffer_load_dwordx4 v19, s[28:31], s65 offen offset:1024 nt lds
    s_waitcnt lgkmcnt(12)
    v_mfma_f32_16x16x32_bf16 v[96:99], v[188:191], a[32:35], v[96:99]
    v_mfma_f32_16x16x32_bf16 v[100:103], v[188:191], a[36:39], v[100:103]
    s_waitcnt lgkmcnt(10)
    v_mfma_f32_16x16x32_bf16 v[104:107], v[192:195], a[32:35], v[104:107]
    v_mfma_f32_16x16x32_bf16 v[108:111], v[192:195], a[36:39], v[108:111]
    s_waitcnt lgkmcnt(8)
    v_mfma_f32_16x16x32_bf16 v[112:115], v[196:199], a[32:35], v[112:115]
    s_waitcnt vmcnt(7)
    buffer_load_dwordx4 v20, s[28:31], s65 offen offset:2048 nt lds
    v_mfma_f32_16x16x32_bf16 v[116:119], v[196:199], a[36:39], v[116:119]
    s_waitcnt lgkmcnt(6)
    v_mfma_f32_16x16x32_bf16 v[88:91], v[200:203], a[40:43], v[88:91]
    v_mfma_f32_16x16x32_bf16 v[92:95], v[200:203], a[44:47], v[92:95]
    s_waitcnt lgkmcnt(4)
    v_mfma_f32_16x16x32_bf16 v[96:99], v[204:207], a[40:43], v[96:99]
    v_mfma_f32_16x16x32_bf16 v[100:103], v[204:207], a[44:47], v[100:103]
    global_load_dwordx4 v[248:251], v41, s[34:35]
    s_waitcnt lgkmcnt(2)
    v_mfma_f32_16x16x32_bf16 v[104:107], v[208:211], a[40:43], v[104:107]
    v_mfma_f32_16x16x32_bf16 v[108:111], v[208:211], a[44:47], v[108:111]
    s_waitcnt lgkmcnt(0)
    v_mfma_f32_16x16x32_bf16 v[112:115], v[212:215], a[40:43], v[112:115]
    v_mfma_f32_16x16x32_bf16 v[116:119], v[212:215], a[44:47], v[116:119]
    s_barrier
    ds_read_b64_tr_b16 v[184:185], v26 offset:16384
    ds_read_b64_tr_b16 v[186:187], v26 offset:18432
    ds_read_b64_tr_b16 v[188:189], v27 offset:16384
    ds_read_b64_tr_b16 v[190:191], v27 offset:18432
    ds_read_b64_tr_b16 v[192:193], v28 offset:16384
    ds_read_b64_tr_b16 v[194:195], v28 offset:18432
    ds_read_b64_tr_b16 v[196:197], v29 offset:16384
    ds_read_b64_tr_b16 v[198:199], v29 offset:18432
    v_mfma_f32_16x16x32_bf16 v[48:51], v[72:75], a[48:51], v[48:51]
    ds_read_b64_tr_b16 v[200:201], v26 offset:20480
    ds_read_b64_tr_b16 v[202:203], v26 offset:22528
    s_waitcnt vmcnt(7)
    buffer_load_dwordx4 v21, s[28:31], s65 offen offset:3072 nt lds
    v_mfma_f32_16x16x32_bf16 v[52:55], v[72:75], a[52:55], v[52:55]
    ds_read_b64_tr_b16 v[204:205], v27 offset:20480
    v_mfma_f32_16x16x32_bf16 v[48:51], v[72:75], a[56:59], v[48:51]
    ds_read_b64_tr_b16 v[206:207], v27 offset:22528
    v_mfma_f32_16x16x32_bf16 v[52:55], v[72:75], a[60:63], v[52:55]
    ds_read_b64_tr_b16 v[208:209], v28 offset:20480
    ds_read_b64_tr_b16 v[210:211], v28 offset:22528
    s_waitcnt lgkmcnt(12)
    v_mfma_f32_16x16x32_bf16 v[88:91], v[184:187], a[48:51], v[88:91]
    ds_read_b64_tr_b16 v[212:213], v29 offset:20480
    v_mfma_f32_16x16x32_bf16 v[92:95], v[184:187], a[52:55], v[92:95]
    ds_read_b64_tr_b16 v[214:215], v29 offset:22528
    s_waitcnt lgkmcnt(12)
    v_mfma_f32_16x16x32_bf16 v[96:99], v[188:191], a[48:51], v[96:99]
    s_waitcnt vmcnt(7)
    s_add_u32 m0, s14, 16384
    s_xor_b32 s65, s13, 49280
    buffer_load_dwordx4 v18, s[28:31], s65 offen offset:0 nt lds
    v_mfma_f32_16x16x32_bf16 v[100:103], v[188:191], a[52:55], v[100:103]
    s_waitcnt lgkmcnt(10)
    v_mfma_f32_16x16x32_bf16 v[104:107], v[192:195], a[48:51], v[104:107]
    v_mfma_f32_16x16x32_bf16 v[108:111], v[192:195], a[52:55], v[108:111]
    s_waitcnt lgkmcnt(8)
    v_mfma_f32_16x16x32_bf16 v[112:115], v[196:199], a[48:51], v[112:115]
    v_mfma_f32_16x16x32_bf16 v[116:119], v[196:199], a[52:55], v[116:119]
    s_waitcnt lgkmcnt(6)
    v_mfma_f32_16x16x32_bf16 v[88:91], v[200:203], a[56:59], v[88:91]
    v_mfma_f32_16x16x32_bf16 v[92:95], v[200:203], a[60:63], v[92:95]
    s_waitcnt vmcnt(7)
    buffer_load_dwordx4 v19, s[28:31], s65 offen offset:1024 nt lds
    s_waitcnt lgkmcnt(4)
    v_mfma_f32_16x16x32_bf16 v[96:99], v[204:207], a[56:59], v[96:99]
    v_mfma_f32_16x16x32_bf16 v[100:103], v[204:207], a[60:63], v[100:103]
    s_waitcnt lgkmcnt(2)
    v_mfma_f32_16x16x32_bf16 v[104:107], v[208:211], a[56:59], v[104:107]
    v_mfma_f32_16x16x32_bf16 v[108:111], v[208:211], a[60:63], v[108:111]
    s_waitcnt lgkmcnt(0)
    v_mfma_f32_16x16x32_bf16 v[112:115], v[212:215], a[56:59], v[112:115]
    v_mfma_f32_16x16x32_bf16 v[116:119], v[212:215], a[60:63], v[116:119]
    s_barrier
    ds_read_b64_tr_b16 v[184:185], v26 offset:32768
    ds_read_b64_tr_b16 v[186:187], v26 offset:34816
    ds_read_b64_tr_b16 v[188:189], v27 offset:32768
    ds_read_b64_tr_b16 v[190:191], v27 offset:34816
    ds_read_b64_tr_b16 v[192:193], v28 offset:32768
    ds_read_b64_tr_b16 v[194:195], v28 offset:34816
    ds_read_b64_tr_b16 v[196:197], v29 offset:32768
    ds_read_b64_tr_b16 v[198:199], v29 offset:34816
    v_mfma_f32_16x16x32_bf16 v[48:51], v[72:75], a[64:67], v[48:51]
    ds_read_b64_tr_b16 v[200:201], v26 offset:36864
    ds_read_b64_tr_b16 v[202:203], v26 offset:38912
    s_waitcnt vmcnt(7)
    buffer_load_dwordx4 v20, s[28:31], s65 offen offset:2048 nt lds
    v_mfma_f32_16x16x32_bf16 v[52:55], v[72:75], a[68:71], v[52:55]
    ds_read_b64_tr_b16 v[204:205], v27 offset:36864
    v_mfma_f32_16x16x32_bf16 v[48:51], v[72:75], a[72:75], v[48:51]
    ds_read_b64_tr_b16 v[206:207], v27 offset:38912
    v_mfma_f32_16x16x32_bf16 v[52:55], v[72:75], a[76:79], v[52:55]
    ds_read_b64_tr_b16 v[208:209], v28 offset:36864
    ds_read_b64_tr_b16 v[210:211], v28 offset:38912
    s_waitcnt lgkmcnt(12)
    v_mfma_f32_16x16x32_bf16 v[88:91], v[184:187], a[64:67], v[88:91]
    ds_read_b64_tr_b16 v[212:213], v29 offset:36864
    v_mfma_f32_16x16x32_bf16 v[92:95], v[184:187], a[68:71], v[92:95]
    ds_read_b64_tr_b16 v[214:215], v29 offset:38912
    s_waitcnt lgkmcnt(12)
    v_mfma_f32_16x16x32_bf16 v[96:99], v[188:191], a[64:67], v[96:99]
    v_mfma_f32_16x16x32_bf16 v[100:103], v[188:191], a[68:71], v[100:103]
    s_waitcnt lgkmcnt(10)
    v_mfma_f32_16x16x32_bf16 v[104:107], v[192:195], a[64:67], v[104:107]
    v_mfma_f32_16x16x32_bf16 v[108:111], v[192:195], a[68:71], v[108:111]
    s_waitcnt lgkmcnt(8)
    v_mfma_f32_16x16x32_bf16 v[112:115], v[196:199], a[64:67], v[112:115]
    s_waitcnt vmcnt(7)
    buffer_load_dwordx4 v21, s[28:31], s65 offen offset:3072 nt lds
    v_mfma_f32_16x16x32_bf16 v[116:119], v[196:199], a[68:71], v[116:119]
    s_waitcnt lgkmcnt(6)
    v_mfma_f32_16x16x32_bf16 v[88:91], v[200:203], a[72:75], v[88:91]
    v_mfma_f32_16x16x32_bf16 v[92:95], v[200:203], a[76:79], v[92:95]
    s_waitcnt lgkmcnt(4)
    v_mfma_f32_16x16x32_bf16 v[96:99], v[204:207], a[72:75], v[96:99]
    v_mfma_f32_16x16x32_bf16 v[100:103], v[204:207], a[76:79], v[100:103]
    s_waitcnt lgkmcnt(2)
    v_mfma_f32_16x16x32_bf16 v[104:107], v[208:211], a[72:75], v[104:107]
    v_mfma_f32_16x16x32_bf16 v[108:111], v[208:211], a[76:79], v[108:111]
    s_waitcnt lgkmcnt(0)
    v_mfma_f32_16x16x32_bf16 v[112:115], v[212:215], a[72:75], v[112:115]
    v_mfma_f32_16x16x32_bf16 v[116:119], v[212:215], a[76:79], v[116:119]
    s_mov_b32 s71, 2000000
L_cnt:
    v_readfirstlane_b32 s62, v42
    s_nop 1
    s_cmp_ge_u32 s62, 32
    s_cbranch_scc1 L_cnt_ok
    v_mov_b32 v42, 0
    buffer_load_dword v42, v42, s[92:95], s61 offen sc1
    s_waitcnt vmcnt(0)
    s_sub_u32 s71, s71, 1
    s_cmp_lg_u32 s71, 0
    s_cbranch_scc1 L_cnt
L_cnt_ok:
    s_barrier
    v_subrev_u32 v26, 0x4000, v26
    v_subrev_u32 v27, 0x4000, v27
    v_subrev_u32 v28, 0x4000, v28
    v_subrev_u32 v29, 0x4000, v29
    ds_read_b64_tr_b16 v[184:185], v26 offset:0
    ds_read_b64_tr_b16 v[186:187], v26 offset:2048
    ds_read_b64_tr_b16 v[188:189], v27 offset:0
    ds_read_b64_tr_b16 v[190:191], v27 offset:2048
    ds_read_b64_tr_b16 v[192:193], v28 offset:0
    ds_read_b64_tr_b16 v[194:195], v28 offset:2048
    ds_read_b64_tr_b16 v[196:197], v29 offset:0
    ds_read_b64_tr_b16 v[198:199], v29 offset:2048
    v_mfma_f32_16x16x32_bf16 v[48:51], v[72:75], a[80:83], v[48:51]
    ds_read_b64_tr_b16 v[200:201], v26 offset:4096
    ds_read_b64_tr_b16 v[202:203], v26 offset:6144
    buffer_load_dword v42, v38, s[44:47], 0 offen sc1
    v_mfma_f32_16x16x32_bf16 v[52:55], v[72:75], a[84:87], v[52:55]
    ds_read_b64_tr_b16 v[204:205], v27 offset:4096
    v_mfma_f32_16x16x32_bf16 v[48:51], v[72:75], a[88:91], v[48:51]
    ds_read_b64_tr_b16 v[206:207], v27 offset:6144
    v_mfma_f32_16x16x32_bf16 v[52:55], v[72:75], a[92:95], v[52:55]
    ds_read_b64_tr_b16 v[208:209], v28 offset:4096
    ds_read_b64_tr_b16 v[210:211], v28 offset:6144
    s_waitcnt lgkmcnt(12)
    v_mfma_f32_16x16x32_bf16 v[88:91], v[184:187], a[80:83], v[88:91]
    ds_read_b64_tr_b16 v[212:213], v29 offset:4096
    v_mfma_f32_16x16x32_bf16 v[92:95], v[184:187], a[84:87], v[92:95]
    ds_read_b64_tr_b16 v[214:215], v29 offset:6144
    s_waitcnt vmcnt(7)
    s_add_u32 m0, s14, 32768
    s_xor_b32 s65, s13, 65664
    buffer_load_dwordx4 v18, s[28:31], s65 offen offset:0 nt lds
    s_waitcnt lgkmcnt(12)
    v_mfma_f32_16x16x32_bf16 v[96:99], v[188:191], a[80:83], v[96:99]
    v_mfma_f32_16x16x32_bf16 v[100:103], v[188:191], a[84:87], v[100:103]
    s_waitcnt lgkmcnt(10)
    v_mfma_f32_16x16x32_bf16 v[104:107], v[192:195], a[80:83], v[104:107]
    v_mfma_f32_16x16x32_bf16 v[108:111], v[192:195], a[84:87], v[108:111]
    s_waitcnt lgkmcnt(8)
    v_mfma_f32_16x16x32_bf16 v[112:115], v[196:199], a[80:83], v[112:115]
    s_waitcnt vmcnt(7)
    buffer_load_dwordx4 v19, s[28:31], s65 offen offset:1024 nt lds
    v_mfma_f32_16x16x32_bf16 v[116:119], v[196:199], a[84:87], v[116:119]
    s_waitcnt lgkmcnt(6)
    v_mfma_f32_16x16x32_bf16 v[88:91], v[200:203], a[88:91], v[88:91]
    v_mfma_f32_16x16x32_bf16 v[92:95], v[200:203], a[92:95], v[92:95]
    s_waitcnt lgkmcnt(4)
    v_mfma_f32_16x16x32_bf16 v[96:99], v[204:207], a[88:91], v[96:99]
    v_mfma_f32_16x16x32_bf16 v[100:103], v[204:207], a[92:95], v[100:103]
    s_waitcnt vmcnt(7)
    buffer_load_dwordx4 v20, s[28:31], s65 offen offset:2048 nt lds
    s_waitcnt lgkmcnt(2)
    v_mfma_f32_16x16x32_bf16 v[104:107], v[208:211], a[88:91], v[104:107]
    v_mfma_f32_16x16x32_bf16 v[108:111], v[208:211], a[92:95], v[108:111]
    s_waitcnt lgkmcnt(0)
    v_mfma_f32_16x16x32_bf16 v[112:115], v[212:215], a[88:91], v[112:115]
    v_mfma_f32_16x16x32_bf16 v[116:119], v[212:215], a[92:95], v[116:119]
    s_barrier
    v_add_u32 v26, 0x14000, v26
    v_add_u32 v27, 0x14000, v27
    v_add_u32 v28, 0x14000, v28
    v_add_u32 v29, 0x14000, v29
    ds_read_b64_tr_b16 v[184:185], v26 offset:0
    ds_read_b64_tr_b16 v[186:187], v26 offset:2048
    ds_read_b64_tr_b16 v[188:189], v27 offset:0
    ds_read_b64_tr_b16 v[190:191], v27 offset:2048
    ds_read_b64_tr_b16 v[192:193], v28 offset:0
    ds_read_b64_tr_b16 v[194:195], v28 offset:2048
    ds_read_b64_tr_b16 v[196:197], v29 offset:0
    ds_read_b64_tr_b16 v[198:199], v29 offset:2048
    v_mfma_f32_16x16x32_bf16 v[48:51], v[72:75], a[96:99], v[48:51]
    ds_read_b64_tr_b16 v[200:201], v26 offset:4096
    ds_read_b64_tr_b16 v[202:203], v26 offset:6144
    s_waitcnt vmcnt(7)
    buffer_load_dwordx4 v21, s[28:31], s65 offen offset:3072 nt lds
    v_mfma_f32_16x16x32_bf16 v[52:55], v[72:75], a[100:103], v[52:55]
    ds_read_b64_tr_b16 v[204:205], v27 offset:4096
    v_mfma_f32_16x16x32_bf16 v[48:51], v[72:75], a[104:107], v[48:51]
    ds_read_b64_tr_b16 v[206:207], v27 offset:6144
    v_mfma_f32_16x16x32_bf16 v[52:55], v[72:75], a[108:111], v[52:55]
    ds_read_b64_tr_b16 v[208:209], v28 offset:4096
    ds_read_b64_tr_b16 v[210:211], v28 offset:6144
    s_waitcnt lgkmcnt(12)
    v_mfma_f32_16x16x32_bf16 v[88:91], v[184:187], a[96:99], v[88:91]
    ds_read_b64_tr_b16 v[212:213], v29 offset:4096
    v_mfma_f32_16x16x32_bf16 v[92:95], v[184:187], a[100:103], v[92:95]
    ds_read_b64_tr_b16 v[214:215], v29 offset:6144
    s_waitcnt lgkmcnt(12)
    v_mfma_f32_16x16x32_bf16 v[96:99], v[188:191], a[96:99], v[96:99]
    s_waitcnt vmcnt(7)
    s_add_u32 m0, s14, 0
    s_xor_b32 s65, s13, 82048
    buffer_load_dwordx4 v18, s[28:31], s65 offen offset:0 nt lds
    v_mfma_f32_16x16x32_bf16 v[100:103], v[188:191], a[100:103], v[100:103]
    s_waitcnt lgkmcnt(10)
    v_mfma_f32_16x16x32_bf16 v[104:107], v[192:195], a[96:99], v[104:107]
    v_mfma_f32_16x16x32_bf16 v[108:111], v[192:195], a[100:103], v[108:111]
    s_waitcnt lgkmcnt(8)
    v_mfma_f32_16x16x32_bf16 v[112:115], v[196:199], a[96:99], v[112:115]
    v_mfma_f32_16x16x32_bf16 v[116:119], v[196:199], a[100:103], v[116:119]
    s_waitcnt lgkmcnt(6)
    v_mfma_f32_16x16x32_bf16 v[88:91], v[200:203], a[104:107], v[88:91]
    v_mfma_f32_16x16x32_bf16 v[92:95], v[200:203], a[108:111], v[92:95]
    s_waitcnt vmcnt(7)
    buffer_load_dwordx4 v19, s[28:31], s65 offen offset:1024 nt lds
    s_waitcnt lgkmcnt(4)
    v_mfma_f32_16x16x32_bf16 v[96:99], v[204:207], a[104:107], v[96:99]
    v_mfma_f32_16x16x32_bf16 v[100:103], v[204:207], a[108:111], v[100:103]
    s_waitcnt lgkmcnt(2)
    v_mfma_f32_16x16x32_bf16 v[104:107], v[208:211], a[104:107], v[104:107]
    v_mfma_f32_16x16x32_bf16 v[108:111], v[208:211], a[108:111], v[108:111]
    s_waitcnt lgkmcnt(0)
    v_mfma_f32_16x16x32_bf16 v[112:115], v[212:215], a[104:107], v[112:115]
    v_mfma_f32_16x16x32_bf16 v[116:119], v[212:215], a[108:111], v[116:119]
    s_barrier
    ds_read_b64_tr_b16 v[184:185], v26 offset:49152
    ds_read_b64_tr_b16 v[186:187], v26 offset:51200
    ds_read_b64_tr_b16 v[188:189], v27 offset:49152
    ds_read_b64_tr_b16 v[190:191], v27 offset:51200
    ds_read_b64_tr_b16 v[192:193], v28 offset:49152
    ds_read_b64_tr_b16 v[194:195], v28 offset:51200
    ds_read_b64_tr_b16 v[196:197], v29 offset:49152
    ds_read_b64_tr_b16 v[198:199], v29 offset:51200
    v_mfma_f32_16x16x32_bf16 v[48:51], v[72:75], a[112:115], v[48:51]
    ds_read_b64_tr_b16 v[200:201], v26 offset:53248
    ds_read_b64_tr_b16 v[202:203], v26 offset:55296
    s_waitcnt vmcnt(7)
    buffer_load_dwordx4 v20, s[28:31], s65 offen offset:2048 nt lds
    v_mfma_f32_16x16x32_bf16 v[52:55], v[72:75], a[116:119], v[52:55]
    ds_read_b64_tr_b16 v[204:205], v27 offset:53248
    v_mfma_f32_16x16x32_bf16 v[48:51], v[72:75], a[120:123], v[48:51]
    ds_read_b64_tr_b16 v[206:207], v27 offset:55296
    v_mfma_f32_16x16x32_bf16 v[52:55], v[72:75], a[124:127], v[52:55]
    ds_read_b64_tr_b16 v[208:209], v28 offset:53248
    ds_read_b64_tr_b16 v[210:211], v28 offset:55296
    s_waitcnt vmcnt(7)
    buffer_load_dwordx4 v21, s[28:31], s65 offen offset:3072 nt lds
    s_waitcnt lgkmcnt(12)
    v_mfma_f32_16x16x32_bf16 v[88:91], v[184:187], a[112:115], v[88:91]
    ds_read_b64_tr_b16 v[212:213], v29 offset:53248
    v_mfma_f32_16x16x32_bf16 v[92:95], v[184:187], a[116:119], v[92:95]
    ds_read_b64_tr_b16 v[214:215], v29 offset:55296
    s_waitcnt lgkmcnt(12)
    v_mfma_f32_16x16x32_bf16 v[96:99], v[188:191], a[112:115], v[96:99]
    s_waitcnt vmcnt(7)
    s_add_u32 m0, s14, 114688
    s_xor_b32 s58, s59, 0x0
    buffer_load_dwordx4 v14, s[36:39], s58 offen offset:0  lds
    v_mfma_f32_16x16x32_bf16 v[100:103], v[188:191], a[116:119], v[100:103]
    s_waitcnt lgkmcnt(10)
    v_mfma_f32_16x16x32_bf16 v[104:107], v[192:195], a[112:115], v[104:107]
    v_mfma_f32_16x16x32_bf16 v[108:111], v[192:195], a[116:119], v[108:111]
    s_waitcnt lgkmcnt(8)
    v_mfma_f32_16x16x32_bf16 v[112:115], v[196:199], a[112:115], v[112:115]
    s_waitcnt vmcnt(7)
    buffer_load_dwordx4 v15, s[36:39], s58 offen offset:1024  lds
    v_mfma_f32_16x16x32_bf16 v[116:119], v[196:199], a[116:119], v[116:119]
    s_waitcnt lgkmcnt(6)
    v_mfma_f32_16x16x32_bf16 v[88:91], v[200:203], a[120:123], v[88:91]
    v_mfma_f32_16x16x32_bf16 v[92:95], v[200:203], a[124:127], v[92:95]
    s_waitcnt vmcnt(7)
    buffer_load_dwordx4 v16, s[36:39], s58 offen offset:2048  lds
    s_waitcnt lgkmcnt(4)
    v_mfma_f32_16x16x32_bf16 v[96:99], v[204:207], a[120:123], v[96:99]
    v_mfma_f32_16x16x32_bf16 v[100:103], v[204:207], a[124:127], v[100:103]
    s_waitcnt lgkmcnt(2)
    v_mfma_f32_16x16x32_bf16 v[104:107], v[208:211], a[120:123], v[104:107]
    s_waitcnt vmcnt(7)
    buffer_load_dwordx4 v17, s[36:39], s58 offen offset:3072  lds
    v_mfma_f32_16x16x32_bf16 v[108:111], v[208:211], a[124:127], v[108:111]
    s_waitcnt lgkmcnt(0)
    v_mfma_f32_16x16x32_bf16 v[112:115], v[212:215], a[120:123], v[112:115]
    v_mfma_f32_16x16x32_bf16 v[116:119], v[212:215], a[124:127], v[116:119]
    s_barrier
    v_add_u32 v26, 0x4000, v26
    v_add_u32 v27, 0x4000, v27
    v_add_u32 v28, 0x4000, v28
    v_add_u32 v29, 0x4000, v29
    ds_read_b64_tr_b16 v[184:185], v26 offset:49152
    ds_read_b64_tr_b16 v[186:187], v26 offset:51200
    ds_read_b64_tr_b16 v[188:189], v27 offset:49152
    ds_read_b64_tr_b16 v[190:191], v27 offset:51200
    ds_read_b64_tr_b16 v[192:193], v28 offset:49152
    ds_read_b64_tr_b16 v[194:195], v28 offset:51200
    ds_read_b64_tr_b16 v[196:197], v29 offset:49152
    ds_read_b64_tr_b16 v[198:199], v29 offset:51200
    v_rcp_f32 v46, v48
    v_rcp_f32 v47, v52
    v_and_b32 v42, -16, v42
    v_cmp_ne_u32 vcc, s15, v42
    s_nop 1
    s_cmp_eq_u64 vcc, 0
    s_cselect_b32 s70, 1, 0
    s_xor_b32 s63, s66, 0
    s_lshl_b32 s63, s63, 12
    s_add_u32 s62, s14, 131072
    v_add_u32 v37, s62, v36
    v_mul_f32 v88, v46, v88
    v_mul_f32 v89, v46, v89
    v_mul_f32 v90, v46, v90
    v_mul_f32 v91, v46, v91
    v_mul_f32 v96, v46, v96
    s_waitcnt lgkmcnt(6)
    v_mfma_f32_16x16x32_bf16 v[120:123], v[184:187], a[0:3], 0
    ds_read_b64_tr_b16 v[200:201], v26 offset:53248
    ds_read_b64_tr_b16 v[202:203], v26 offset:55296
    s_waitcnt vmcnt(7)
    s_add_u32 m0, s14, 49152
    s_xor_b32 s65, s13, 98432
    buffer_load_dwordx4 v18, s[28:31], s65 offen offset:0 nt lds
    v_mul_f32 v97, v46, v97
    v_mul_f32 v98, v46, v98
    v_mul_f32 v99, v46, v99
    v_cvt_pk_bf16_f32 v152, v88, v89
    v_mfma_f32_16x16x32_bf16 v[124:127], v[184:187], a[4:7], 0
    ds_read_b64_tr_b16 v[204:205], v27 offset:53248
    v_cvt_pk_bf16_f32 v153, v90, v91
    v_cvt_pk_bf16_f32 v154, v96, v97
    v_cvt_pk_bf16_f32 v155, v98, v99
    s_waitcnt lgkmcnt(7)
    v_mfma_f32_16x16x32_bf16 v[128:131], v[188:191], a[0:3], 0
    ds_read_b64_tr_b16 v[206:207], v27 offset:55296
    v_mul_f32 v92, v47, v92
    v_mul_f32 v93, v47, v93
    v_mul_f32 v94, v47, v94
    v_mfma_f32_16x16x32_bf16 v[132:135], v[188:191], a[4:7], 0
    ds_read_b64_tr_b16 v[208:209], v28 offset:53248
    ds_read_b64_tr_b16 v[210:211], v28 offset:55296
    v_mul_f32 v95, v47, v95
    v_mul_f32 v100, v47, v100
    v_mul_f32 v101, v47, v101
    s_waitcnt lgkmcnt(8)
    v_mfma_f32_16x16x32_bf16 v[136:139], v[192:195], a[0:3], 0
    ds_read_b64_tr_b16 v[212:213], v29 offset:53248
    v_mul_f32 v102, v47, v102
    v_mul_f32 v103, v47, v103
    v_cvt_pk_bf16_f32 v156, v92, v93
    v_mfma_f32_16x16x32_bf16 v[140:143], v[192:195], a[4:7], 0
    ds_read_b64_tr_b16 v[214:215], v29 offset:55296
    s_waitcnt vmcnt(7)
    buffer_load_dwordx4 v19, s[28:31], s65 offen offset:1024 nt lds
    v_cvt_pk_bf16_f32 v157, v94, v95
    v_cvt_pk_bf16_f32 v158, v100, v101
    v_cvt_pk_bf16_f32 v159, v102, v103
    s_waitcnt lgkmcnt(8)
    v_mfma_f32_16x16x32_bf16 v[144:147], v[196:199], a[0:3], 0
    s_cmp_eq_u32 s70, 0
    s_cbranch_scc1 L_wt_1
    buffer_store_dwordx4 v[152:155], v36, s[40:43], s63 offen offset:0
    buffer_store_dwordx4 v[156:159], v36, s[40:43], s63 offen offset:1024
    s_branch L_wd_1
L_wt_1:
    buffer_store_dwordx4 v[152:155], v36, s[40:43], s63 offen offset:0 sc1
    buffer_store_dwordx4 v[156:159], v36, s[40:43], s63 offen offset:1024 sc1
L_wd_1:
    v_mul_f32 v104, v46, v104
    v_mul_f32 v105, v46, v105
    v_mfma_f32_16x16x32_bf16 v[148:151], v[196:199], a[4:7], 0
    v_mul_f32 v106, v46, v106
    v_mul_f32 v107, v46, v107
    v_mul_f32 v112, v46, v112
    s_waitcnt lgkmcnt(6)
    v_mfma_f32_16x16x32_bf16 v[120:123], v[200:203], a[8:11], v[120:123]
    v_mul_f32 v113, v46, v113
    v_mul_f32 v114, v46, v114
    v_mul_f32 v115, v46, v115
    v_mfma_f32_16x16x32_bf16 v[124:127], v[200:203], a[12:15], v[124:127]
    v_cvt_pk_bf16_f32 v160, v104, v105
    v_cvt_pk_bf16_f32 v161, v106, v107
    v_cvt_pk_bf16_f32 v162, v112, v113
    s_waitcnt lgkmcnt(4)
    v_mfma_f32_16x16x32_bf16 v[128:131], v[204:207], a[8:11], v[128:131]
    s_waitcnt vmcnt(9)
    buffer_load_dwordx4 v20, s[28:31], s65 offen offset:2048 nt lds
    v_cvt_pk_bf16_f32 v163, v114, v115
    v_mul_f32 v108, v47, v108
    v_mul_f32 v109, v47, v109
    v_mfma_f32_16x16x32_bf16 v[132:135], v[204:207], a[12:15], v[132:135]
    v_mul_f32 v110, v47, v110
    v_mul_f32 v111, v47, v111
    v_mul_f32 v116, v47, v116
    s_waitcnt lgkmcnt(2)
    v_mfma_f32_16x16x32_bf16 v[136:139], v[208:211], a[8:11], v[136:139]
    v_mul_f32 v117, v47, v117
    v_mul_f32 v118, v47, v118
    v_mul_f32 v119, v47, v119
    v_mfma_f32_16x16x32_bf16 v[140:143], v[208:211], a[12:15], v[140:143]
    v_cvt_pk_bf16_f32 v164, v108, v109
    v_cvt_pk_bf16_f32 v165, v110, v111
    v_cvt_pk_bf16_f32 v166, v116, v117
    s_waitcnt lgkmcnt(0)
    v_mfma_f32_16x16x32_bf16 v[144:147], v[212:215], a[8:11], v[144:147]
    v_cvt_pk_bf16_f32 v167, v118, v119
    s_cmp_eq_u32 s70, 0
    s_cbranch_scc1 L_wt_3
    buffer_store_dwordx4 v[160:163], v36, s[40:43], s63 offen offset:2048
    buffer_store_dwordx4 v[164:167], v36, s[40:43], s63 offen offset:3072
    s_branch L_wd_3
L_wt_3:
    buffer_store_dwordx4 v[160:163], v36, s[40:43], s63 offen offset:2048 sc1
    buffer_store_dwordx4 v[164:167], v36, s[40:43], s63 offen offset:3072 sc1
L_wd_3:
    ds_write_b128 v37, v[152:155] offset:0
    v_mfma_f32_16x16x32_bf16 v[148:151], v[212:215], a[12:15], v[148:151]
    ds_write_b128 v37, v[156:159] offset:1024
    ds_write_b128 v37, v[160:163] offset:2048
    ds_write_b128 v37, v[164:167] offset:3072
    s_waitcnt lgkmcnt(0)
    s_barrier
    ds_read_b64_tr_b16 v[184:185], v26 offset:0
    ds_read_b64_tr_b16 v[186:187], v26 offset:2048
    ds_read_b64_tr_b16 v[188:189], v27 offset:0
    ds_read_b64_tr_b16 v[190:191], v27 offset:2048
    ds_read_b64_tr_b16 v[192:193], v28 offset:0
    ds_read_b64_tr_b16 v[194:195], v28 offset:2048
    ds_read_b64_tr_b16 v[196:197], v29 offset:0
    ds_read_b64_tr_b16 v[198:199], v29 offset:2048
    s_waitcnt lgkmcnt(6)
    v_mfma_f32_16x16x32_bf16 v[120:123], v[184:187], a[16:19], v[120:123]
    ds_read_b64_tr_b16 v[200:201], v26 offset:4096
    ds_read_b64_tr_b16 v[202:203], v26 offset:6144
    s_waitcnt vmcnt(11)
    buffer_load_dwordx4 v21, s[28:31], s65 offen offset:3072 nt lds
    v_mfma_f32_16x16x32_bf16 v[124:127], v[184:187], a[20:23], v[124:127]
    ds_read_b64_tr_b16 v[204:205], v27 offset:4096
    s_waitcnt lgkmcnt(7)
    v_mfma_f32_16x16x32_bf16 v[128:131], v[188:191], a[16:19], v[128:131]
    ds_read_b64_tr_b16 v[206:207], v27 offset:6144
    v_mfma_f32_16x16x32_bf16 v[132:135], v[188:191], a[20:23], v[132:135]
    ds_read_b64_tr_b16 v[208:209], v28 offset:4096
    ds_read_b64_tr_b16 v[210:211], v28 offset:6144
    s_waitcnt lgkmcnt(8)
    v_mfma_f32_16x16x32_bf16 v[136:139], v[192:195], a[16:19], v[136:139]
    ds_read_b64_tr_b16 v[212:213], v29 offset:4096
    s_waitcnt vmcnt(11)
    s_add_u32 m0, s14, 81920
    s_xor_b32 s65, s13, 114816
    buffer_load_dwordx4 v18, s[28:31], s65 offen offset:0 nt lds
    v_mfma_f32_16x16x32_bf16 v[140:143], v[192:195], a[20:23], v[140:143]
    ds_read_b64_tr_b16 v[214:215], v29 offset:6144
    s_waitcnt lgkmcnt(8)
    v_mfma_f32_16x16x32_bf16 v[144:147], v[196:199], a[16:19], v[144:147]
    v_mfma_f32_16x16x32_bf16 v[148:151], v[196:199], a[20:23], v[148:151]
    s_waitcnt lgkmcnt(6)
    v_mfma_f32_16x16x32_bf16 v[120:123], v[200:203], a[24:27], v[120:123]
    s_waitcnt vmcnt(11)
    buffer_load_dwordx4 v19, s[28:31], s65 offen offset:1024 nt lds
    v_mfma_f32_16x16x32_bf16 v[124:127], v[200:203], a[28:31], v[124:127]
    s_waitcnt lgkmcnt(4)
    v_mfma_f32_16x16x32_bf16 v[128:131], v[204:207], a[24:27], v[128:131]
    v_mfma_f32_16x16x32_bf16 v[132:135], v[204:207], a[28:31], v[132:135]
    s_waitcnt lgkmcnt(2)
    v_mfma_f32_16x16x32_bf16 v[136:139], v[208:211], a[24:27], v[136:139]
    global_load_dwordx4 v[248:251], v41, s[34:35]
    v_mfma_f32_16x16x32_bf16 v[140:143], v[208:211], a[28:31], v[140:143]
    s_waitcnt lgkmcnt(0)
    v_mfma_f32_16x16x32_bf16 v[144:147], v[212:215], a[24:27], v[144:147]
    v_mfma_f32_16x16x32_bf16 v[148:151], v[212:215], a[28:31], v[148:151]
    s_barrier
    v_subrev_u32 v26, 0x8000, v26
    v_subrev_u32 v27, 0x8000, v27
    v_subrev_u32 v28, 0x8000, v28
    v_subrev_u32 v29, 0x8000, v29
    ds_read_b64_tr_b16 v[184:185], v26 offset:0
    ds_read_b64_tr_b16 v[186:187], v26 offset:2048
    ds_read_b64_tr_b16 v[188:189], v27 offset:0
    ds_read_b64_tr_b16 v[190:191], v27 offset:2048
    ds_read_b64_tr_b16 v[192:193], v28 offset:0
    ds_read_b64_tr_b16 v[194:195], v28 offset:2048
    ds_read_b64_tr_b16 v[196:197], v29 offset:0
    ds_read_b64_tr_b16 v[198:199], v29 offset:2048
    s_waitcnt lgkmcnt(6)
    v_mfma_f32_16x16x32_bf16 v[120:123], v[184:187], a[32:35], v[120:123]
    ds_read_b64_tr_b16 v[200:201], v26 offset:4096
    ds_read_b64_tr_b16 v[202:203], v26 offset:6144
    s_waitcnt vmcnt(11)
    buffer_load_dwordx4 v20, s[28:31], s65 offen offset:2048 nt lds
    v_mfma_f32_16x16x32_bf16 v[124:127], v[184:187], a[36:39], v[124:127]
    ds_read_b64_tr_b16 v[204:205], v27 offset:4096
    s_waitcnt lgkmcnt(7)
    v_mfma_f32_16x16x32_bf16 v[128:131], v[188:191], a[32:35], v[128:131]
    ds_read_b64_tr_b16 v[206:207], v27 offset:6144
    v_mfma_f32_16x16x32_bf16 v[132:135], v[188:191], a[36:39], v[132:135]
    ds_read_b64_tr_b16 v[208:209], v28 offset:4096
    ds_read_b64_tr_b16 v[210:211], v28 offset:6144
    s_waitcnt lgkmcnt(8)
    v_mfma_f32_16x16x32_bf16 v[136:139], v[192:195], a[32:35], v[136:139]
    ds_read_b64_tr_b16 v[212:213], v29 offset:4096
    v_mfma_f32_16x16x32_bf16 v[140:143], v[192:195], a[36:39], v[140:143]
    ds_read_b64_tr_b16 v[214:215], v29 offset:6144
    s_waitcnt lgkmcnt(8)
    v_mfma_f32_16x16x32_bf16 v[144:147], v[196:199], a[32:35], v[144:147]
    v_mfma_f32_16x16x32_bf16 v[148:151], v[196:199], a[36:39], v[148:151]
    s_waitcnt lgkmcnt(6)
    v_mfma_f32_16x16x32_bf16 v[120:123], v[200:203], a[40:43], v[120:123]
    s_waitcnt vmcnt(11)
    buffer_load_dwordx4 v21, s[28:31], s65 offen offset:3072 nt lds
    v_mfma_f32_16x16x32_bf16 v[124:127], v[200:203], a[44:47], v[124:127]
    s_waitcnt lgkmcnt(4)
    v_mfma_f32_16x16x32_bf16 v[128:131], v[204:207], a[40:43], v[128:131]
    v_mfma_f32_16x16x32_bf16 v[132:135], v[204:207], a[44:47], v[132:135]
    s_waitcnt lgkmcnt(2)
    v_mfma_f32_16x16x32_bf16 v[136:139], v[208:211], a[40:43], v[136:139]
    v_mfma_f32_16x16x32_bf16 v[140:143], v[208:211], a[44:47], v[140:143]
    s_waitcnt lgkmcnt(0)
    v_mfma_f32_16x16x32_bf16 v[144:147], v[212:215], a[40:43], v[144:147]
    v_mfma_f32_16x16x32_bf16 v[148:151], v[212:215], a[44:47], v[148:151]
    s_barrier
    v_subrev_u32 v26, 0xc000, v26
    v_subrev_u32 v27, 0xc000, v27
    v_subrev_u32 v28, 0xc000, v28
    v_subrev_u32 v29, 0xc000, v29
    ds_read_b64_tr_b16 v[184:185], v26 offset:0
    ds_read_b64_tr_b16 v[186:187], v26 offset:2048
    ds_read_b64_tr_b16 v[188:189], v27 offset:0
    ds_read_b64_tr_b16 v[190:191], v27 offset:2048
    ds_read_b64_tr_b16 v[192:193], v28 offset:0
    ds_read_b64_tr_b16 v[194:195], v28 offset:2048
    ds_read_b64_tr_b16 v[196:197], v29 offset:0
    ds_read_b64_tr_b16 v[198:199], v29 offset:2048
    s_waitcnt lgkmcnt(6)
    v_mfma_f32_16x16x32_bf16 v[120:123], v[184:187], a[48:51], v[120:123]
    ds_read_b64_tr_b16 v[200:201], v26 offset:4096
    ds_read_b64_tr_b16 v[202:203], v26 offset:6144
    s_waitcnt vmcnt(6)
    v_mov_b32 v252, s15
    v_add_u32 v252, 1, v252
    s_mov_b64 exec, 1
    buffer_store_dword v252, v39, s[44:47], 0 offen sc1
    s_mov_b64 exec, -1
    v_mfma_f32_16x16x32_bf16 v[124:127], v[184:187], a[52:55], v[124:127]
    ds_read_b64_tr_b16 v[204:205], v27 offset:4096
    s_waitcnt lgkmcnt(7)
    v_mfma_f32_16x16x32_bf16 v[128:131], v[188:191], a[48:51], v[128:131]
    ds_read_b64_tr_b16 v[206:207], v27 offset:6144
    v_mfma_f32_16x16x32_bf16 v[132:135], v[188:191], a[52:55], v[132:135]
    ds_read_b64_tr_b16 v[208:209], v28 offset:4096
    ds_read_b64_tr_b16 v[210:211], v28 offset:6144
    s_waitcnt lgkmcnt(8)
    v_mfma_f32_16x16x32_bf16 v[136:139], v[192:195], a[48:51], v[136:139]
    ds_read_b64_tr_b16 v[212:213], v29 offset:4096
    v_mfma_f32_16x16x32_bf16 v[140:143], v[192:195], a[52:55], v[140:143]
    ds_read_b64_tr_b16 v[214:215], v29 offset:6144
    s_waitcnt lgkmcnt(8)
    v_mfma_f32_16x16x32_bf16 v[144:147], v[196:199], a[48:51], v[144:147]
    v_mfma_f32_16x16x32_bf16 v[148:151], v[196:199], a[52:55], v[148:151]
    s_waitcnt lgkmcnt(6)
    v_mfma_f32_16x16x32_bf16 v[120:123], v[200:203], a[56:59], v[120:123]
    v_mfma_f32_16x16x32_bf16 v[124:127], v[200:203], a[60:63], v[124:127]
    s_waitcnt lgkmcnt(4)
    v_mfma_f32_16x16x32_bf16 v[128:131], v[204:207], a[56:59], v[128:131]
    v_mfma_f32_16x16x32_bf16 v[132:135], v[204:207], a[60:63], v[132:135]
    s_waitcnt lgkmcnt(2)
    v_mfma_f32_16x16x32_bf16 v[136:139], v[208:211], a[56:59], v[136:139]
    v_mfma_f32_16x16x32_bf16 v[140:143], v[208:211], a[60:63], v[140:143]
    s_waitcnt lgkmcnt(0)
    v_mfma_f32_16x16x32_bf16 v[144:147], v[212:215], a[56:59], v[144:147]
    v_mfma_f32_16x16x32_bf16 v[148:151], v[212:215], a[60:63], v[148:151]
    s_barrier
    ds_read_b64_tr_b16 v[184:185], v26 offset:16384
    ds_read_b64_tr_b16 v[186:187], v26 offset:18432
    ds_read_b64_tr_b16 v[188:189], v27 offset:16384
    ds_read_b64_tr_b16 v[190:191], v27 offset:18432
    ds_read_b64_tr_b16 v[192:193], v28 offset:16384
    ds_read_b64_tr_b16 v[194:195], v28 offset:18432
    ds_read_b64_tr_b16 v[196:197], v29 offset:16384
    ds_read_b64_tr_b16 v[198:199], v29 offset:18432
    s_waitcnt lgkmcnt(6)
    v_mfma_f32_16x16x32_bf16 v[120:123], v[184:187], a[64:67], v[120:123]
    ds_read_b64_tr_b16 v[200:201], v26 offset:20480
    ds_read_b64_tr_b16 v[202:203], v26 offset:22528
    v_mfma_f32_16x16x32_bf16 v[124:127], v[184:187], a[68:71], v[124:127]
    ds_read_b64_tr_b16 v[204:205], v27 offset:20480
    s_waitcnt lgkmcnt(7)
    v_mfma_f32_16x16x32_bf16 v[128:131], v[188:191], a[64:67], v[128:131]
    ds_read_b64_tr_b16 v[206:207], v27 offset:22528
    v_mfma_f32_16x16x32_bf16 v[132:135], v[188:191], a[68:71], v[132:135]
    ds_read_b64_tr_b16 v[208:209], v28 offset:20480
    ds_read_b64_tr_b16 v[210:211], v28 offset:22528
    s_waitcnt lgkmcnt(8)
    v_mfma_f32_16x16x32_bf16 v[136:139], v[192:195], a[64:67], v[136:139]
    ds_read_b64_tr_b16 v[212:213], v29 offset:20480
    v_mfma_f32_16x16x32_bf16 v[140:143], v[192:195], a[68:71], v[140:143]
    ds_read_b64_tr_b16 v[214:215], v29 offset:22528
    s_waitcnt lgkmcnt(8)
    v_mfma_f32_16x16x32_bf16 v[144:147], v[196:199], a[64:67], v[144:147]
    v_mfma_f32_16x16x32_bf16 v[148:151], v[196:199], a[68:71], v[148:151]
    s_waitcnt lgkmcnt(6)
    v_mfma_f32_16x16x32_bf16 v[120:123], v[200:203], a[72:75], v[120:123]
    v_mfma_f32_16x16x32_bf16 v[124:127], v[200:203], a[76:79], v[124:127]
    s_waitcnt lgkmcnt(4)
    v_mfma_f32_16x16x32_bf16 v[128:131], v[204:207], a[72:75], v[128:131]
    v_mfma_f32_16x16x32_bf16 v[132:135], v[204:207], a[76:79], v[132:135]
    s_waitcnt lgkmcnt(2)
    v_mfma_f32_16x16x32_bf16 v[136:139], v[208:211], a[72:75], v[136:139]
    v_mfma_f32_16x16x32_bf16 v[140:143], v[208:211], a[76:79], v[140:143]
    s_waitcnt lgkmcnt(0)
    v_mfma_f32_16x16x32_bf16 v[144:147], v[212:215], a[72:75], v[144:147]
    v_mfma_f32_16x16x32_bf16 v[148:151], v[212:215], a[76:79], v[148:151]
    s_barrier
    ds_read_b64_tr_b16 a[128:129], v10 offset:49152
    ds_read_b64_tr_b16 a[130:131], v10 offset:53248
    ds_read_b64_tr_b16 a[132:133], v11 offset:49152
    ds_read_b64_tr_b16 a[134:135], v11 offset:53248
    ds_read_b128 v[216:219], v7 offset:32768
    ds_read_b128 v[220:223], v8 offset:32768
    ds_read_b128 v[224:227], v9 offset:32768
    ds_read_b128 v[228:231], v6 offset:32768
    ds_read_b128 v[232:235], v7 offset:33792
    ds_read_b128 v[236:239], v8 offset:33792
    ds_read_b128 v[240:243], v9 offset:33792
    ds_read_b64_tr_b16 a[136:137], v10 offset:57344
    ds_read_b64_tr_b16 a[138:139], v10 offset:61440
    ds_read_b64_tr_b16 a[140:141], v11 offset:57344
    ds_read_b64_tr_b16 a[142:143], v11 offset:61440
    s_waitcnt lgkmcnt(7)
    v_mfma_f32_16x16x32_bf16 v[88:91], a[128:131], v[216:219], 0
    ds_read_b128 v[244:247], v6 offset:33792
    v_mfma_f32_16x16x32_bf16 v[92:95], a[132:135], v[216:219], 0
    v_mfma_f32_16x16x32_bf16 v[104:107], a[128:131], v[220:223], 0
    ds_read_b128 v[216:219], v7 offset:34816
    v_mfma_f32_16x16x32_bf16 v[108:111], a[132:135], v[220:223], 0
    v_mfma_f32_16x16x32_bf16 v[152:155], a[128:131], v[224:227], 0
    ds_read_b128 v[220:223], v8 offset:34816
    v_mfma_f32_16x16x32_bf16 v[156:159], a[132:135], v[224:227], 0
    v_mfma_f32_16x16x32_bf16 v[56:59], a[128:131], v[228:231], 0
    ds_read_b128 v[224:227], v9 offset:34816
    v_mfma_f32_16x16x32_bf16 v[60:63], a[132:135], v[228:231], 0
    s_waitcnt lgkmcnt(3)
    v_mfma_f32_16x16x32_bf16 v[96:99], a[128:131], v[232:235], 0
    ds_read_b128 v[228:231], v6 offset:34816
    v_mfma_f32_16x16x32_bf16 v[100:103], a[132:135], v[232:235], 0
    v_mfma_f32_16x16x32_bf16 v[112:115], a[128:131], v[236:239], 0
    ds_read_b128 v[232:235], v7 offset:35840
    v_mfma_f32_16x16x32_bf16 v[116:119], a[132:135], v[236:239], 0
    v_mfma_f32_16x16x32_bf16 v[160:163], a[128:131], v[240:243], 0
    ds_read_b128 v[236:239], v8 offset:35840
    v_mfma_f32_16x16x32_bf16 v[164:167], a[132:135], v[240:243], 0
    v_mfma_f32_16x16x32_bf16 v[64:67], a[128:131], v[244:247], 0
    ds_read_b128 v[240:243], v9 offset:35840
    v_mfma_f32_16x16x32_bf16 v[68:71], a[132:135], v[244:247], 0
    s_waitcnt lgkmcnt(3)
    v_mfma_f32_16x16x32_bf16 v[88:91], a[136:139], v[216:219], v[88:91]
    ds_read_b128 v[244:247], v6 offset:35840
    v_mfma_f32_16x16x32_bf16 v[92:95], a[140:143], v[216:219], v[92:95]
    s_waitcnt lgkmcnt(0)
    s_barrier
    v_subrev_u32 v26, 0x4000, v26
    v_subrev_u32 v27, 0x4000, v27
    v_subrev_u32 v28, 0x4000, v28
    v_subrev_u32 v29, 0x4000, v29
    ds_read_b64_tr_b16 v[184:185], v26 offset:0
    ds_read_b64_tr_b16 v[186:187], v26 offset:2048
    ds_read_b64_tr_b16 v[188:189], v27 offset:0
    ds_read_b64_tr_b16 v[190:191], v27 offset:2048
    ds_read_b64_tr_b16 v[192:193], v28 offset:0
    ds_read_b64_tr_b16 v[194:195], v28 offset:2048
    ds_read_b64_tr_b16 v[196:197], v29 offset:0
    ds_read_b64_tr_b16 v[198:199], v29 offset:2048
    s_waitcnt lgkmcnt(6)
    v_mfma_f32_16x16x32_bf16 v[120:123], v[184:187], a[80:83], v[120:123]
    ds_read_b64_tr_b16 v[200:201], v26 offset:4096
    ds_read_b64_tr_b16 v[202:203], v26 offset:6144
    s_add_u32 m0, s14, 147456
    s_xor_b32 s58, s59, 0x20000
    buffer_load_dwordx4 v14, s[36:39], s58 offen offset:0  lds
    v_mfma_f32_16x16x32_bf16 v[124:127], v[184:187], a[84:87], v[124:127]
    ds_read_b64_tr_b16 v[204:205], v27 offset:4096
    s_waitcnt lgkmcnt(7)
    v_mfma_f32_16x16x32_bf16 v[128:131], v[188:191], a[80:83], v[128:131]
    ds_read_b64_tr_b16 v[206:207], v27 offset:6144
    v_mfma_f32_16x16x32_bf16 v[132:135], v[188:191], a[84:87], v[132:135]
    ds_read_b64_tr_b16 v[208:209], v28 offset:4096
    ds_read_b64_tr_b16 v[210:211], v28 offset:6144
    s_waitcnt lgkmcnt(8)
    v_mfma_f32_16x16x32_bf16 v[136:139], v[192:195], a[80:83], v[136:139]
    ds_read_b64_tr_b16 v[212:213], v29 offset:4096
    buffer_load_dwordx4 v15, s[36:39], s58 offen offset:1024  lds
    v_mfma_f32_16x16x32_bf16 v[140:143], v[192:195], a[84:87], v[140:143]
    ds_read_b64_tr_b16 v[214:215], v29 offset:6144
    s_waitcnt lgkmcnt(8)
    v_mfma_f32_16x16x32_bf16 v[144:147], v[196:199], a[80:83], v[144:147]
    v_mfma_f32_16x16x32_bf16 v[148:151], v[196:199], a[84:87], v[148:151]
    s_waitcnt lgkmcnt(6)
    v_mfma_f32_16x16x32_bf16 v[120:123], v[200:203], a[88:91], v[120:123]
    buffer_load_dwordx4 v16, s[36:39], s58 offen offset:2048  lds
    v_mfma_f32_16x16x32_bf16 v[124:127], v[200:203], a[92:95], v[124:127]
    s_waitcnt lgkmcnt(4)
    v_mfma_f32_16x16x32_bf16 v[128:131], v[204:207], a[88:91], v[128:131]
    v_mfma_f32_16x16x32_bf16 v[132:135], v[204:207], a[92:95], v[132:135]
    s_waitcnt lgkmcnt(2)
    v_mfma_f32_16x16x32_bf16 v[136:139], v[208:211], a[88:91], v[136:139]
    buffer_load_dwordx4 v17, s[36:39], s58 offen offset:3072  lds
    v_mfma_f32_16x16x32_bf16 v[140:143], v[208:211], a[92:95], v[140:143]
    s_waitcnt lgkmcnt(0)
    v_mfma_f32_16x16x32_bf16 v[144:147], v[212:215], a[88:91], v[144:147]
    v_mfma_f32_16x16x32_bf16 v[148:151], v[212:215], a[92:95], v[148:151]
    s_waitcnt vmcnt(10)
    s_barrier
    ds_read_b64_tr_b16 v[184:185], v26 offset:49152
    ds_read_b64_tr_b16 v[186:187], v26 offset:51200
    ds_read_b64_tr_b16 v[188:189], v27 offset:49152
    ds_read_b64_tr_b16 v[190:191], v27 offset:51200
    ds_read_b64_tr_b16 v[192:193], v28 offset:49152
    ds_read_b64_tr_b16 v[194:195], v28 offset:51200
    ds_read_b64_tr_b16 v[196:197], v29 offset:49152
    ds_read_b64_tr_b16 v[198:199], v29 offset:51200
    s_waitcnt lgkmcnt(6)
    v_mfma_f32_16x16x32_bf16 v[120:123], v[184:187], a[96:99], v[120:123]
    ds_read_b64_tr_b16 v[200:201], v26 offset:53248
    ds_read_b64_tr_b16 v[202:203], v26 offset:55296
    s_add_u32 m0, s14, 114688
    s_xor_b32 s58, s59, 0x80000
    buffer_load_dwordx4 v14, s[36:39], s58 offen offset:0  lds
    v_mfma_f32_16x16x32_bf16 v[124:127], v[184:187], a[100:103], v[124:127]
    ds_read_b64_tr_b16 v[204:205], v27 offset:53248
    s_waitcnt lgkmcnt(7)
    v_mfma_f32_16x16x32_bf16 v[128:131], v[188:191], a[96:99], v[128:131]
    ds_read_b64_tr_b16 v[206:207], v27 offset:55296
    v_mfma_f32_16x16x32_bf16 v[132:135], v[188:191], a[100:103], v[132:135]
    ds_read_b64_tr_b16 v[208:209], v28 offset:53248
    ds_read_b64_tr_b16 v[210:211], v28 offset:55296
    s_waitcnt lgkmcnt(8)
    v_mfma_f32_16x16x32_bf16 v[136:139], v[192:195], a[96:99], v[136:139]
    ds_read_b64_tr_b16 v[212:213], v29 offset:53248
    buffer_load_dwordx4 v15, s[36:39], s58 offen offset:1024  lds
    v_mfma_f32_16x16x32_bf16 v[140:143], v[192:195], a[100:103], v[140:143]
    ds_read_b64_tr_b16 v[214:215], v29 offset:55296
    s_waitcnt lgkmcnt(8)
    v_mfma_f32_16x16x32_bf16 v[144:147], v[196:199], a[96:99], v[144:147]
    v_mfma_f32_16x16x32_bf16 v[148:151], v[196:199], a[100:103], v[148:151]
    s_waitcnt lgkmcnt(6)
    v_mfma_f32_16x16x32_bf16 v[120:123], v[200:203], a[104:107], v[120:123]
    buffer_load_dwordx4 v16, s[36:39], s58 offen offset:2048  lds
    v_mfma_f32_16x16x32_bf16 v[124:127], v[200:203], a[108:111], v[124:127]
    s_waitcnt lgkmcnt(4)
    v_mfma_f32_16x16x32_bf16 v[128:131], v[204:207], a[104:107], v[128:131]
    v_mfma_f32_16x16x32_bf16 v[132:135], v[204:207], a[108:111], v[132:135]
    s_waitcnt lgkmcnt(2)
    v_mfma_f32_16x16x32_bf16 v[136:139], v[208:211], a[104:107], v[136:139]
    buffer_load_dwordx4 v17, s[36:39], s58 offen offset:3072  lds
    v_mfma_f32_16x16x32_bf16 v[140:143], v[208:211], a[108:111], v[140:143]
    s_waitcnt lgkmcnt(0)
    v_mfma_f32_16x16x32_bf16 v[144:147], v[212:215], a[104:107], v[144:147]
    v_mfma_f32_16x16x32_bf16 v[148:151], v[212:215], a[108:111], v[148:151]
    s_waitcnt vmcnt(9)
    s_barrier
    v_add_u32 v26, 0x14000, v26
    v_add_u32 v27, 0x14000, v27
    v_add_u32 v28, 0x14000, v28
    v_add_u32 v29, 0x14000, v29
    ds_read_b64_tr_b16 v[184:185], v26 offset:0
    ds_read_b64_tr_b16 v[186:187], v26 offset:2048
    ds_read_b64_tr_b16 v[188:189], v27 offset:0
    ds_read_b64_tr_b16 v[190:191], v27 offset:2048
    ds_read_b64_tr_b16 v[192:193], v28 offset:0
    ds_read_b64_tr_b16 v[194:195], v28 offset:2048
    ds_read_b64_tr_b16 v[196:197], v29 offset:0
    ds_read_b64_tr_b16 v[198:199], v29 offset:2048
    s_waitcnt lgkmcnt(6)
    v_mfma_f32_16x16x32_bf16 v[120:123], v[184:187], a[112:115], v[120:123]
    ds_read_b64_tr_b16 v[200:201], v26 offset:4096
    ds_read_b64_tr_b16 v[202:203], v26 offset:6144
    v_mfma_f32_16x16x32_bf16 v[124:127], v[184:187], a[116:119], v[124:127]
    ds_read_b64_tr_b16 v[204:205], v27 offset:4096
    s_waitcnt lgkmcnt(7)
    v_mfma_f32_16x16x32_bf16 v[128:131], v[188:191], a[112:115], v[128:131]
    ds_read_b64_tr_b16 v[206:207], v27 offset:6144
    v_mfma_f32_16x16x32_bf16 v[132:135], v[188:191], a[116:119], v[132:135]
    ds_read_b64_tr_b16 v[208:209], v28 offset:4096
    ds_read_b64_tr_b16 v[210:211], v28 offset:6144
    s_waitcnt lgkmcnt(8)
    v_mfma_f32_16x16x32_bf16 v[136:139], v[192:195], a[112:115], v[136:139]
    ds_read_b64_tr_b16 v[212:213], v29 offset:4096
    v_mfma_f32_16x16x32_bf16 v[140:143], v[192:195], a[116:119], v[140:143]
    ds_read_b64_tr_b16 v[214:215], v29 offset:6144
    s_waitcnt lgkmcnt(8)
    v_mfma_f32_16x16x32_bf16 v[144:147], v[196:199], a[112:115], v[144:147]
    v_mfma_f32_16x16x32_bf16 v[148:151], v[196:199], a[116:119], v[148:151]
    s_waitcnt lgkmcnt(6)
    v_mfma_f32_16x16x32_bf16 v[120:123], v[200:203], a[120:123], v[120:123]
    v_mfma_f32_16x16x32_bf16 v[124:127], v[200:203], a[124:127], v[124:127]
    s_waitcnt lgkmcnt(4)
    v_mfma_f32_16x16x32_bf16 v[128:131], v[204:207], a[120:123], v[128:131]
    v_mfma_f32_16x16x32_bf16 v[132:135], v[204:207], a[124:127], v[132:135]
    s_waitcnt lgkmcnt(2)
    v_mfma_f32_16x16x32_bf16 v[136:139], v[208:211], a[120:123], v[136:139]
    v_mfma_f32_16x16x32_bf16 v[140:143], v[208:211], a[124:127], v[140:143]
    s_waitcnt lgkmcnt(0)
    v_mfma_f32_16x16x32_bf16 v[144:147], v[212:215], a[120:123], v[144:147]
    v_mfma_f32_16x16x32_bf16 v[148:151], v[212:215], a[124:127], v[148:151]
    s_xor_b32 s63, s66, 1
    s_lshl_b32 s63, s63, 12
    s_add_u32 s62, s14, 98304
    v_add_u32 v37, s62, v36
    v_mul_f32 v120, v46, v120
    v_mul_f32 v121, v46, v121
    v_mul_f32 v122, v46, v122
    v_mul_f32 v123, v46, v123
    v_mul_f32 v128, v46, v128
    v_mul_f32 v129, v46, v129
    v_mul_f32 v130, v46, v130
    v_mul_f32 v131, v46, v131
    v_cvt_pk_bf16_f32 v168, v120, v121
    v_cvt_pk_bf16_f32 v169, v122, v123
    v_cvt_pk_bf16_f32 v170, v128, v129
    v_cvt_pk_bf16_f32 v171, v130, v131
    v_mul_f32 v124, v47, v124
    v_mul_f32 v125, v47, v125
    v_mul_f32 v126, v47, v126
    v_mul_f32 v127, v47, v127
    v_mul_f32 v132, v47, v132
    v_mul_f32 v133, v47, v133
    v_mul_f32 v134, v47, v134
    v_mul_f32 v135, v47, v135
    v_cvt_pk_bf16_f32 v172, v124, v125
    v_cvt_pk_bf16_f32 v173, v126, v127
    v_cvt_pk_bf16_f32 v174, v132, v133
    v_cvt_pk_bf16_f32 v175, v134, v135
    s_cmp_eq_u32 s70, 0
    s_cbranch_scc1 L_wt_5
    buffer_store_dwordx4 v[168:171], v36, s[40:43], s63 offen offset:0
    buffer_store_dwordx4 v[172:175], v36, s[40:43], s63 offen offset:1024
    s_branch L_wd_5
L_wt_5:
    buffer_store_dwordx4 v[168:171], v36, s[40:43], s63 offen offset:0 sc1
    buffer_store_dwordx4 v[172:175], v36, s[40:43], s63 offen offset:1024 sc1
L_wd_5:
    v_mul_f32 v136, v46, v136
    v_mul_f32 v137, v46, v137
    v_mul_f32 v138, v46, v138
    v_mul_f32 v139, v46, v139
    v_mul_f32 v144, v46, v144
    v_mul_f32 v145, v46, v145
    v_mul_f32 v146, v46, v146
    v_mul_f32 v147, v46, v147
    v_cvt_pk_bf16_f32 v176, v136, v137
    v_cvt_pk_bf16_f32 v177, v138, v139
    v_cvt_pk_bf16_f32 v178, v144, v145
    v_cvt_pk_bf16_f32 v179, v146, v147
    v_mul_f32 v140, v47, v140
    v_mul_f32 v141, v47, v141
    v_mul_f32 v142, v47, v142
    v_mul_f32 v143, v47, v143
    v_mul_f32 v148, v47, v148
    v_mul_f32 v149, v47, v149
    v_mul_f32 v150, v47, v150
    v_mul_f32 v151, v47, v151
    v_cvt_pk_bf16_f32 v180, v140, v141
    v_cvt_pk_bf16_f32 v181, v142, v143
    v_cvt_pk_bf16_f32 v182, v148, v149
    v_cvt_pk_bf16_f32 v183, v150, v151
    s_cmp_eq_u32 s70, 0
    s_cbranch_scc1 L_wt_7
    buffer_store_dwordx4 v[176:179], v36, s[40:43], s63 offen offset:2048
    buffer_store_dwordx4 v[180:183], v36, s[40:43], s63 offen offset:3072
    s_branch L_wd_7
L_wt_7:
    buffer_store_dwordx4 v[176:179], v36, s[40:43], s63 offen offset:2048 sc1
    buffer_store_dwordx4 v[180:183], v36, s[40:43], s63 offen offset:3072 sc1
L_wd_7:
    ds_write_b128 v37, v[168:171] offset:0
    ds_write_b128 v37, v[172:175] offset:1024
    ds_write_b128 v37, v[176:179] offset:2048
    ds_write_b128 v37, v[180:183] offset:3072
    buffer_load_dword v40, v38, s[44:47], 0 offen sc1
    s_waitcnt vmcnt(0)
    v_and_b32 v40, 3, v40
    v_cmp_ne_u32 s[32:33], 0, v40
    v_cmp_eq_u32 s[54:55], 2, v40
    s_nop 0
    s_bitcmp1_b32 s32, 1
    s_cbranch_scc1 L_p1_01_x
    s_mov_b32 s71, 2000000
L_p1_01:
    buffer_load_dword v40, v38, s[44:47], 0 offen sc1
    s_sub_u32 s71, s71, 1
    s_waitcnt vmcnt(0)
    v_and_b32 v40, 3, v40
    v_cmp_ne_u32 s[32:33], 0, v40
    v_cmp_eq_u32 s[54:55], 2, v40
    s_cmp_eq_u32 s71, 0
    s_cbranch_scc1 L_p1_01_x
    s_bitcmp1_b32 s32, 1
    s_cbranch_scc0 L_p1_01
L_p1_01_x:
    s_add_u32 m0, s14, 65536
    s_xor_b32 s57, s56, 0x2000
    buffer_load_dwordx4 v36, s[40:43], s57 offen offset:0 sc1 lds
    buffer_load_dwordx4 v36, s[40:43], s57 offen offset:1024 sc1 lds
    buffer_load_dwordx4 v36, s[40:43], s57 offen offset:2048 sc1 lds
    buffer_load_dwordx4 v36, s[40:43], s57 offen offset:3072 sc1 lds
    s_add_u32 m0, s14, 49152
    s_xor_b32 s58, s59, 0x100000
    buffer_load_dwordx4 v14, s[36:39], s58 offen offset:0  lds
    buffer_load_dwordx4 v15, s[36:39], s58 offen offset:1024  lds
    buffer_load_dwordx4 v16, s[36:39], s58 offen offset:2048  lds
    buffer_load_dwordx4 v17, s[36:39], s58 offen offset:3072  lds
    v_mfma_f32_16x16x32_bf16 v[104:107], a[136:139], v[220:223], v[104:107]
    s_waitcnt lgkmcnt(0)
    s_barrier
    ds_read_b128 v[216:219], v3 offset:32768
    v_mfma_f32_16x16x32_bf16 v[108:111], a[140:143], v[220:223], v[108:111]
    ds_read_b64_tr_b16 a[0:1], v12 offset:49152
    v_bfe_u32 v248, v1, 2, 2
    s_bitcmp1_b32 s32, 2
    s_cbranch_scc1 L_p1_02_x
    s_mov_b32 s71, 2000000
L_p1_02:
    buffer_load_dword v40, v38, s[44:47], 0 offen sc1
    s_sub_u32 s71, s71, 1
    s_waitcnt vmcnt(0)
    v_and_b32 v40, 3, v40
    v_cmp_ne_u32 s[32:33], 0, v40
    v_cmp_eq_u32 s[54:55], 2, v40
    s_cmp_eq_u32 s71, 0
    s_cbranch_scc1 L_p1_02_x
    s_bitcmp1_b32 s32, 2
    s_cbranch_scc0 L_p1_02
L_p1_02_x:
    s_add_u32 m0, s14, 81920
    s_xor_b32 s57, s56, 0x4000
    buffer_load_dwordx4 v36, s[40:43], s57 offen offset:0 sc1 lds
    v_mfma_f32_16x16x32_bf16 v[152:155], a[136:139], v[224:227], v[152:155]
    ds_read_b128 v[220:223], v4 offset:32768
    v_mfma_f32_16x16x32_bf16 v[156:159], a[140:143], v[224:227], v[156:159]
    ds_read_b64_tr_b16 a[2:3], v12 offset:53248
    v_lshrrev_b32 v249, 4, v1
    v_mfma_f32_16x16x32_bf16 v[56:59], a[136:139], v[228:231], v[56:59]
    ds_read_b128 v[224:227], v5 offset:32768
    v_mfma_f32_16x16x32_bf16 v[60:63], a[140:143], v[228:231], v[60:63]
    ds_read_b64_tr_b16 a[4:5], v13 offset:49152
    v_and_b32 v250, 1, v1
    buffer_load_dwordx4 v36, s[40:43], s57 offen offset:1024 sc1 lds
    v_mfma_f32_16x16x32_bf16 v[96:99], a[136:139], v[232:235], v[96:99]
    ds_read_b128 v[228:231], v2 offset:32768
    v_mfma_f32_16x16x32_bf16 v[100:103], a[140:143], v[232:235], v[100:103]
    ds_read_b64_tr_b16 a[6:7], v13 offset:53248
    v_lshlrev_b32 v250, 4, v250
    v_mfma_f32_16x16x32_bf16 v[112:115], a[136:139], v[236:239], v[112:115]
    ds_read_b128 v[232:235], v3 offset:33792
    v_mfma_f32_16x16x32_bf16 v[116:119], a[140:143], v[236:239], v[116:119]
    ds_read_b64_tr_b16 a[8:9], v12 offset:57344
    v_mov_b32 v251, 0x3f80
    buffer_load_dwordx4 v36, s[40:43], s57 offen offset:2048 sc1 lds
    v_mfma_f32_16x16x32_bf16 v[160:163], a[136:139], v[240:243], v[160:163]
    ds_read_b128 v[236:239], v4 offset:33792
    v_mfma_f32_16x16x32_bf16 v[164:167], a[140:143], v[240:243], v[164:167]
    ds_read_b64_tr_b16 a[10:11], v12 offset:61440
    v_lshlrev_b32 v250, v250, v251
    v_mfma_f32_16x16x32_bf16 v[64:67], a[136:139], v[244:247], v[64:67]
    ds_read_b128 v[240:243], v5 offset:33792
    v_mfma_f32_16x16x32_bf16 v[68:71], a[140:143], v[244:247], v[68:71]
    ds_read_b64_tr_b16 a[12:13], v13 offset:57344
    v_cmp_eq_u32 vcc, v248, v249
    buffer_load_dwordx4 v36, s[40:43], s57 offen offset:3072 sc1 lds
    s_waitcnt lgkmcnt(6)
    v_mfma_f32_16x16x32_bf16 v[88:91], a[0:3], v[216:219], v[88:91]
    ds_read_b128 v[244:247], v2 offset:33792
    v_mfma_f32_16x16x32_bf16 v[92:95], a[4:7], v[216:219], v[92:95]
    ds_read_b64_tr_b16 a[14:15], v13 offset:61440
    v_mov_b32 v48, 0
    v_mfma_f32_16x16x32_bf16 v[104:107], a[0:3], v[220:223], v[104:107]
    ds_read_b128 v[216:219], v3 offset:34816
    v_mfma_f32_16x16x32_bf16 v[108:111], a[4:7], v[220:223], v[108:111]
    v_mov_b32 v49, 0
    s_add_u32 m0, s14, 32768
    s_xor_b32 s58, s59, 0x180000
    buffer_load_dwordx4 v14, s[36:39], s58 offen offset:0  lds
    v_mfma_f32_16x16x32_bf16 v[152:155], a[0:3], v[224:227], v[152:155]
    ds_read_b128 v[220:223], v4 offset:34816
    v_mfma_f32_16x16x32_bf16 v[156:159], a[4:7], v[224:227], v[156:159]
    v_cndmask_b32 v250, 0, v250, vcc
    v_mfma_f32_16x16x32_bf16 v[56:59], a[0:3], v[228:231], v[56:59]
    ds_read_b128 v[224:227], v5 offset:34816
    v_mfma_f32_16x16x32_bf16 v[60:63], a[4:7], v[228:231], v[60:63]
    v_and_b32 v248, 2, v1
    buffer_load_dwordx4 v15, s[36:39], s58 offen offset:1024  lds
    s_waitcnt lgkmcnt(4)
    v_mfma_f32_16x16x32_bf16 v[96:99], a[0:3], v[232:235], v[96:99]
    ds_read_b128 v[228:231], v2 offset:34816
    v_mfma_f32_16x16x32_bf16 v[100:103], a[4:7], v[232:235], v[100:103]
    v_cmp_eq_u32 vcc, 0, v248
    v_mfma_f32_16x16x32_bf16 v[112:115], a[0:3], v[236:239], v[112:115]
    ds_read_b128 v[232:235], v3 offset:35840
    v_mfma_f32_16x16x32_bf16 v[116:119], a[4:7], v[236:239], v[116:119]
    v_mov_b32 v52, 0
    buffer_load_dwordx4 v16, s[36:39], s58 offen offset:2048  lds
    v_mfma_f32_16x16x32_bf16 v[160:163], a[0:3], v[240:243], v[160:163]
    ds_read_b128 v[236:239], v4 offset:35840
    v_mfma_f32_16x16x32_bf16 v[164:167], a[4:7], v[240:243], v[164:167]
    v_mov_b32 v53, 0
    v_mfma_f32_16x16x32_bf16 v[64:67], a[0:3], v[244:247], v[64:67]
    ds_read_b128 v[240:243], v5 offset:35840
    v_mfma_f32_16x16x32_bf16 v[68:71], a[4:7], v[244:247], v[68:71]
    v_cndmask_b32 v50, 0, v250, vcc
    buffer_load_dwordx4 v17, s[36:39], s58 offen offset:3072  lds
    s_waitcnt lgkmcnt(3)
    v_mfma_f32_16x16x32_bf16 v[88:91], a[8:11], v[216:219], v[88:91]
    ds_read_b128 v[244:247], v2 offset:35840
    v_mfma_f32_16x16x32_bf16 v[92:95], a[12:15], v[216:219], v[92:95]
    v_sub_u32 v51, v250, v50
    v_mfma_f32_16x16x32_bf16 v[104:107], a[8:11], v[220:223], v[104:107]
    s_waitcnt vmcnt(12)
    s_barrier
    ds_read_b128 v[216:219], v3 offset:0
    v_mfma_f32_16x16x32_bf16 v[108:111], a[12:15], v[220:223], v[108:111]
    ds_read_b64_tr_b16 a[144:145], v10 offset:49152
    s_bitcmp1_b32 s32, 3
    s_cbranch_scc1 L_p1_03_x
    s_mov_b32 s71, 2000000
L_p1_03:
    buffer_load_dword v40, v38, s[44:47], 0 offen sc1
    s_sub_u32 s71, s71, 1
    s_waitcnt vmcnt(0)
    v_and_b32 v40, 3, v40
    v_cmp_ne_u32 s[32:33], 0, v40
    v_cmp_eq_u32 s[54:55], 2, v40
    s_cmp_eq_u32 s71, 0
    s_cbranch_scc1 L_p1_03_x
    s_bitcmp1_b32 s32, 3
    s_cbranch_scc0 L_p1_03
L_p1_03_x:
    s_add_u32 m0, s14, 147456
    s_xor_b32 s57, s56, 0x6000
    buffer_load_dwordx4 v36, s[40:43], s57 offen offset:0 sc1 lds
    v_mfma_f32_16x16x32_bf16 v[152:155], a[8:11], v[224:227], v[152:155]
    ds_read_b128 v[220:223], v4 offset:0
    v_mfma_f32_16x16x32_bf16 v[156:159], a[12:15], v[224:227], v[156:159]
    ds_read_b64_tr_b16 a[146:147], v10 offset:53248
    v_mov_b32 v252, s15
    v_add_u32 v252, 2, v252
    s_mov_b64 exec, 1
    buffer_store_dword v252, v39, s[44:47], 0 offen sc1
    s_mov_b64 exec, -1
    v_mfma_f32_16x16x32_bf16 v[56:59], a[8:11], v[228:231], v[56:59]
    ds_read_b128 v[224:227], v5 offset:0
    v_mfma_f32_16x16x32_bf16 v[60:63], a[12:15], v[228:231], v[60:63]
    ds_read_b64_tr_b16 a[148:149], v11 offset:49152
    buffer_load_dwordx4 v36, s[40:43], s57 offen offset:1024 sc1 lds
    s_waitcnt lgkmcnt(6)
    v_mfma_f32_16x16x32_bf16 v[96:99], a[8:11], v[232:235], v[96:99]
    ds_read_b128 v[228:231], v2 offset:0
    v_mfma_f32_16x16x32_bf16 v[100:103], a[12:15], v[232:235], v[100:103]
    ds_read_b64_tr_b16 a[150:151], v11 offset:53248
    v_mfma_f32_16x16x32_bf16 v[112:115], a[8:11], v[236:239], v[112:115]
    ds_read_b128 v[232:235], v3 offset:1024
    v_mfma_f32_16x16x32_bf16 v[116:119], a[12:15], v[236:239], v[116:119]
    ds_read_b64_tr_b16 a[152:153], v10 offset:57344
    buffer_load_dwordx4 v36, s[40:43], s57 offen offset:2048 sc1 lds
    v_mfma_f32_16x16x32_bf16 v[160:163], a[8:11], v[240:243], v[160:163]
    ds_read_b128 v[236:239], v4 offset:1024
    v_mfma_f32_16x16x32_bf16 v[164:167], a[12:15], v[240:243], v[164:167]
    ds_read_b64_tr_b16 a[154:155], v10 offset:61440
    v_mfma_f32_16x16x32_bf16 v[64:67], a[8:11], v[244:247], v[64:67]
    ds_read_b128 v[240:243], v5 offset:1024
    v_mfma_f32_16x16x32_bf16 v[68:71], a[12:15], v[244:247], v[68:71]
    ds_read_b64_tr_b16 a[156:157], v11 offset:57344
    buffer_load_dwordx4 v36, s[40:43], s57 offen offset:3072 sc1 lds
    s_waitcnt lgkmcnt(6)
    v_mfma_f32_16x16x32_bf16 v[88:91], a[144:147], v[216:219], v[88:91]
    ds_read_b128 v[244:247], v2 offset:1024
    v_mfma_f32_16x16x32_bf16 v[92:95], a[148:151], v[216:219], v[92:95]
    ds_read_b64_tr_b16 a[158:159], v11 offset:61440
    v_mfma_f32_16x16x32_bf16 v[104:107], a[144:147], v[220:223], v[104:107]
    ds_read_b128 v[216:219], v3 offset:2048
    v_mfma_f32_16x16x32_bf16 v[108:111], a[148:151], v[220:223], v[108:111]
    s_add_u32 m0, s14, 131072
    s_xor_b32 s58, s59, 0x400000
    buffer_load_dwordx4 v14, s[36:39], s58 offen offset:0  lds
    v_mfma_f32_16x16x32_bf16 v[152:155], a[144:147], v[224:227], v[152:155]
    ds_read_b128 v[220:223], v4 offset:2048
    v_mfma_f32_16x16x32_bf16 v[156:159], a[148:151], v[224:227], v[156:159]
    v_mfma_f32_16x16x32_bf16 v[56:59], a[144:147], v[228:231], v[56:59]
    ds_read_b128 v[224:227], v5 offset:2048
    v_mfma_f32_16x16x32_bf16 v[60:63], a[148:151], v[228:231], v[60:63]
    buffer_load_dwordx4 v15, s[36:39], s58 offen offset:1024  lds
    s_waitcnt lgkmcnt(4)
    v_mfma_f32_16x16x32_bf16 v[96:99], a[144:147], v[232:235], v[96:99]
    ds_read_b128 v[228:231], v2 offset:2048
    v_mfma_f32_16x16x32_bf16 v[100:103], a[148:151], v[232:235], v[100:103]
    v_mfma_f32_16x16x32_bf16 v[112:115], a[144:147], v[236:239], v[112:115]
    ds_read_b128 v[232:235], v3 offset:3072
    v_mfma_f32_16x16x32_bf16 v[116:119], a[148:151], v[236:239], v[116:119]
    buffer_load_dwordx4 v16, s[36:39], s58 offen offset:2048  lds
    v_mfma_f32_16x16x32_bf16 v[160:163], a[144:147], v[240:243], v[160:163]
    ds_read_b128 v[236:239], v4 offset:3072
    v_mfma_f32_16x16x32_bf16 v[164:167], a[148:151], v[240:243], v[164:167]
    v_mfma_f32_16x16x32_bf16 v[64:67], a[144:147], v[244:247], v[64:67]
    ds_read_b128 v[240:243], v5 offset:3072
    v_mfma_f32_16x16x32_bf16 v[68:71], a[148:151], v[244:247], v[68:71]
    buffer_load_dwordx4 v17, s[36:39], s58 offen offset:3072  lds
    s_waitcnt lgkmcnt(3)
    v_mfma_f32_16x16x32_bf16 v[88:91], a[152:155], v[216:219], v[88:91]
    ds_read_b128 v[244:247], v2 offset:3072
    v_mfma_f32_16x16x32_bf16 v[92:95], a[156:159], v[216:219], v[92:95]
    v_mfma_f32_16x16x32_bf16 v[104:107], a[152:155], v[220:223], v[104:107]
    s_waitcnt vmcnt(13)
    s_barrier
    ds_read_b128 v[216:219], v3 offset:16384
    v_mfma_f32_16x16x32_bf16 v[108:111], a[156:159], v[220:223], v[108:111]
    ds_read_b64_tr_b16 a[160:161], v30 offset:49152
    s_bitcmp1_b32 s32, 4
    s_cbranch_scc1 L_p1_04_x
    s_mov_b32 s71, 2000000
L_p1_04:
    buffer_load_dword v40, v38, s[44:47], 0 offen sc1
    s_sub_u32 s71, s71, 1
    s_waitcnt vmcnt(0)
    v_and_b32 v40, 3, v40
    v_cmp_ne_u32 s[32:33], 0, v40
    v_cmp_eq_u32 s[54:55], 2, v40
    s_cmp_eq_u32 s71, 0
    s_cbranch_scc1 L_p1_04_x
    s_bitcmp1_b32 s32, 4
    s_cbranch_scc0 L_p1_04
L_p1_04_x:
    s_add_u32 m0, s14, 114688
    s_xor_b32 s57, s56, 0x8000
    buffer_load_dwordx4 v36, s[40:43], s57 offen offset:0 sc1 lds
    v_mfma_f32_16x16x32_bf16 v[152:155], a[152:155], v[224:227], v[152:155]
    ds_read_b128 v[220:223], v4 offset:16384
    v_mfma_f32_16x16x32_bf16 v[156:159], a[156:159], v[224:227], v[156:159]
    ds_read_b64_tr_b16 a[162:163], v30 offset:53248
    v_mfma_f32_16x16x32_bf16 v[56:59], a[152:155], v[228:231], v[56:59]
    ds_read_b128 v[224:227], v5 offset:16384
    v_mfma_f32_16x16x32_bf16 v[60:63], a[156:159], v[228:231], v[60:63]
    ds_read_b64_tr_b16 a[164:165], v31 offset:49152
    buffer_load_dwordx4 v36, s[40:43], s57 offen offset:1024 sc1 lds
    s_waitcnt lgkmcnt(6)
    v_mfma_f32_16x16x32_bf16 v[96:99], a[152:155], v[232:235], v[96:99]
    ds_read_b128 v[228:231], v2 offset:16384
    v_mfma_f32_16x16x32_bf16 v[100:103], a[156:159], v[232:235], v[100:103]
    ds_read_b64_tr_b16 a[166:167], v31 offset:53248
    v_mfma_f32_16x16x32_bf16 v[112:115], a[152:155], v[236:239], v[112:115]
    ds_read_b128 v[232:235], v3 offset:17408
    v_mfma_f32_16x16x32_bf16 v[116:119], a[156:159], v[236:239], v[116:119]
    ds_read_b64_tr_b16 a[168:169], v30 offset:57344
    buffer_load_dwordx4 v36, s[40:43], s57 offen offset:2048 sc1 lds
    v_mfma_f32_16x16x32_bf16 v[160:163], a[152:155], v[240:243], v[160:163]
    ds_read_b128 v[236:239], v4 offset:17408
    v_mfma_f32_16x16x32_bf16 v[164:167], a[156:159], v[240:243], v[164:167]
    ds_read_b64_tr_b16 a[170:171], v30 offset:61440
    v_mfma_f32_16x16x32_bf16 v[64:67], a[152:155], v[244:247], v[64:67]
    ds_read_b128 v[240:243], v5 offset:17408
    v_mfma_f32_16x16x32_bf16 v[68:71], a[156:159], v[244:247], v[68:71]
    ds_read_b64_tr_b16 a[172:173], v31 offset:57344
    buffer_load_dwordx4 v36, s[40:43], s57 offen offset:3072 sc1 lds
    s_waitcnt lgkmcnt(6)
    v_mfma_f32_16x16x32_bf16 v[88:91], a[160:163], v[216:219], v[88:91]
    ds_read_b128 v[244:247], v2 offset:17408
    v_mfma_f32_16x16x32_bf16 v[92:95], a[164:167], v[216:219], v[92:95]
    ds_read_b64_tr_b16 a[174:175], v31 offset:61440
    v_mfma_f32_16x16x32_bf16 v[104:107], a[160:163], v[220:223], v[104:107]
    ds_read_b128 v[216:219], v3 offset:18432
    v_mfma_f32_16x16x32_bf16 v[108:111], a[164:167], v[220:223], v[108:111]
    s_add_u32 m0, s14, 98304
    s_xor_b32 s58, s59, 0xa0000
    buffer_load_dwordx4 v14, s[36:39], s58 offen offset:0  lds
    v_mfma_f32_16x16x32_bf16 v[152:155], a[160:163], v[224:227], v[152:155]
    ds_read_b128 v[220:223], v4 offset:18432
    v_mfma_f32_16x16x32_bf16 v[156:159], a[164:167], v[224:227], v[156:159]
    v_mfma_f32_16x16x32_bf16 v[56:59], a[160:163], v[228:231], v[56:59]
    ds_read_b128 v[224:227], v5 offset:18432
    v_mfma_f32_16x16x32_bf16 v[60:63], a[164:167], v[228:231], v[60:63]
    buffer_load_dwordx4 v15, s[36:39], s58 offen offset:1024  lds
    s_waitcnt lgkmcnt(4)
    v_mfma_f32_16x16x32_bf16 v[96:99], a[160:163], v[232:235], v[96:99]
    ds_read_b128 v[228:231], v2 offset:18432
    v_mfma_f32_16x16x32_bf16 v[100:103], a[164:167], v[232:235], v[100:103]
    v_mfma_f32_16x16x32_bf16 v[112:115], a[160:163], v[236:239], v[112:115]
    ds_read_b128 v[232:235], v3 offset:19456
    v_mfma_f32_16x16x32_bf16 v[116:119], a[164:167], v[236:239], v[116:119]
    buffer_load_dwordx4 v16, s[36:39], s58 offen offset:2048  lds
    v_mfma_f32_16x16x32_bf16 v[160:163], a[160:163], v[240:243], v[160:163]
    ds_read_b128 v[236:239], v4 offset:19456
    v_mfma_f32_16x16x32_bf16 v[164:167], a[164:167], v[240:243], v[164:167]
    v_mfma_f32_16x16x32_bf16 v[64:67], a[160:163], v[244:247], v[64:67]
    ds_read_b128 v[240:243], v5 offset:19456
    v_mfma_f32_16x16x32_bf16 v[68:71], a[164:167], v[244:247], v[68:71]
    buffer_load_dwordx4 v17, s[36:39], s58 offen offset:3072  lds
    s_waitcnt lgkmcnt(3)
    v_mfma_f32_16x16x32_bf16 v[88:91], a[168:171], v[216:219], v[88:91]
    ds_read_b128 v[244:247], v2 offset:19456
    v_mfma_f32_16x16x32_bf16 v[92:95], a[172:175], v[216:219], v[92:95]
    v_mfma_f32_16x16x32_bf16 v[104:107], a[168:171], v[220:223], v[104:107]
    s_waitcnt vmcnt(12)
    s_barrier
    ds_read_b128 v[216:219], v7 offset:49152
    v_mfma_f32_16x16x32_bf16 v[108:111], a[172:175], v[220:223], v[108:111]
    ds_read_b64_tr_b16 a[176:177], v30 offset:32768
    s_add_u32 m0, s14, 65536
    s_xor_b32 s58, s59, 0x480000
    buffer_load_dwordx4 v14, s[36:39], s58 offen offset:0  lds
    v_mfma_f32_16x16x32_bf16 v[152:155], a[168:171], v[224:227], v[152:155]
    ds_read_b128 v[220:223], v8 offset:49152
    v_mfma_f32_16x16x32_bf16 v[156:159], a[172:175], v[224:227], v[156:159]
    ds_read_b64_tr_b16 a[178:179], v30 offset:36864
    v_mfma_f32_16x16x32_bf16 v[56:59], a[168:171], v[228:231], v[56:59]
    ds_read_b128 v[224:227], v9 offset:49152
    v_mfma_f32_16x16x32_bf16 v[60:63], a[172:175], v[228:231], v[60:63]
    ds_read_b64_tr_b16 a[180:181], v31 offset:32768
    buffer_load_dwordx4 v15, s[36:39], s58 offen offset:1024  lds
    s_waitcnt lgkmcnt(6)
    v_mfma_f32_16x16x32_bf16 v[96:99], a[168:171], v[232:235], v[96:99]
    ds_read_b128 v[228:231], v6 offset:49152
    v_mfma_f32_16x16x32_bf16 v[100:103], a[172:175], v[232:235], v[100:103]
    ds_read_b64_tr_b16 a[182:183], v31 offset:36864
    v_mfma_f32_16x16x32_bf16 v[112:115], a[168:171], v[236:239], v[112:115]
    ds_read_b128 v[232:235], v7 offset:50176
    v_mfma_f32_16x16x32_bf16 v[116:119], a[172:175], v[236:239], v[116:119]
    ds_read_b64_tr_b16 a[184:185], v30 offset:40960
    buffer_load_dwordx4 v16, s[36:39], s58 offen offset:2048  lds
    v_mfma_f32_16x16x32_bf16 v[160:163], a[168:171], v[240:243], v[160:163]
    ds_read_b128 v[236:239], v8 offset:50176
    v_mfma_f32_16x16x32_bf16 v[164:167], a[172:175], v[240:243], v[164:167]
    ds_read_b64_tr_b16 a[186:187], v30 offset:45056
    v_mfma_f32_16x16x32_bf16 v[64:67], a[168:171], v[244:247], v[64:67]
    ds_read_b128 v[240:243], v9 offset:50176
    v_mfma_f32_16x16x32_bf16 v[68:71], a[172:175], v[244:247], v[68:71]
    ds_read_b64_tr_b16 a[188:189], v31 offset:40960
    buffer_load_dwordx4 v17, s[36:39], s58 offen offset:3072  lds
    s_waitcnt lgkmcnt(6)
    v_mfma_f32_16x16x32_bf16 v[88:91], a[176:179], v[216:219], v[88:91]
    ds_read_b128 v[244:247], v6 offset:50176
    v_mfma_f32_16x16x32_bf16 v[92:95], a[180:183], v[216:219], v[92:95]
    ds_read_b64_tr_b16 a[190:191], v31 offset:45056
    v_mfma_f32_16x16x32_bf16 v[104:107], a[176:179], v[220:223], v[104:107]
    ds_read_b128 v[216:219], v7 offset:51200
    v_mfma_f32_16x16x32_bf16 v[108:111], a[180:183], v[220:223], v[108:111]
    s_bitcmp1_b32 s32, 5
    s_cbranch_scc1 L_p1_05_x
    s_mov_b32 s71, 2000000
L_p1_05:
    buffer_load_dword v40, v38, s[44:47], 0 offen sc1
    s_sub_u32 s71, s71, 1
    s_waitcnt vmcnt(0)
    v_and_b32 v40, 3, v40
    v_cmp_ne_u32 s[32:33], 0, v40
    v_cmp_eq_u32 s[54:55], 2, v40
    s_cmp_eq_u32 s71, 0
    s_cbranch_scc1 L_p1_05_x
    s_bitcmp1_b32 s32, 5
    s_cbranch_scc0 L_p1_05
L_p1_05_x:
    s_add_u32 m0, s14, 49152
    s_xor_b32 s57, s56, 0xa000
    buffer_load_dwordx4 v36, s[40:43], s57 offen offset:0 sc1 lds
    v_mfma_f32_16x16x32_bf16 v[152:155], a[176:179], v[224:227], v[152:155]
    ds_read_b128 v[220:223], v8 offset:51200
    v_mfma_f32_16x16x32_bf16 v[156:159], a[180:183], v[224:227], v[156:159]
    v_mfma_f32_16x16x32_bf16 v[56:59], a[176:179], v[228:231], v[56:59]
    ds_read_b128 v[224:227], v9 offset:51200
    v_mfma_f32_16x16x32_bf16 v[60:63], a[180:183], v[228:231], v[60:63]
    buffer_load_dwordx4 v36, s[40:43], s57 offen offset:1024 sc1 lds
    s_waitcnt lgkmcnt(4)
    v_mfma_f32_16x16x32_bf16 v[96:99], a[176:179], v[232:235], v[96:99]
    ds_read_b128 v[228:231], v6 offset:51200
    v_mfma_f32_16x16x32_bf16 v[100:103], a[180:183], v[232:235], v[100:103]
    v_mfma_f32_16x16x32_bf16 v[112:115], a[176:179], v[236:239], v[112:115]
    ds_read_b128 v[232:235], v7 offset:52224
    v_mfma_f32_16x16x32_bf16 v[116:119], a[180:183], v[236:239], v[116:119]
    buffer_load_dwordx4 v36, s[40:43], s57 offen offset:2048 sc1 lds
    v_mfma_f32_16x16x32_bf16 v[160:163], a[176:179], v[240:243], v[160:163]
    ds_read_b128 v[236:239], v8 offset:52224
    v_mfma_f32_16x16x32_bf16 v[164:167], a[180:183], v[240:243], v[164:167]
    v_mfma_f32_16x16x32_bf16 v[64:67], a[176:179], v[244:247], v[64:67]
    ds_read_b128 v[240:243], v9 offset:52224
    v_mfma_f32_16x16x32_bf16 v[68:71], a[180:183], v[244:247], v[68:71]
    buffer_load_dwordx4 v36, s[40:43], s57 offen offset:3072 sc1 lds
    s_waitcnt lgkmcnt(3)
    v_mfma_f32_16x16x32_bf16 v[88:91], a[184:187], v[216:219], v[88:91]
    ds_read_b128 v[244:247], v6 offset:52224
    v_mfma_f32_16x16x32_bf16 v[92:95], a[188:191], v[216:219], v[92:95]
    v_mfma_f32_16x16x32_bf16 v[104:107], a[184:187], v[220:223], v[104:107]
    s_waitcnt vmcnt(12)
    s_barrier
    ds_read_b128 v[216:219], v3 offset:49152
    v_mfma_f32_16x16x32_bf16 v[108:111], a[188:191], v[220:223], v[108:111]
    ds_read_b64_tr_b16 a[192:193], v12 offset:32768
    buffer_load_dword v40, v38, s[44:47], 0 offen sc1
    v_mfma_f32_16x16x32_bf16 v[152:155], a[184:187], v[224:227], v[152:155]
    ds_read_b128 v[220:223], v4 offset:49152
    v_mfma_f32_16x16x32_bf16 v[156:159], a[188:191], v[224:227], v[156:159]
    ds_read_b64_tr_b16 a[194:195], v12 offset:36864
    s_add_u32 m0, s14, 81920
    s_xor_b32 s58, s59, 0x500000
    buffer_load_dwordx4 v14, s[36:39], s58 offen offset:0  lds
    v_mfma_f32_16x16x32_bf16 v[56:59], a[184:187], v[228:231], v[56:59]
    ds_read_b128 v[224:227], v5 offset:49152
    v_mfma_f32_16x16x32_bf16 v[60:63], a[188:191], v[228:231], v[60:63]
    ds_read_b64_tr_b16 a[196:197], v13 offset:32768
    s_waitcnt lgkmcnt(6)
    v_mfma_f32_16x16x32_bf16 v[96:99], a[184:187], v[232:235], v[96:99]
    ds_read_b128 v[228:231], v2 offset:49152
    v_mfma_f32_16x16x32_bf16 v[100:103], a[188:191], v[232:235], v[100:103]
    ds_read_b64_tr_b16 a[198:199], v13 offset:36864
    buffer_load_dwordx4 v15, s[36:39], s58 offen offset:1024  lds
    v_mfma_f32_16x16x32_bf16 v[112:115], a[184:187], v[236:239], v[112:115]
    ds_read_b128 v[232:235], v3 offset:50176
    v_mfma_f32_16x16x32_bf16 v[116:119], a[188:191], v[236:239], v[116:119]
    ds_read_b64_tr_b16 a[200:201], v12 offset:40960
    v_mfma_f32_16x16x32_bf16 v[160:163], a[184:187], v[240:243], v[160:163]
    ds_read_b128 v[236:239], v4 offset:50176
    v_mfma_f32_16x16x32_bf16 v[164:167], a[188:191], v[240:243], v[164:167]
    ds_read_b64_tr_b16 a[202:203], v12 offset:45056
    buffer_load_dwordx4 v16, s[36:39], s58 offen offset:2048  lds
    v_mfma_f32_16x16x32_bf16 v[64:67], a[184:187], v[244:247], v[64:67]
    ds_read_b128 v[240:243], v5 offset:50176
    v_mfma_f32_16x16x32_bf16 v[68:71], a[188:191], v[244:247], v[68:71]
    ds_read_b64_tr_b16 a[204:205], v13 offset:40960
    s_waitcnt lgkmcnt(6)
    v_mfma_f32_16x16x32_bf16 v[88:91], a[192:195], v[216:219], v[88:91]
    ds_read_b128 v[244:247], v2 offset:50176
    v_mfma_f32_16x16x32_bf16 v[92:95], a[196:199], v[216:219], v[92:95]
    ds_read_b64_tr_b16 a[206:207], v13 offset:45056
    buffer_load_dwordx4 v17, s[36:39], s58 offen offset:3072  lds
    v_mfma_f32_16x16x32_bf16 v[104:107], a[192:195], v[220:223], v[104:107]
    ds_read_b128 v[216:219], v3 offset:51200
    v_mfma_f32_16x16x32_bf16 v[108:111], a[196:199], v[220:223], v[108:111]
    s_bitcmp1_b32 s32, 6
    s_cbranch_scc1 L_p1_06_x
    s_mov_b32 s71, 2000000
L_p1_06:
    buffer_load_dword v40, v38, s[44:47], 0 offen sc1
    s_sub_u32 s71, s71, 1
    s_waitcnt vmcnt(0)
    v_and_b32 v40, 3, v40
    v_cmp_ne_u32 s[32:33], 0, v40
    v_cmp_eq_u32 s[54:55], 2, v40
    s_cmp_eq_u32 s71, 0
    s_cbranch_scc1 L_p1_06_x
    s_bitcmp1_b32 s32, 6
    s_cbranch_scc0 L_p1_06
L_p1_06_x:
    s_add_u32 m0, s14, 32768
    s_xor_b32 s57, s56, 0xc000
    buffer_load_dwordx4 v36, s[40:43], s57 offen offset:0 sc1 lds
    v_mfma_f32_16x16x32_bf16 v[152:155], a[192:195], v[224:227], v[152:155]
    ds_read_b128 v[220:223], v4 offset:51200
    v_mfma_f32_16x16x32_bf16 v[156:159], a[196:199], v[224:227], v[156:159]
    v_mfma_f32_16x16x32_bf16 v[56:59], a[192:195], v[228:231], v[56:59]
    ds_read_b128 v[224:227], v5 offset:51200
    v_mfma_f32_16x16x32_bf16 v[60:63], a[196:199], v[228:231], v[60:63]
    buffer_load_dwordx4 v36, s[40:43], s57 offen offset:1024 sc1 lds
    s_waitcnt lgkmcnt(4)
    v_mfma_f32_16x16x32_bf16 v[96:99], a[192:195], v[232:235], v[96:99]
    ds_read_b128 v[228:231], v2 offset:51200
    v_mfma_f32_16x16x32_bf16 v[100:103], a[196:199], v[232:235], v[100:103]
    v_mfma_f32_16x16x32_bf16 v[112:115], a[192:195], v[236:239], v[112:115]
    ds_read_b128 v[232:235], v3 offset:52224
    v_mfma_f32_16x16x32_bf16 v[116:119], a[196:199], v[236:239], v[116:119]
    buffer_load_dwordx4 v36, s[40:43], s57 offen offset:2048 sc1 lds
    v_mfma_f32_16x16x32_bf16 v[160:163], a[192:195], v[240:243], v[160:163]
    ds_read_b128 v[236:239], v4 offset:52224
    v_mfma_f32_16x16x32_bf16 v[164:167], a[196:199], v[240:243], v[164:167]
    v_mfma_f32_16x16x32_bf16 v[64:67], a[192:195], v[244:247], v[64:67]
    ds_read_b128 v[240:243], v5 offset:52224
    v_mfma_f32_16x16x32_bf16 v[68:71], a[196:199], v[244:247], v[68:71]
    buffer_load_dwordx4 v36, s[40:43], s57 offen offset:3072 sc1 lds
    s_waitcnt lgkmcnt(3)
    v_mfma_f32_16x16x32_bf16 v[88:91], a[200:203], v[216:219], v[88:91]
    ds_read_b128 v[244:247], v2 offset:52224
    v_mfma_f32_16x16x32_bf16 v[92:95], a[204:207], v[216:219], v[92:95]
    v_mfma_f32_16x16x32_bf16 v[104:107], a[200:203], v[220:223], v[104:107]
    s_waitcnt vmcnt(9)
    s_barrier
    ds_read_b128 v[216:219], v33 offset:49152
    v_mfma_f32_16x16x32_bf16 v[108:111], a[204:207], v[220:223], v[108:111]
    ds_read_b64_tr_b16 a[208:209], v10 offset:0
    ds_read_b64_tr_b16 a[210:211], v10 offset:4096
    s_add_u32 m0, s14, 147456
    s_xor_b32 s58, s59, 0x580000
    buffer_load_dwordx4 v14, s[36:39], s58 offen offset:0  lds
    v_mfma_f32_16x16x32_bf16 v[152:155], a[200:203], v[224:227], v[152:155]
    ds_read_b128 v[220:223], v34 offset:49152
    v_mfma_f32_16x16x32_bf16 v[156:159], a[204:207], v[224:227], v[156:159]
    ds_read_b64_tr_b16 a[212:213], v11 offset:0
    buffer_load_dwordx4 v15, s[36:39], s58 offen offset:1024  lds
    v_mfma_f32_16x16x32_bf16 v[56:59], a[200:203], v[228:231], v[56:59]
    ds_read_b128 v[224:227], v35 offset:49152
    ds_read_b128 v[72:75], v32 offset:49152
    v_mfma_f32_16x16x32_bf16 v[60:63], a[204:207], v[228:231], v[60:63]
    ds_read_b64_tr_b16 a[214:215], v11 offset:4096
    s_waitcnt lgkmcnt(8)
    v_mfma_f32_16x16x32_bf16 v[96:99], a[200:203], v[232:235], v[96:99]
    ds_read_b128 v[228:231], v33 offset:50176
    v_mfma_f32_16x16x32_bf16 v[100:103], a[204:207], v[232:235], v[100:103]
    ds_read_b64_tr_b16 a[216:217], v10 offset:8192
    ds_read_b64_tr_b16 a[218:219], v10 offset:12288
    buffer_load_dwordx4 v16, s[36:39], s58 offen offset:2048  lds
    v_mfma_f32_16x16x32_bf16 v[112:115], a[200:203], v[236:239], v[112:115]
    ds_read_b128 v[232:235], v34 offset:50176
    v_mfma_f32_16x16x32_bf16 v[116:119], a[204:207], v[236:239], v[116:119]
    ds_read_b64_tr_b16 a[220:221], v11 offset:8192
    buffer_load_dwordx4 v17, s[36:39], s58 offen offset:3072  lds
    v_mfma_f32_16x16x32_bf16 v[160:163], a[200:203], v[240:243], v[160:163]
    ds_read_b128 v[236:239], v35 offset:50176
    ds_read_b128 v[76:79], v32 offset:50176
    v_mfma_f32_16x16x32_bf16 v[164:167], a[204:207], v[240:243], v[164:167]
    ds_read_b64_tr_b16 a[222:223], v11 offset:12288
    v_mfma_f32_16x16x32_bf16 v[64:67], a[200:203], v[244:247], v[64:67]
    ds_read_b128 v[240:243], v33 offset:51200
    v_mfma_f32_16x16x32_bf16 v[68:71], a[204:207], v[244:247], v[68:71]
    ds_read_b64_tr_b16 a[16:17], v10 offset:32768
    ds_read_b64_tr_b16 a[18:19], v10 offset:36864
    s_bitcmp1_b32 s32, 7
    s_cbranch_scc1 L_p1_07_x
    s_mov_b32 s71, 2000000
L_p1_07:
    buffer_load_dword v40, v38, s[44:47], 0 offen sc1
    s_sub_u32 s71, s71, 1
    s_waitcnt vmcnt(0)
    v_and_b32 v40, 3, v40
    v_cmp_ne_u32 s[32:33], 0, v40
    v_cmp_eq_u32 s[54:55], 2, v40
    s_cmp_eq_u32 s71, 0
    s_cbranch_scc1 L_p1_07_x
    s_bitcmp1_b32 s32, 7
    s_cbranch_scc0 L_p1_07
L_p1_07_x:
    s_add_u32 m0, s14, 131072
    s_xor_b32 s57, s56, 0xe000
    buffer_load_dwordx4 v36, s[40:43], s57 offen offset:0 sc1 lds
    s_waitcnt lgkmcnt(10)
    v_mfma_f32_16x16x32_bf16 v[88:91], a[208:211], v[216:219], v[88:91]
    ds_read_b128 v[244:247], v34 offset:51200
    v_mfma_f32_16x16x32_bf16 v[92:95], a[212:215], v[216:219], v[92:95]
    ds_read_b64_tr_b16 a[20:21], v11 offset:32768
    buffer_load_dwordx4 v36, s[40:43], s57 offen offset:1024 sc1 lds
    v_mfma_f32_16x16x32_bf16 v[104:107], a[208:211], v[220:223], v[104:107]
    ds_read_b128 v[216:219], v35 offset:51200
    ds_read_b128 v[80:83], v32 offset:51200
    v_mfma_f32_16x16x32_bf16 v[108:111], a[212:215], v[220:223], v[108:111]
    ds_read_b64_tr_b16 a[22:23], v11 offset:36864
    v_mfma_f32_16x16x32_bf16 v[152:155], a[208:211], v[224:227], v[152:155]
    ds_read_b128 v[220:223], v33 offset:52224
    v_mfma_f32_16x16x32_bf16 v[156:159], a[212:215], v[224:227], v[156:159]
    ds_read_b64_tr_b16 a[24:25], v10 offset:40960
    ds_read_b64_tr_b16 a[26:27], v10 offset:45056
    buffer_load_dwordx4 v36, s[40:43], s57 offen offset:2048 sc1 lds
    v_mfma_f32_16x16x32_bf16 v[96:99], a[208:211], v[228:231], v[96:99]
    ds_read_b128 v[224:227], v34 offset:52224
    v_mfma_f32_16x16x32_bf16 v[100:103], a[212:215], v[228:231], v[100:103]
    ds_read_b64_tr_b16 a[28:29], v11 offset:40960
    buffer_load_dwordx4 v36, s[40:43], s57 offen offset:3072 sc1 lds
    s_waitcnt lgkmcnt(9)
    v_mfma_f32_16x16x32_bf16 v[112:115], a[208:211], v[232:235], v[112:115]
    ds_read_b128 v[228:231], v35 offset:52224
    ds_read_b128 v[84:87], v32 offset:52224
    v_mfma_f32_16x16x32_bf16 v[116:119], a[212:215], v[232:235], v[116:119]
    ds_read_b64_tr_b16 a[30:31], v11 offset:45056
    v_mfma_f32_16x16x32_bf16 v[160:163], a[208:211], v[236:239], v[160:163]
    s_waitcnt vmcnt(8) lgkmcnt(0)
    s_barrier
    ds_read_b128 v[232:235], v33 offset:32768
    v_mfma_f32_16x16x32_bf16 v[164:167], a[212:215], v[236:239], v[164:167]
    ds_read_b64_tr_b16 a[224:225], v10 offset:16384
    s_add_u32 m0, s14, 114688
    s_xor_b32 s58, s59, 0x120000
    buffer_load_dwordx4 v14, s[36:39], s58 offen offset:0  lds
    v_mfma_f32_16x16x32_bf16 v[88:91], a[216:219], v[240:243], v[88:91]
    ds_read_b128 v[236:239], v34 offset:32768
    v_mfma_f32_16x16x32_bf16 v[92:95], a[220:223], v[240:243], v[92:95]
    ds_read_b64_tr_b16 a[226:227], v10 offset:20480
    buffer_load_dwordx4 v15, s[36:39], s58 offen offset:1024  lds
    v_mfma_f32_16x16x32_bf16 v[104:107], a[216:219], v[244:247], v[104:107]
    ds_read_b128 v[240:243], v35 offset:32768
    ds_read_b128 v[184:187], v32 offset:32768
    v_mfma_f32_16x16x32_bf16 v[108:111], a[220:223], v[244:247], v[108:111]
    ds_read_b64_tr_b16 a[228:229], v11 offset:16384
    v_mfma_f32_16x16x32_bf16 v[152:155], a[216:219], v[216:219], v[152:155]
    ds_read_b128 v[244:247], v33 offset:33792
    v_mfma_f32_16x16x32_bf16 v[156:159], a[220:223], v[216:219], v[156:159]
    ds_read_b64_tr_b16 a[230:231], v11 offset:20480
    buffer_load_dwordx4 v16, s[36:39], s58 offen offset:2048  lds
    v_mfma_f32_16x16x32_bf16 v[96:99], a[216:219], v[220:223], v[96:99]
    ds_read_b128 v[216:219], v34 offset:33792
    v_mfma_f32_16x16x32_bf16 v[100:103], a[220:223], v[220:223], v[100:103]
    ds_read_b64_tr_b16 a[232:233], v10 offset:24576
    buffer_load_dwordx4 v17, s[36:39], s58 offen offset:3072  lds
    v_mfma_f32_16x16x32_bf16 v[112:115], a[216:219], v[224:227], v[112:115]
    ds_read_b128 v[220:223], v35 offset:33792
    ds_read_b128 v[188:191], v32 offset:33792
    v_mfma_f32_16x16x32_bf16 v[116:119], a[220:223], v[224:227], v[116:119]
    ds_read_b64_tr_b16 a[234:235], v10 offset:28672
    v_mfma_f32_16x16x32_bf16 v[160:163], a[216:219], v[228:231], v[160:163]
    ds_read_b128 v[224:227], v33 offset:34816
    v_mfma_f32_16x16x32_bf16 v[164:167], a[220:223], v[228:231], v[164:167]
    ds_read_b64_tr_b16 a[236:237], v11 offset:24576
    v_and_b32 v40, 3, v40
    v_cmp_ne_u32 s[32:33], 0, v40
    v_cmp_eq_u32 s[54:55], 2, v40
    s_nop 1
    s_bitcmp1_b32 s54, 1
    s_cbranch_scc1 L_p1_11_x
    s_mov_b32 s71, 2000000
L_p1_11:
    buffer_load_dword v40, v38, s[44:47], 0 offen sc1
    s_sub_u32 s71, s71, 1
    s_waitcnt vmcnt(0)
    v_and_b32 v40, 3, v40
    v_cmp_ne_u32 s[32:33], 0, v40
    v_cmp_eq_u32 s[54:55], 2, v40
    s_cmp_eq_u32 s71, 0
    s_cbranch_scc1 L_p1_11_x
    s_bitcmp1_b32 s54, 1
    s_cbranch_scc0 L_p1_11
L_p1_11_x:
    s_add_u32 m0, s14, 98304
    s_xor_b32 s57, s56, 0x3000
    buffer_load_dwordx4 v36, s[40:43], s57 offen offset:0 sc1 lds
    s_waitcnt lgkmcnt(7)
    v_mfma_f32_16x16x32_bf16 v[88:91], a[224:227], v[232:235], v[88:91]
    ds_read_b128 v[228:231], v34 offset:34816
    v_mfma_f32_16x16x32_bf16 v[92:95], a[228:231], v[232:235], v[92:95]
    ds_read_b64_tr_b16 a[238:239], v11 offset:28672
    buffer_load_dwordx4 v36, s[40:43], s57 offen offset:1024 sc1 lds
    v_mfma_f32_16x16x32_bf16 v[104:107], a[224:227], v[236:239], v[104:107]
    ds_read_b128 v[232:235], v35 offset:34816
    ds_read_b128 v[192:195], v32 offset:34816
    v_mfma_f32_16x16x32_bf16 v[108:111], a[228:231], v[236:239], v[108:111]
    v_mfma_f32_16x16x32_bf16 v[152:155], a[224:227], v[240:243], v[152:155]
    ds_read_b128 v[236:239], v33 offset:35840
    v_mfma_f32_16x16x32_bf16 v[156:159], a[228:231], v[240:243], v[156:159]
    buffer_load_dwordx4 v36, s[40:43], s57 offen offset:2048 sc1 lds
    v_mfma_f32_16x16x32_bf16 v[96:99], a[224:227], v[244:247], v[96:99]
    ds_read_b128 v[240:243], v34 offset:35840
    v_mfma_f32_16x16x32_bf16 v[100:103], a[228:231], v[244:247], v[100:103]
    buffer_load_dwordx4 v36, s[40:43], s57 offen offset:3072 sc1 lds
    s_waitcnt lgkmcnt(4)
    v_mfma_f32_16x16x32_bf16 v[112:115], a[224:227], v[216:219], v[112:115]
    ds_read_b128 v[244:247], v35 offset:35840
    ds_read_b128 v[196:199], v32 offset:35840
    v_mfma_f32_16x16x32_bf16 v[116:119], a[228:231], v[216:219], v[116:119]
    v_mfma_f32_16x16x32_bf16 v[160:163], a[224:227], v[220:223], v[160:163]
    s_waitcnt vmcnt(8)
    s_barrier
    ds_read_b128 v[216:219], v7 offset:32768
    v_mfma_f32_16x16x32_bf16 v[164:167], a[228:231], v[220:223], v[164:167]
    ds_read_b64_tr_b16 a[240:241], v12 offset:49152
    s_bitcmp1_b32 s54, 2
    s_cbranch_scc1 L_p1_12_x
    s_mov_b32 s71, 2000000
L_p1_12:
    buffer_load_dword v40, v38, s[44:47], 0 offen sc1
    s_sub_u32 s71, s71, 1
    s_waitcnt vmcnt(0)
    v_and_b32 v40, 3, v40
    v_cmp_ne_u32 s[32:33], 0, v40
    v_cmp_eq_u32 s[54:55], 2, v40
    s_cmp_eq_u32 s71, 0
    s_cbranch_scc1 L_p1_12_x
    s_bitcmp1_b32 s54, 2
    s_cbranch_scc0 L_p1_12
L_p1_12_x:
    s_add_u32 m0, s14, 81920
    s_xor_b32 s57, s56, 0x5000
    buffer_load_dwordx4 v36, s[40:43], s57 offen offset:0 sc1 lds
    v_mfma_f32_16x16x32_bf16 v[88:91], a[232:235], v[224:227], v[88:91]
    ds_read_b128 v[220:223], v8 offset:32768
    v_mfma_f32_16x16x32_bf16 v[92:95], a[236:239], v[224:227], v[92:95]
    ds_read_b64_tr_b16 a[242:243], v12 offset:53248
    buffer_load_dwordx4 v36, s[40:43], s57 offen offset:1024 sc1 lds
    v_mfma_f32_16x16x32_bf16 v[104:107], a[232:235], v[228:231], v[104:107]
    ds_read_b128 v[224:227], v9 offset:32768
    ds_read_b128 v[200:203], v6 offset:32768
    v_mfma_f32_16x16x32_bf16 v[108:111], a[236:239], v[228:231], v[108:111]
    ds_read_b64_tr_b16 a[244:245], v13 offset:49152
    s_waitcnt lgkmcnt(8)
    v_mfma_f32_16x16x32_bf16 v[152:155], a[232:235], v[232:235], v[152:155]
    ds_read_b128 v[228:231], v7 offset:33792
    v_mfma_f32_16x16x32_bf16 v[156:159], a[236:239], v[232:235], v[156:159]
    ds_read_b64_tr_b16 a[246:247], v13 offset:53248
    buffer_load_dwordx4 v36, s[40:43], s57 offen offset:2048 sc1 lds
    v_mfma_f32_16x16x32_bf16 v[96:99], a[232:235], v[236:239], v[96:99]
    ds_read_b128 v[232:235], v8 offset:33792
    v_mfma_f32_16x16x32_bf16 v[100:103], a[236:239], v[236:239], v[100:103]
    ds_read_b64_tr_b16 a[248:249], v12 offset:57344
    buffer_load_dwordx4 v36, s[40:43], s57 offen offset:3072 sc1 lds
    v_mfma_f32_16x16x32_bf16 v[112:115], a[232:235], v[240:243], v[112:115]
    ds_read_b128 v[236:239], v9 offset:33792
    ds_read_b128 v[204:207], v6 offset:33792
    v_mfma_f32_16x16x32_bf16 v[116:119], a[236:239], v[240:243], v[116:119]
    ds_read_b64_tr_b16 a[250:251], v12 offset:61440
    v_mfma_f32_16x16x32_bf16 v[160:163], a[232:235], v[244:247], v[160:163]
    ds_read_b128 v[240:243], v7 offset:34816
    v_mfma_f32_16x16x32_bf16 v[164:167], a[236:239], v[244:247], v[164:167]
    ds_read_b64_tr_b16 a[252:253], v13 offset:57344
    s_add_u32 m0, s14, 65536
    s_xor_b32 s58, s59, 0x1a0000
    buffer_load_dwordx4 v14, s[36:39], s58 offen offset:0  lds
    s_waitcnt lgkmcnt(7)
    v_mfma_f32_16x16x32_bf16 v[88:91], a[240:243], v[216:219], v[88:91]
    ds_read_b128 v[244:247], v8 offset:34816
    v_mfma_f32_16x16x32_bf16 v[92:95], a[244:247], v[216:219], v[92:95]
    ds_read_b64_tr_b16 a[254:255], v13 offset:61440
    buffer_load_dwordx4 v15, s[36:39], s58 offen offset:1024  lds
    v_mfma_f32_16x16x32_bf16 v[104:107], a[240:243], v[220:223], v[104:107]
    ds_read_b128 v[216:219], v9 offset:34816
    ds_read_b128 v[208:211], v6 offset:34816
    v_mfma_f32_16x16x32_bf16 v[108:111], a[244:247], v[220:223], v[108:111]
    v_mfma_f32_16x16x32_bf16 v[152:155], a[240:243], v[224:227], v[152:155]
    ds_read_b128 v[220:223], v7 offset:35840
    v_mfma_f32_16x16x32_bf16 v[156:159], a[244:247], v[224:227], v[156:159]
    buffer_load_dwordx4 v16, s[36:39], s58 offen offset:2048  lds
    v_mfma_f32_16x16x32_bf16 v[96:99], a[240:243], v[228:231], v[96:99]
    ds_read_b128 v[224:227], v8 offset:35840
    v_mfma_f32_16x16x32_bf16 v[100:103], a[244:247], v[228:231], v[100:103]
    buffer_load_dwordx4 v17, s[36:39], s58 offen offset:3072  lds
    s_waitcnt lgkmcnt(4)
    v_mfma_f32_16x16x32_bf16 v[112:115], a[240:243], v[232:235], v[112:115]
    ds_read_b128 v[228:231], v9 offset:35840
    ds_read_b128 v[212:215], v6 offset:35840
    v_mfma_f32_16x16x32_bf16 v[116:119], a[244:247], v[232:235], v[116:119]
    v_mfma_f32_16x16x32_bf16 v[160:163], a[240:243], v[236:239], v[160:163]
    s_waitcnt vmcnt(8)
    s_barrier
    ds_read_b128 v[232:235], v3 offset:32768
    v_mfma_f32_16x16x32_bf16 v[164:167], a[244:247], v[236:239], v[164:167]
    ds_read_b64_tr_b16 a[32:33], v10 offset:49152
    s_bitcmp1_b32 s54, 3
    s_cbranch_scc1 L_p1_13_x
    s_mov_b32 s71, 2000000
L_p1_13:
    buffer_load_dword v40, v38, s[44:47], 0 offen sc1
    s_sub_u32 s71, s71, 1
    s_waitcnt vmcnt(0)
    v_and_b32 v40, 3, v40
    v_cmp_ne_u32 s[32:33], 0, v40
    v_cmp_eq_u32 s[54:55], 2, v40
    s_cmp_eq_u32 s71, 0
    s_cbranch_scc1 L_p1_13_x
    s_bitcmp1_b32 s54, 3
    s_cbranch_scc0 L_p1_13
L_p1_13_x:
    s_add_u32 m0, s14, 147456
    s_xor_b32 s57, s56, 0x7000
    buffer_load_dwordx4 v36, s[40:43], s57 offen offset:0 sc1 lds
    v_mfma_f32_16x16x32_bf16 v[88:91], a[248:251], v[240:243], v[88:91]
    ds_read_b128 v[236:239], v4 offset:32768
    v_mfma_f32_16x16x32_bf16 v[92:95], a[252:255], v[240:243], v[92:95]
    ds_read_b64_tr_b16 a[34:35], v10 offset:53248
    buffer_load_dwordx4 v36, s[40:43], s57 offen offset:1024 sc1 lds
    v_mfma_f32_16x16x32_bf16 v[104:107], a[248:251], v[244:247], v[104:107]
    ds_read_b128 v[240:243], v5 offset:32768
    ds_read_b128 v[120:123], v2 offset:32768
    v_mfma_f32_16x16x32_bf16 v[108:111], a[252:255], v[244:247], v[108:111]
    ds_read_b64_tr_b16 a[36:37], v11 offset:49152
    s_waitcnt lgkmcnt(8)
    v_mfma_f32_16x16x32_bf16 v[152:155], a[248:251], v[216:219], v[152:155]
    ds_read_b128 v[244:247], v3 offset:33792
    v_mfma_f32_16x16x32_bf16 v[156:159], a[252:255], v[216:219], v[156:159]
    ds_read_b64_tr_b16 a[38:39], v11 offset:53248
    buffer_load_dwordx4 v36, s[40:43], s57 offen offset:2048 sc1 lds
    v_mfma_f32_16x16x32_bf16 v[96:99], a[248:251], v[220:223], v[96:99]
    ds_read_b128 v[216:219], v4 offset:33792
    v_mfma_f32_16x16x32_bf16 v[100:103], a[252:255], v[220:223], v[100:103]
    ds_read_b64_tr_b16 a[40:41], v10 offset:57344
    buffer_load_dwordx4 v36, s[40:43], s57 offen offset:3072 sc1 lds
    v_mfma_f32_16x16x32_bf16 v[112:115], a[248:251], v[224:227], v[112:115]
    ds_read_b128 v[220:223], v5 offset:33792
    ds_read_b128 v[124:127], v2 offset:33792
    v_mfma_f32_16x16x32_bf16 v[116:119], a[252:255], v[224:227], v[116:119]
    ds_read_b64_tr_b16 a[42:43], v10 offset:61440
    v_mfma_f32_16x16x32_bf16 v[160:163], a[248:251], v[228:231], v[160:163]
    ds_read_b128 v[224:227], v3 offset:34816
    v_mfma_f32_16x16x32_bf16 v[164:167], a[252:255], v[228:231], v[164:167]
    ds_read_b64_tr_b16 a[44:45], v11 offset:57344
    s_add_u32 m0, s14, 49152
    s_xor_b32 s58, s59, 0x420000
    buffer_load_dwordx4 v14, s[36:39], s58 offen offset:0  lds
    s_waitcnt lgkmcnt(8)
    v_mfma_f32_16x16x32_bf16 v[88:91], a[16:19], v[232:235], v[88:91]
    ds_read_b128 v[228:231], v4 offset:34816
    v_mfma_f32_16x16x32_bf16 v[92:95], a[20:23], v[232:235], v[92:95]
    ds_read_b64_tr_b16 a[46:47], v11 offset:61440
    buffer_load_dwordx4 v15, s[36:39], s58 offen offset:1024  lds
    v_mfma_f32_16x16x32_bf16 v[104:107], a[16:19], v[236:239], v[104:107]
    ds_read_b128 v[232:235], v5 offset:34816
    ds_read_b128 v[128:131], v2 offset:34816
    v_mfma_f32_16x16x32_bf16 v[108:111], a[20:23], v[236:239], v[108:111]
    v_mfma_f32_16x16x32_bf16 v[152:155], a[16:19], v[240:243], v[152:155]
    ds_read_b128 v[236:239], v3 offset:35840
    v_mfma_f32_16x16x32_bf16 v[156:159], a[20:23], v[240:243], v[156:159]
    buffer_load_dwordx4 v16, s[36:39], s58 offen offset:2048  lds
    v_mfma_f32_16x16x32_bf16 v[96:99], a[16:19], v[244:247], v[96:99]
    ds_read_b128 v[240:243], v4 offset:35840
    v_mfma_f32_16x16x32_bf16 v[100:103], a[20:23], v[244:247], v[100:103]
    buffer_load_dwordx4 v17, s[36:39], s58 offen offset:3072  lds
    s_waitcnt lgkmcnt(5)
    v_mfma_f32_16x16x32_bf16 v[112:115], a[16:19], v[216:219], v[112:115]
    ds_read_b128 v[244:247], v5 offset:35840
    ds_read_b128 v[132:135], v2 offset:35840
    v_mfma_f32_16x16x32_bf16 v[116:119], a[20:23], v[216:219], v[116:119]
    v_mfma_f32_16x16x32_bf16 v[160:163], a[16:19], v[220:223], v[160:163]
    s_waitcnt vmcnt(12) lgkmcnt(6)
    s_barrier
    ds_read_b128 v[216:219], v3 offset:16384
    v_mfma_f32_16x16x32_bf16 v[164:167], a[20:23], v[220:223], v[164:167]
    s_bitcmp1_b32 s54, 4
    s_cbranch_scc1 L_p1_14_x
    s_mov_b32 s71, 2000000
L_p1_14:
    buffer_load_dword v40, v38, s[44:47], 0 offen sc1
    s_sub_u32 s71, s71, 1
    s_waitcnt vmcnt(0)
    v_and_b32 v40, 3, v40
    v_cmp_ne_u32 s[32:33], 0, v40
    v_cmp_eq_u32 s[54:55], 2, v40
    s_cmp_eq_u32 s71, 0
    s_cbranch_scc1 L_p1_14_x
    s_bitcmp1_b32 s54, 4
    s_cbranch_scc0 L_p1_14
L_p1_14_x:
    s_add_u32 m0, s14, 131072
    s_xor_b32 s57, s56, 0x9000
    buffer_load_dwordx4 v36, s[40:43], s57 offen offset:0 sc1 lds
    v_mfma_f32_16x16x32_bf16 v[88:91], a[24:27], v[224:227], v[88:91]
    ds_read_b128 v[220:223], v4 offset:16384
    v_mfma_f32_16x16x32_bf16 v[92:95], a[28:31], v[224:227], v[92:95]
    buffer_load_dwordx4 v36, s[40:43], s57 offen offset:1024 sc1 lds
    v_mfma_f32_16x16x32_bf16 v[104:107], a[24:27], v[228:231], v[104:107]
    ds_read_b128 v[224:227], v5 offset:16384
    ds_read_b128 v[136:139], v2 offset:16384
    v_mfma_f32_16x16x32_bf16 v[108:111], a[28:31], v[228:231], v[108:111]
    s_waitcnt lgkmcnt(5)
    v_mfma_f32_16x16x32_bf16 v[152:155], a[24:27], v[232:235], v[152:155]
    ds_read_b128 v[228:231], v3 offset:17408
    v_mfma_f32_16x16x32_bf16 v[156:159], a[28:31], v[232:235], v[156:159]
    buffer_load_dwordx4 v36, s[40:43], s57 offen offset:2048 sc1 lds
    v_mfma_f32_16x16x32_bf16 v[96:99], a[24:27], v[236:239], v[96:99]
    ds_read_b128 v[232:235], v4 offset:17408
    v_mfma_f32_16x16x32_bf16 v[100:103], a[28:31], v[236:239], v[100:103]
    buffer_load_dwordx4 v36, s[40:43], s57 offen offset:3072 sc1 lds
    v_mfma_f32_16x16x32_bf16 v[112:115], a[24:27], v[240:243], v[112:115]
    ds_read_b128 v[236:239], v5 offset:17408
    ds_read_b128 v[140:143], v2 offset:17408
    v_mfma_f32_16x16x32_bf16 v[116:119], a[28:31], v[240:243], v[116:119]
    v_mfma_f32_16x16x32_bf16 v[160:163], a[24:27], v[244:247], v[160:163]
    ds_read_b128 v[240:243], v3 offset:18432
    v_mfma_f32_16x16x32_bf16 v[164:167], a[28:31], v[244:247], v[164:167]
    s_add_u32 m0, s14, 114688
    s_xor_b32 s58, s59, 0x4a0000
    buffer_load_dwordx4 v14, s[36:39], s58 offen offset:0  lds
    s_waitcnt lgkmcnt(4)
    v_mfma_f32_16x16x32_bf16 v[88:91], a[32:35], v[216:219], v[88:91]
    ds_read_b128 v[244:247], v4 offset:18432
    v_mfma_f32_16x16x32_bf16 v[92:95], a[36:39], v[216:219], v[92:95]
    buffer_load_dwordx4 v15, s[36:39], s58 offen offset:1024  lds
    v_mfma_f32_16x16x32_bf16 v[104:107], a[32:35], v[220:223], v[104:107]
    ds_read_b128 v[216:219], v5 offset:18432
    ds_read_b128 v[144:147], v2 offset:18432
    v_mfma_f32_16x16x32_bf16 v[108:111], a[36:39], v[220:223], v[108:111]
    v_mfma_f32_16x16x32_bf16 v[152:155], a[32:35], v[224:227], v[152:155]
    ds_read_b128 v[220:223], v3 offset:19456
    v_mfma_f32_16x16x32_bf16 v[156:159], a[36:39], v[224:227], v[156:159]
    buffer_load_dwordx4 v16, s[36:39], s58 offen offset:2048  lds
    v_mfma_f32_16x16x32_bf16 v[96:99], a[32:35], v[228:231], v[96:99]
    ds_read_b128 v[224:227], v4 offset:19456
    v_mfma_f32_16x16x32_bf16 v[100:103], a[36:39], v[228:231], v[100:103]
    buffer_load_dwordx4 v17, s[36:39], s58 offen offset:3072  lds
    s_waitcnt lgkmcnt(4)
    v_mfma_f32_16x16x32_bf16 v[112:115], a[32:35], v[232:235], v[112:115]
    ds_read_b128 v[228:231], v5 offset:19456
    ds_read_b128 v[148:151], v2 offset:19456
    v_mfma_f32_16x16x32_bf16 v[116:119], a[36:39], v[232:235], v[116:119]
    v_mfma_f32_16x16x32_bf16 v[160:163], a[32:35], v[236:239], v[160:163]
    s_waitcnt vmcnt(12)
    s_barrier
    ds_read_b128 v[232:235], v7 offset:49152
    v_mfma_f32_16x16x32_bf16 v[164:167], a[36:39], v[236:239], v[164:167]
    ds_read_b64_tr_b16 a[48:49], v10 offset:0
    s_bitcmp1_b32 s54, 5
    s_cbranch_scc1 L_p1_15_x
    s_mov_b32 s71, 2000000
L_p1_15:
    buffer_load_dword v40, v38, s[44:47], 0 offen sc1
    s_sub_u32 s71, s71, 1
    s_waitcnt vmcnt(0)
    v_and_b32 v40, 3, v40
    v_cmp_ne_u32 s[32:33], 0, v40
    v_cmp_eq_u32 s[54:55], 2, v40
    s_cmp_eq_u32 s71, 0
    s_cbranch_scc1 L_p1_15_x
    s_bitcmp1_b32 s54, 5
    s_cbranch_scc0 L_p1_15
L_p1_15_x:
    s_add_u32 m0, s14, 98304
    s_xor_b32 s57, s56, 0xb000
    buffer_load_dwordx4 v36, s[40:43], s57 offen offset:0 sc1 lds
    v_mfma_f32_16x16x32_bf16 v[88:91], a[40:43], v[240:243], v[88:91]
    ds_read_b128 v[236:239], v8 offset:49152
    v_mfma_f32_16x16x32_bf16 v[92:95], a[44:47], v[240:243], v[92:95]
    ds_read_b64_tr_b16 a[50:51], v10 offset:4096
    buffer_load_dwordx4 v36, s[40:43], s57 offen offset:1024 sc1 lds
    v_mfma_f32_16x16x32_bf16 v[104:107], a[40:43], v[244:247], v[104:107]
    ds_read_b128 v[240:243], v9 offset:49152
    ds_read_b128 v[168:171], v6 offset:49152
    v_mfma_f32_16x16x32_bf16 v[108:111], a[44:47], v[244:247], v[108:111]
    ds_read_b64_tr_b16 a[52:53], v11 offset:0
    s_waitcnt lgkmcnt(8)
    v_mfma_f32_16x16x32_bf16 v[152:155], a[40:43], v[216:219], v[152:155]
    ds_read_b128 v[244:247], v7 offset:50176
    v_mfma_f32_16x16x32_bf16 v[156:159], a[44:47], v[216:219], v[156:159]
    ds_read_b64_tr_b16 a[54:55], v11 offset:4096
    buffer_load_dwordx4 v36, s[40:43], s57 offen offset:2048 sc1 lds
    v_mfma_f32_16x16x32_bf16 v[96:99], a[40:43], v[220:223], v[96:99]
    ds_read_b128 v[216:219], v8 offset:50176
    v_mfma_f32_16x16x32_bf16 v[100:103], a[44:47], v[220:223], v[100:103]
    ds_read_b64_tr_b16 a[56:57], v10 offset:8192
    buffer_load_dwordx4 v36, s[40:43], s57 offen offset:3072 sc1 lds
    v_mfma_f32_16x16x32_bf16 v[112:115], a[40:43], v[224:227], v[112:115]
    ds_read_b128 v[220:223], v9 offset:50176
    ds_read_b128 v[172:175], v6 offset:50176
    v_mfma_f32_16x16x32_bf16 v[116:119], a[44:47], v[224:227], v[116:119]
    ds_read_b64_tr_b16 a[58:59], v10 offset:12288
    v_mfma_f32_16x16x32_bf16 v[160:163], a[40:43], v[228:231], v[160:163]
    ds_read_b128 v[224:227], v7 offset:51200
    v_mfma_f32_16x16x32_bf16 v[164:167], a[44:47], v[228:231], v[164:167]
    ds_read_b64_tr_b16 a[60:61], v11 offset:8192
    s_add_u32 m0, s14, 32768
    s_xor_b32 s58, s59, 0x520000
    buffer_load_dwordx4 v14, s[36:39], s58 offen offset:0  lds
    s_waitcnt lgkmcnt(7)
    v_mfma_f32_16x16x32_bf16 v[88:91], a[48:51], v[232:235], v[88:91]
    ds_read_b128 v[228:231], v8 offset:51200
    v_mfma_f32_16x16x32_bf16 v[92:95], a[52:55], v[232:235], v[92:95]
    ds_read_b64_tr_b16 a[62:63], v11 offset:12288
    buffer_load_dwordx4 v15, s[36:39], s58 offen offset:1024  lds
    v_mfma_f32_16x16x32_bf16 v[104:107], a[48:51], v[236:239], v[104:107]
    ds_read_b128 v[232:235], v9 offset:51200
    ds_read_b128 v[176:179], v6 offset:51200
    v_mfma_f32_16x16x32_bf16 v[108:111], a[52:55], v[236:239], v[108:111]
    v_mfma_f32_16x16x32_bf16 v[152:155], a[48:51], v[240:243], v[152:155]
    ds_read_b128 v[236:239], v7 offset:52224
    v_mfma_f32_16x16x32_bf16 v[156:159], a[52:55], v[240:243], v[156:159]
    buffer_load_dwordx4 v16, s[36:39], s58 offen offset:2048  lds
    v_mfma_f32_16x16x32_bf16 v[96:99], a[48:51], v[244:247], v[96:99]
    ds_read_b128 v[240:243], v8 offset:52224
    v_mfma_f32_16x16x32_bf16 v[100:103], a[52:55], v[244:247], v[100:103]
    buffer_load_dwordx4 v17, s[36:39], s58 offen offset:3072  lds
    s_waitcnt lgkmcnt(4)
    v_mfma_f32_16x16x32_bf16 v[112:115], a[48:51], v[216:219], v[112:115]
    ds_read_b128 v[244:247], v9 offset:52224
    ds_read_b128 v[180:183], v6 offset:52224
    v_mfma_f32_16x16x32_bf16 v[116:119], a[52:55], v[216:219], v[116:119]
    v_mfma_f32_16x16x32_bf16 v[160:163], a[48:51], v[220:223], v[160:163]
    s_waitcnt vmcnt(12)
    s_barrier
    ds_read_b128 v[216:219], v7 offset:32768
    v_mfma_f32_16x16x32_bf16 v[164:167], a[52:55], v[220:223], v[164:167]
    ds_read_b64_tr_b16 a[64:65], v30 offset:49152
    s_bitcmp1_b32 s54, 6
    s_cbranch_scc1 L_p1_16_x
    s_mov_b32 s71, 2000000
L_p1_16:
    buffer_load_dword v40, v38, s[44:47], 0 offen sc1
    s_sub_u32 s71, s71, 1
    s_waitcnt vmcnt(0)
    v_and_b32 v40, 3, v40
    v_cmp_ne_u32 s[32:33], 0, v40
    v_cmp_eq_u32 s[54:55], 2, v40
    s_cmp_eq_u32 s71, 0
    s_cbranch_scc1 L_p1_16_x
    s_bitcmp1_b32 s54, 6
    s_cbranch_scc0 L_p1_16
L_p1_16_x:
    s_add_u32 m0, s14, 81920
    s_xor_b32 s57, s56, 0xd000
    buffer_load_dwordx4 v36, s[40:43], s57 offen offset:0 sc1 lds
    v_mfma_f32_16x16x32_bf16 v[88:91], a[56:59], v[224:227], v[88:91]
    ds_read_b128 v[220:223], v8 offset:32768
    v_mfma_f32_16x16x32_bf16 v[92:95], a[60:63], v[224:227], v[92:95]
    ds_read_b64_tr_b16 a[66:67], v30 offset:53248
    buffer_load_dwordx4 v36, s[40:43], s57 offen offset:1024 sc1 lds
    v_mfma_f32_16x16x32_bf16 v[104:107], a[56:59], v[228:231], v[104:107]
    ds_read_b128 v[224:227], v9 offset:32768
    v_mfma_f32_16x16x32_bf16 v[108:111], a[60:63], v[228:231], v[108:111]
    ds_read_b64_tr_b16 a[68:69], v31 offset:49152
    s_waitcnt lgkmcnt(7)
    v_mfma_f32_16x16x32_bf16 v[152:155], a[56:59], v[232:235], v[152:155]
    ds_read_b128 v[228:231], v7 offset:33792
    v_mfma_f32_16x16x32_bf16 v[156:159], a[60:63], v[232:235], v[156:159]
    ds_read_b64_tr_b16 a[70:71], v31 offset:53248
    buffer_load_dwordx4 v36, s[40:43], s57 offen offset:2048 sc1 lds
    v_mfma_f32_16x16x32_bf16 v[96:99], a[56:59], v[236:239], v[96:99]
    ds_read_b128 v[232:235], v8 offset:33792
    v_mfma_f32_16x16x32_bf16 v[100:103], a[60:63], v[236:239], v[100:103]
    ds_read_b64_tr_b16 a[72:73], v30 offset:57344
    buffer_load_dwordx4 v36, s[40:43], s57 offen offset:3072 sc1 lds
    v_mfma_f32_16x16x32_bf16 v[112:115], a[56:59], v[240:243], v[112:115]
    ds_read_b128 v[236:239], v9 offset:33792
    v_mfma_f32_16x16x32_bf16 v[116:119], a[60:63], v[240:243], v[116:119]
    ds_read_b64_tr_b16 a[74:75], v30 offset:61440
    v_mfma_f32_16x16x32_bf16 v[160:163], a[56:59], v[244:247], v[160:163]
    ds_read_b128 v[240:243], v7 offset:34816
    v_mfma_f32_16x16x32_bf16 v[164:167], a[60:63], v[244:247], v[164:167]
    ds_read_b64_tr_b16 a[76:77], v31 offset:57344
    s_add_u32 m0, s14, 65536
    s_xor_b32 s58, s59, 0x5a0000
    buffer_load_dwordx4 v14, s[36:39], s58 offen offset:0  lds
    s_waitcnt lgkmcnt(6)
    v_mfma_f32_16x16x32_bf16 v[88:91], a[64:67], v[216:219], v[88:91]
    ds_read_b128 v[244:247], v8 offset:34816
    v_mfma_f32_16x16x32_bf16 v[92:95], a[68:71], v[216:219], v[92:95]
    ds_read_b64_tr_b16 a[78:79], v31 offset:61440
    buffer_load_dwordx4 v15, s[36:39], s58 offen offset:1024  lds
    v_mfma_f32_16x16x32_bf16 v[104:107], a[64:67], v[220:223], v[104:107]
    ds_read_b128 v[216:219], v9 offset:34816
    v_mfma_f32_16x16x32_bf16 v[108:111], a[68:71], v[220:223], v[108:111]
    v_mfma_f32_16x16x32_bf16 v[152:155], a[64:67], v[224:227], v[152:155]
    ds_read_b128 v[220:223], v7 offset:35840
    v_mfma_f32_16x16x32_bf16 v[156:159], a[68:71], v[224:227], v[156:159]
    buffer_load_dwordx4 v16, s[36:39], s58 offen offset:2048  lds
    v_mfma_f32_16x16x32_bf16 v[96:99], a[64:67], v[228:231], v[96:99]
    ds_read_b128 v[224:227], v8 offset:35840
    v_mfma_f32_16x16x32_bf16 v[100:103], a[68:71], v[228:231], v[100:103]
    buffer_load_dwordx4 v17, s[36:39], s58 offen offset:3072  lds
    s_waitcnt lgkmcnt(3)
    v_mfma_f32_16x16x32_bf16 v[112:115], a[64:67], v[232:235], v[112:115]
    ds_read_b128 v[228:231], v9 offset:35840
    v_mfma_f32_16x16x32_bf16 v[116:119], a[68:71], v[232:235], v[116:119]
    v_mfma_f32_16x16x32_bf16 v[160:163], a[64:67], v[236:239], v[160:163]
    s_waitcnt vmcnt(12)
    s_barrier
    ds_read_b128 v[232:235], v3 offset:32768
    v_mfma_f32_16x16x32_bf16 v[164:167], a[68:71], v[236:239], v[164:167]
    ds_read_b64_tr_b16 a[80:81], v10 offset:49152
    s_bitcmp1_b32 s54, 7
    s_cbranch_scc1 L_p1_17_x
    s_mov_b32 s71, 2000000
L_p1_17:
    buffer_load_dword v40, v38, s[44:47], 0 offen sc1
    s_sub_u32 s71, s71, 1
    s_waitcnt vmcnt(0)
    v_and_b32 v40, 3, v40
    v_cmp_ne_u32 s[32:33], 0, v40
    v_cmp_eq_u32 s[54:55], 2, v40
    s_cmp_eq_u32 s71, 0
    s_cbranch_scc1 L_p1_17_x
    s_bitcmp1_b32 s54, 7
    s_cbranch_scc0 L_p1_17
L_p1_17_x:
    s_add_u32 m0, s14, 147456
    s_xor_b32 s57, s56, 0xf000
    buffer_load_dwordx4 v36, s[40:43], s57 offen offset:0 sc1 lds
    v_mfma_f32_16x16x32_bf16 v[88:91], a[72:75], v[240:243], v[88:91]
    ds_read_b128 v[236:239], v4 offset:32768
    v_mfma_f32_16x16x32_bf16 v[92:95], a[76:79], v[240:243], v[92:95]
    ds_read_b64_tr_b16 a[82:83], v10 offset:53248
    v_mfma_f32_16x16x32_bf16 v[104:107], a[72:75], v[244:247], v[104:107]
    ds_read_b128 v[240:243], v5 offset:32768
    v_mfma_f32_16x16x32_bf16 v[108:111], a[76:79], v[244:247], v[108:111]
    ds_read_b64_tr_b16 a[84:85], v11 offset:49152
    s_waitcnt lgkmcnt(6)
    v_mfma_f32_16x16x32_bf16 v[152:155], a[72:75], v[216:219], v[152:155]
    ds_read_b128 v[244:247], v3 offset:33792
    v_mfma_f32_16x16x32_bf16 v[156:159], a[76:79], v[216:219], v[156:159]
    ds_read_b64_tr_b16 a[86:87], v11 offset:53248
    buffer_load_dwordx4 v36, s[40:43], s57 offen offset:1024 sc1 lds
    v_mfma_f32_16x16x32_bf16 v[96:99], a[72:75], v[220:223], v[96:99]
    ds_read_b128 v[216:219], v4 offset:33792
    v_mfma_f32_16x16x32_bf16 v[100:103], a[76:79], v[220:223], v[100:103]
    ds_read_b64_tr_b16 a[88:89], v10 offset:57344
    v_mfma_f32_16x16x32_bf16 v[112:115], a[72:75], v[224:227], v[112:115]
    ds_read_b128 v[220:223], v5 offset:33792
    v_mfma_f32_16x16x32_bf16 v[116:119], a[76:79], v[224:227], v[116:119]
    ds_read_b64_tr_b16 a[90:91], v10 offset:61440
    v_mfma_f32_16x16x32_bf16 v[160:163], a[72:75], v[228:231], v[160:163]
    ds_read_b128 v[224:227], v3 offset:34816
    v_mfma_f32_16x16x32_bf16 v[164:167], a[76:79], v[228:231], v[164:167]
    ds_read_b64_tr_b16 a[92:93], v11 offset:57344
    buffer_load_dwordx4 v36, s[40:43], s57 offen offset:2048 sc1 lds
    s_waitcnt lgkmcnt(6)
    v_mfma_f32_16x16x32_bf16 v[88:91], a[80:83], v[232:235], v[88:91]
    ds_read_b128 v[228:231], v4 offset:34816
    v_mfma_f32_16x16x32_bf16 v[92:95], a[84:87], v[232:235], v[92:95]
    ds_read_b64_tr_b16 a[94:95], v11 offset:61440
    v_mfma_f32_16x16x32_bf16 v[104:107], a[80:83], v[236:239], v[104:107]
    ds_read_b128 v[232:235], v5 offset:34816
    v_mfma_f32_16x16x32_bf16 v[108:111], a[84:87], v[236:239], v[108:111]
    v_mfma_f32_16x16x32_bf16 v[152:155], a[80:83], v[240:243], v[152:155]
    ds_read_b128 v[236:239], v3 offset:35840
    v_mfma_f32_16x16x32_bf16 v[156:159], a[84:87], v[240:243], v[156:159]
    buffer_load_dwordx4 v36, s[40:43], s57 offen offset:3072 sc1 lds
    v_mfma_f32_16x16x32_bf16 v[96:99], a[80:83], v[244:247], v[96:99]
    ds_read_b128 v[240:243], v4 offset:35840
    v_mfma_f32_16x16x32_bf16 v[100:103], a[84:87], v[244:247], v[100:103]
    s_waitcnt lgkmcnt(3)
    v_mfma_f32_16x16x32_bf16 v[112:115], a[80:83], v[216:219], v[112:115]
    ds_read_b128 v[244:247], v5 offset:35840
    v_mfma_f32_16x16x32_bf16 v[116:119], a[84:87], v[216:219], v[116:119]
    v_mfma_f32_16x16x32_bf16 v[160:163], a[80:83], v[220:223], v[160:163]
    s_waitcnt vmcnt(8)
    s_barrier
    ds_read_b128 v[216:219], v3 offset:16384
    v_mfma_f32_16x16x32_bf16 v[164:167], a[84:87], v[220:223], v[164:167]
    ds_read_b64_tr_b16 a[96:97], v30 offset:32768
    v_mfma_f32_16x16x32_bf16 v[88:91], a[88:91], v[224:227], v[88:91]
    ds_read_b128 v[220:223], v4 offset:16384
    v_mfma_f32_16x16x32_bf16 v[92:95], a[92:95], v[224:227], v[92:95]
    ds_read_b64_tr_b16 a[98:99], v30 offset:36864
    v_mfma_f32_16x16x32_bf16 v[104:107], a[88:91], v[228:231], v[104:107]
    ds_read_b128 v[224:227], v5 offset:16384
    v_mfma_f32_16x16x32_bf16 v[108:111], a[92:95], v[228:231], v[108:111]
    ds_read_b64_tr_b16 a[100:101], v31 offset:32768
    s_waitcnt lgkmcnt(6)
    v_mfma_f32_16x16x32_bf16 v[152:155], a[88:91], v[232:235], v[152:155]
    ds_read_b128 v[228:231], v3 offset:17408
    v_mfma_f32_16x16x32_bf16 v[156:159], a[92:95], v[232:235], v[156:159]
    ds_read_b64_tr_b16 a[102:103], v31 offset:36864
    v_mfma_f32_16x16x32_bf16 v[96:99], a[88:91], v[236:239], v[96:99]
    ds_read_b128 v[232:235], v4 offset:17408
    v_mfma_f32_16x16x32_bf16 v[100:103], a[92:95], v[236:239], v[100:103]
    ds_read_b64_tr_b16 a[104:105], v30 offset:40960
    v_mfma_f32_16x16x32_bf16 v[112:115], a[88:91], v[240:243], v[112:115]
    ds_read_b128 v[236:239], v5 offset:17408
    v_mfma_f32_16x16x32_bf16 v[116:119], a[92:95], v[240:243], v[116:119]
    ds_read_b64_tr_b16 a[106:107], v30 offset:45056
    v_mfma_f32_16x16x32_bf16 v[160:163], a[88:91], v[244:247], v[160:163]
    ds_read_b128 v[240:243], v3 offset:18432
    v_mfma_f32_16x16x32_bf16 v[164:167], a[92:95], v[244:247], v[164:167]
    ds_read_b64_tr_b16 a[108:109], v31 offset:40960
    s_waitcnt lgkmcnt(6)
    v_mfma_f32_16x16x32_bf16 v[88:91], a[96:99], v[216:219], v[88:91]
    ds_read_b128 v[244:247], v4 offset:18432
    v_mfma_f32_16x16x32_bf16 v[92:95], a[100:103], v[216:219], v[92:95]
    ds_read_b64_tr_b16 a[110:111], v31 offset:45056
    v_mfma_f32_16x16x32_bf16 v[104:107], a[96:99], v[220:223], v[104:107]
    ds_read_b128 v[216:219], v5 offset:18432
    v_mfma_f32_16x16x32_bf16 v[108:111], a[100:103], v[220:223], v[108:111]
    v_mfma_f32_16x16x32_bf16 v[152:155], a[96:99], v[224:227], v[152:155]
    ds_read_b128 v[220:223], v3 offset:19456
    v_mfma_f32_16x16x32_bf16 v[156:159], a[100:103], v[224:227], v[156:159]
    v_mfma_f32_16x16x32_bf16 v[96:99], a[96:99], v[228:231], v[96:99]
    ds_read_b128 v[224:227], v4 offset:19456
    v_mfma_f32_16x16x32_bf16 v[100:103], a[100:103], v[228:231], v[100:103]
    s_waitcnt lgkmcnt(3)
    v_mfma_f32_16x16x32_bf16 v[112:115], a[96:99], v[232:235], v[112:115]
    ds_read_b128 v[228:231], v5 offset:19456
    v_mfma_f32_16x16x32_bf16 v[116:119], a[100:103], v[232:235], v[116:119]
    v_mfma_f32_16x16x32_bf16 v[160:163], a[96:99], v[236:239], v[160:163]
    s_waitcnt vmcnt(0)
    s_barrier
    ds_read_b128 v[232:235], v7 offset:49152
    v_mfma_f32_16x16x32_bf16 v[164:167], a[100:103], v[236:239], v[164:167]
    ds_read_b64_tr_b16 a[112:113], v10 offset:0
    v_mfma_f32_16x16x32_bf16 v[88:91], a[104:107], v[240:243], v[88:91]
    ds_read_b128 v[236:239], v7 offset:50176
    v_mfma_f32_16x16x32_bf16 v[92:95], a[108:111], v[240:243], v[92:95]
    ds_read_b64_tr_b16 a[114:115], v10 offset:4096
    s_lshl_b32 s62, s2, 2
    s_add_u32 s62, s62, s3
    s_lshl_b32 s63, s62, 7
    s_add_u32 s63, s63, 0x1100000
    v_min_u32 v38, 2, v1
    v_lshl_add_u32 v38, v38, 2, s63
    v_mov_b32 v248, 1
    v_mfma_f32_16x16x32_bf16 v[104:107], a[104:107], v[244:247], v[104:107]
    ds_read_b128 v[240:243], v7 offset:51200
    v_mfma_f32_16x16x32_bf16 v[108:111], a[108:111], v[244:247], v[108:111]
    ds_read_b64_tr_b16 a[116:117], v11 offset:0
    v_and_b32 v42, 15, v1
    v_lshrrev_b32 v44, 4, v1
    v_lshlrev_b32 v44, 4, v44
    v_lshl_add_u32 v42, v42, 11, v44
    s_waitcnt lgkmcnt(6)
    v_mfma_f32_16x16x32_bf16 v[152:155], a[104:107], v[216:219], v[152:155]
    ds_read_b128 v[244:247], v7 offset:52224
    v_mfma_f32_16x16x32_bf16 v[156:159], a[108:111], v[216:219], v[156:159]
    ds_read_b64_tr_b16 a[118:119], v11 offset:4096
    v_mfma_f32_16x16x32_bf16 v[96:99], a[104:107], v[220:223], v[96:99]
    ds_read_b128 v[216:219], v8 offset:49152
    v_mfma_f32_16x16x32_bf16 v[100:103], a[108:111], v[220:223], v[100:103]
    ds_read_b64_tr_b16 a[120:121], v10 offset:8192
    v_mfma_f32_16x16x32_bf16 v[112:115], a[104:107], v[224:227], v[112:115]
    ds_read_b128 v[220:223], v8 offset:50176
    v_mfma_f32_16x16x32_bf16 v[116:119], a[108:111], v[224:227], v[116:119]
    ds_read_b64_tr_b16 a[122:123], v10 offset:12288
    v_mfma_f32_16x16x32_bf16 v[160:163], a[104:107], v[228:231], v[160:163]
    ds_read_b128 v[224:227], v8 offset:51200
    v_mfma_f32_16x16x32_bf16 v[164:167], a[108:111], v[228:231], v[164:167]
    ds_read_b64_tr_b16 a[124:125], v11 offset:8192
    s_waitcnt lgkmcnt(0)
    v_mfma_f32_16x16x32_bf16 v[88:91], a[112:115], v[232:235], v[88:91]
    ds_read_b128 v[228:231], v8 offset:52224
    v_mfma_f32_16x16x32_bf16 v[92:95], a[116:119], v[232:235], v[92:95]
    ds_read_b64_tr_b16 a[126:127], v11 offset:12288
    v_mfma_f32_16x16x32_bf16 v[96:99], a[112:115], v[236:239], v[96:99]
    ds_read_b128 v[232:235], v9 offset:49152
    v_mfma_f32_16x16x32_bf16 v[100:103], a[116:119], v[236:239], v[100:103]
    s_waitcnt lgkmcnt(1)
    v_mfma_f32_16x16x32_bf16 v[88:91], a[120:123], v[240:243], v[88:91]
    ds_read_b128 v[236:239], v9 offset:50176
    v_mfma_f32_16x16x32_bf16 v[92:95], a[124:127], v[240:243], v[92:95]
    v_mfma_f32_16x16x32_bf16 v[96:99], a[120:123], v[244:247], v[96:99]
    ds_read_b128 v[240:243], v9 offset:51200
    v_mfma_f32_16x16x32_bf16 v[100:103], a[124:127], v[244:247], v[100:103]
    v_mfma_f32_16x16x32_bf16 v[104:107], a[112:115], v[216:219], v[104:107]
    ds_read_b128 v[244:247], v9 offset:52224
    v_mfma_f32_16x16x32_bf16 v[108:111], a[116:119], v[216:219], v[108:111]
    v_mfma_f32_16x16x32_bf16 v[112:115], a[112:115], v[220:223], v[112:115]
    v_mfma_f32_16x16x32_bf16 v[116:119], a[116:119], v[220:223], v[116:119]
    v_cvt_pk_bf16_f32 v88, v88, v89
    v_cvt_pk_bf16_f32 v89, v90, v91
    v_cvt_pk_bf16_f32 v90, v92, v93
    v_cvt_pk_bf16_f32 v91, v94, v95
    v_mfma_f32_16x16x32_bf16 v[104:107], a[120:123], v[224:227], v[104:107]
    v_mfma_f32_16x16x32_bf16 v[108:111], a[124:127], v[224:227], v[108:111]
    buffer_store_dwordx4 v[88:91], v36, s[44:47], s88 offen offset:0 sc1
    v_cvt_pk_bf16_f32 v92, v96, v97
    v_cvt_pk_bf16_f32 v93, v98, v99
    v_mfma_f32_16x16x32_bf16 v[112:115], a[120:123], v[228:231], v[112:115]
    v_mfma_f32_16x16x32_bf16 v[116:119], a[124:127], v[228:231], v[116:119]
    v_cvt_pk_bf16_f32 v94, v100, v101
    v_cvt_pk_bf16_f32 v95, v102, v103
    buffer_store_dwordx4 v[92:95], v36, s[44:47], s88 offen offset:1024 sc1
    s_waitcnt lgkmcnt(0)
    v_mfma_f32_16x16x32_bf16 v[152:155], a[112:115], v[232:235], v[152:155]
    v_mfma_f32_16x16x32_bf16 v[156:159], a[116:119], v[232:235], v[156:159]
    v_mfma_f32_16x16x32_bf16 v[160:163], a[112:115], v[236:239], v[160:163]
    v_mfma_f32_16x16x32_bf16 v[164:167], a[116:119], v[236:239], v[164:167]
    v_cvt_pk_bf16_f32 v104, v104, v105
    v_cvt_pk_bf16_f32 v105, v106, v107
    v_cvt_pk_bf16_f32 v106, v108, v109
    v_cvt_pk_bf16_f32 v107, v110, v111
    v_mfma_f32_16x16x32_bf16 v[152:155], a[120:123], v[240:243], v[152:155]
    v_mfma_f32_16x16x32_bf16 v[156:159], a[124:127], v[240:243], v[156:159]
    buffer_store_dwordx4 v[104:107], v36, s[44:47], s89 offen offset:0 sc1
    v_cvt_pk_bf16_f32 v108, v112, v113
    v_cvt_pk_bf16_f32 v109, v114, v115
    v_mfma_f32_16x16x32_bf16 v[160:163], a[120:123], v[244:247], v[160:163]
    v_mfma_f32_16x16x32_bf16 v[164:167], a[124:127], v[244:247], v[164:167]
    v_cvt_pk_bf16_f32 v110, v116, v117
    v_cvt_pk_bf16_f32 v111, v118, v119
    buffer_store_dwordx4 v[108:111], v36, s[44:47], s89 offen offset:1024 sc1
    v_mfma_f32_16x16x32_bf16 v[56:59], a[208:211], v[72:75], v[56:59]
    v_mfma_f32_16x16x32_bf16 v[60:63], a[212:215], v[72:75], v[60:63]
    v_mfma_f32_16x16x32_bf16 v[64:67], a[208:211], v[76:79], v[64:67]
    v_mfma_f32_16x16x32_bf16 v[68:71], a[212:215], v[76:79], v[68:71]
    v_cvt_pk_bf16_f32 v152, v152, v153
    v_cvt_pk_bf16_f32 v153, v154, v155
    v_cvt_pk_bf16_f32 v154, v156, v157
    v_mfma_f32_16x16x32_bf16 v[56:59], a[216:219], v[80:83], v[56:59]
    v_mfma_f32_16x16x32_bf16 v[60:63], a[220:223], v[80:83], v[60:63]
    v_cvt_pk_bf16_f32 v155, v158, v159
    buffer_store_dwordx4 v[152:155], v36, s[44:47], s90 offen offset:0 sc1
    v_cvt_pk_bf16_f32 v156, v160, v161
    v_cvt_pk_bf16_f32 v157, v162, v163
    v_mfma_f32_16x16x32_bf16 v[64:67], a[216:219], v[84:87], v[64:67]
    v_mfma_f32_16x16x32_bf16 v[68:71], a[220:223], v[84:87], v[68:71]
    v_cvt_pk_bf16_f32 v158, v164, v165
    v_cvt_pk_bf16_f32 v159, v166, v167
    buffer_store_dwordx4 v[156:159], v36, s[44:47], s90 offen offset:1024 sc1
    v_mfma_f32_16x16x32_bf16 v[56:59], a[224:227], v[184:187], v[56:59]
    v_mfma_f32_16x16x32_bf16 v[60:63], a[228:231], v[184:187], v[60:63]
    v_mfma_f32_16x16x32_bf16 v[64:67], a[224:227], v[188:191], v[64:67]
    v_mfma_f32_16x16x32_bf16 v[68:71], a[228:231], v[188:191], v[68:71]
    v_mfma_f32_16x16x32_bf16 v[56:59], a[232:235], v[192:195], v[56:59]
    v_mfma_f32_16x16x32_bf16 v[60:63], a[236:239], v[192:195], v[60:63]
    v_mfma_f32_16x16x32_bf16 v[64:67], a[232:235], v[196:199], v[64:67]
    v_mfma_f32_16x16x32_bf16 v[68:71], a[236:239], v[196:199], v[68:71]
    v_mfma_f32_16x16x32_bf16 v[56:59], a[240:243], v[200:203], v[56:59]
    v_mfma_f32_16x16x32_bf16 v[60:63], a[244:247], v[200:203], v[60:63]
    v_mfma_f32_16x16x32_bf16 v[64:67], a[240:243], v[204:207], v[64:67]
    v_mfma_f32_16x16x32_bf16 v[68:71], a[244:247], v[204:207], v[68:71]
    v_mfma_f32_16x16x32_bf16 v[56:59], a[248:251], v[208:211], v[56:59]
    v_mfma_f32_16x16x32_bf16 v[60:63], a[252:255], v[208:211], v[60:63]
    v_mfma_f32_16x16x32_bf16 v[64:67], a[248:251], v[212:215], v[64:67]
    v_mfma_f32_16x16x32_bf16 v[68:71], a[252:255], v[212:215], v[68:71]
    v_mfma_f32_16x16x32_bf16 v[56:59], a[16:19], v[120:123], v[56:59]
    v_mfma_f32_16x16x32_bf16 v[60:63], a[20:23], v[120:123], v[60:63]
    v_mfma_f32_16x16x32_bf16 v[64:67], a[16:19], v[124:127], v[64:67]
    v_mfma_f32_16x16x32_bf16 v[68:71], a[20:23], v[124:127], v[68:71]
    v_mfma_f32_16x16x32_bf16 v[56:59], a[24:27], v[128:131], v[56:59]
    v_mfma_f32_16x16x32_bf16 v[60:63], a[28:31], v[128:131], v[60:63]
    v_mfma_f32_16x16x32_bf16 v[64:67], a[24:27], v[132:135], v[64:67]
    v_mfma_f32_16x16x32_bf16 v[68:71], a[28:31], v[132:135], v[68:71]
    v_mfma_f32_16x16x32_bf16 v[56:59], a[32:35], v[136:139], v[56:59]
    v_mfma_f32_16x16x32_bf16 v[60:63], a[36:39], v[136:139], v[60:63]
    v_mfma_f32_16x16x32_bf16 v[64:67], a[32:35], v[140:143], v[64:67]
    ds_read_b128 v[216:219], v6 offset:32768
    v_mfma_f32_16x16x32_bf16 v[68:71], a[36:39], v[140:143], v[68:71]
    s_waitcnt vmcnt(4)
    s_mov_b64 exec, 2
    buffer_store_dword v248, v39, s[44:47], 0 offen sc1
    s_mov_b64 exec, -1
    v_mfma_f32_16x16x32_bf16 v[56:59], a[40:43], v[144:147], v[56:59]
    ds_read_b128 v[220:223], v6 offset:33792
    v_mfma_f32_16x16x32_bf16 v[60:63], a[44:47], v[144:147], v[60:63]
    v_mfma_f32_16x16x32_bf16 v[64:67], a[40:43], v[148:151], v[64:67]
    ds_read_b128 v[224:227], v6 offset:34816
    v_mfma_f32_16x16x32_bf16 v[68:71], a[44:47], v[148:151], v[68:71]
    v_mfma_f32_16x16x32_bf16 v[56:59], a[48:51], v[168:171], v[56:59]
    ds_read_b128 v[228:231], v6 offset:35840
    v_mfma_f32_16x16x32_bf16 v[60:63], a[52:55], v[168:171], v[60:63]
    v_mfma_f32_16x16x32_bf16 v[64:67], a[48:51], v[172:175], v[64:67]
    ds_read_b128 v[232:235], v2 offset:32768
    v_mfma_f32_16x16x32_bf16 v[68:71], a[52:55], v[172:175], v[68:71]
    s_waitcnt vmcnt(3)
    s_mov_b64 exec, 4
    buffer_store_dword v248, v39, s[44:47], 0 offen sc1
    s_mov_b64 exec, -1
    v_mfma_f32_16x16x32_bf16 v[56:59], a[56:59], v[176:179], v[56:59]
    ds_read_b128 v[236:239], v2 offset:33792
    v_mfma_f32_16x16x32_bf16 v[60:63], a[60:63], v[176:179], v[60:63]
    v_mfma_f32_16x16x32_bf16 v[64:67], a[56:59], v[180:183], v[64:67]
    ds_read_b128 v[240:243], v2 offset:34816
    v_mfma_f32_16x16x32_bf16 v[68:71], a[60:63], v[180:183], v[68:71]
    s_waitcnt lgkmcnt(3)
    v_mfma_f32_16x16x32_bf16 v[56:59], a[64:67], v[216:219], v[56:59]
    ds_read_b128 v[244:247], v2 offset:35840
    v_mfma_f32_16x16x32_bf16 v[60:63], a[68:71], v[216:219], v[60:63]
    v_mfma_f32_16x16x32_bf16 v[64:67], a[64:67], v[220:223], v[64:67]
    ds_read_b128 v[216:219], v2 offset:16384
    v_mfma_f32_16x16x32_bf16 v[68:71], a[68:71], v[220:223], v[68:71]
    s_waitcnt vmcnt(2)
    s_mov_b64 exec, 8
    buffer_store_dword v248, v39, s[44:47], 0 offen sc1
    s_mov_b64 exec, -1
    v_mfma_f32_16x16x32_bf16 v[56:59], a[72:75], v[224:227], v[56:59]
    ds_read_b128 v[220:223], v2 offset:17408
    v_mfma_f32_16x16x32_bf16 v[60:63], a[76:79], v[224:227], v[60:63]
    v_mfma_f32_16x16x32_bf16 v[64:67], a[72:75], v[228:231], v[64:67]
    ds_read_b128 v[224:227], v2 offset:18432
    v_mfma_f32_16x16x32_bf16 v[68:71], a[76:79], v[228:231], v[68:71]
    s_waitcnt lgkmcnt(3)
    v_mfma_f32_16x16x32_bf16 v[56:59], a[80:83], v[232:235], v[56:59]
    ds_read_b128 v[228:231], v2 offset:19456
    v_mfma_f32_16x16x32_bf16 v[60:63], a[84:87], v[232:235], v[60:63]
    v_mfma_f32_16x16x32_bf16 v[64:67], a[80:83], v[236:239], v[64:67]
    ds_read_b128 v[232:235], v6 offset:49152
    v_mfma_f32_16x16x32_bf16 v[68:71], a[84:87], v[236:239], v[68:71]
    v_mfma_f32_16x16x32_bf16 v[56:59], a[88:91], v[240:243], v[56:59]
    ds_read_b128 v[236:239], v6 offset:50176
    v_mfma_f32_16x16x32_bf16 v[60:63], a[92:95], v[240:243], v[60:63]
    v_mfma_f32_16x16x32_bf16 v[64:67], a[88:91], v[244:247], v[64:67]
    ds_read_b128 v[240:243], v6 offset:51200
    v_mfma_f32_16x16x32_bf16 v[68:71], a[92:95], v[244:247], v[68:71]
    buffer_load_dword v40, v38, s[44:47], 0 offen sc1
    s_waitcnt lgkmcnt(3)
    v_mfma_f32_16x16x32_bf16 v[56:59], a[96:99], v[216:219], v[56:59]
    ds_read_b128 v[244:247], v6 offset:52224
    v_mfma_f32_16x16x32_bf16 v[60:63], a[100:103], v[216:219], v[60:63]
    v_mfma_f32_16x16x32_bf16 v[64:67], a[96:99], v[220:223], v[64:67]
    v_mfma_f32_16x16x32_bf16 v[68:71], a[100:103], v[220:223], v[68:71]
    v_mfma_f32_16x16x32_bf16 v[56:59], a[104:107], v[224:227], v[56:59]
    v_mfma_f32_16x16x32_bf16 v[60:63], a[108:111], v[224:227], v[60:63]
    v_mfma_f32_16x16x32_bf16 v[64:67], a[104:107], v[228:231], v[64:67]
    v_mfma_f32_16x16x32_bf16 v[68:71], a[108:111], v[228:231], v[68:71]
    s_waitcnt lgkmcnt(0)
    v_mfma_f32_16x16x32_bf16 v[56:59], a[112:115], v[232:235], v[56:59]
    v_mfma_f32_16x16x32_bf16 v[60:63], a[116:119], v[232:235], v[60:63]
    v_mfma_f32_16x16x32_bf16 v[64:67], a[112:115], v[236:239], v[64:67]
    v_mfma_f32_16x16x32_bf16 v[68:71], a[116:119], v[236:239], v[68:71]
    v_mfma_f32_16x16x32_bf16 v[56:59], a[120:123], v[240:243], v[56:59]
    v_mfma_f32_16x16x32_bf16 v[60:63], a[124:127], v[240:243], v[60:63]
    v_mfma_f32_16x16x32_bf16 v[64:67], a[120:123], v[244:247], v[64:67]
    v_mfma_f32_16x16x32_bf16 v[68:71], a[124:127], v[244:247], v[68:71]
    s_mov_b32 s71, 2000000
    s_mov_b32 s63, 0
L_p2:
    s_waitcnt vmcnt(0)
    v_cmp_ne_u32 s[32:33], 0, v40
    s_sub_u32 s71, s71, 1
    s_cselect_b32 s61, 7, 0
    s_or_b32 s61, s61, s32
    s_andn2_b32 s61, s61, s63
    s_bitcmp1_b32 s61, 0
    s_cbranch_scc0 L_p2_n0
    s_add_u32 s62, s91, 0
    buffer_load_dwordx4 v[184:187], v36, s[44:47], s62 offen offset:0 sc1
    buffer_load_dwordx4 v[188:191], v36, s[44:47], s62 offen offset:1024 sc1
L_p2_n0:
    s_bitcmp1_b32 s61, 1
    s_cbranch_scc0 L_p2_n1
    s_add_u32 s62, s91, 4096
    buffer_load_dwordx4 v[200:203], v36, s[44:47], s62 offen offset:0 sc1
    buffer_load_dwordx4 v[204:207], v36, s[44:47], s62 offen offset:1024 sc1
L_p2_n1:
    s_bitcmp1_b32 s61, 2
    s_cbranch_scc0 L_p2_n2
    s_add_u32 s62, s91, 8192
    buffer_load_dwordx4 v[216:219], v36, s[44:47], s62 offen offset:0 sc1
    buffer_load_dwordx4 v[220:223], v36, s[44:47], s62 offen offset:1024 sc1
L_p2_n2:
    s_or_b32 s63, s63, s61
    s_and_b32 s61, s63, 7
    s_cmp_eq_u32 s61, 7
    s_cbranch_scc1 L_p2_x
    buffer_load_dword v40, v38, s[44:47], 0 offen sc1
    s_branch L_p2
L_p2_x:
    s_waitcnt vmcnt(0)
    v_mfma_f32_16x16x32_bf16 v[56:59], v[50:53], v[184:187], v[56:59]
    v_mfma_f32_16x16x32_bf16 v[60:63], v[48:51], v[184:187], v[60:63]
    v_mfma_f32_16x16x32_bf16 v[64:67], v[50:53], v[188:191], v[64:67]
    v_mfma_f32_16x16x32_bf16 v[68:71], v[48:51], v[188:191], v[68:71]
    v_mfma_f32_16x16x32_bf16 v[56:59], v[50:53], v[200:203], v[56:59]
    v_mfma_f32_16x16x32_bf16 v[60:63], v[48:51], v[200:203], v[60:63]
    v_mfma_f32_16x16x32_bf16 v[64:67], v[50:53], v[204:207], v[64:67]
    v_mfma_f32_16x16x32_bf16 v[68:71], v[48:51], v[204:207], v[68:71]
    v_mfma_f32_16x16x32_bf16 v[56:59], v[50:53], v[216:219], v[56:59]
    v_mfma_f32_16x16x32_bf16 v[60:63], v[48:51], v[216:219], v[60:63]
    v_mfma_f32_16x16x32_bf16 v[64:67], v[50:53], v[220:223], v[64:67]
    v_mfma_f32_16x16x32_bf16 v[68:71], v[48:51], v[220:223], v[68:71]
    s_nop 4
    v_cvt_pk_bf16_f32 v152, v56, v57
    v_cvt_pk_bf16_f32 v153, v58, v59
    v_cvt_pk_bf16_f32 v154, v60, v61
    v_cvt_pk_bf16_f32 v155, v62, v63
    v_cvt_pk_bf16_f32 v156, v64, v65
    v_cvt_pk_bf16_f32 v157, v66, v67
    v_cvt_pk_bf16_f32 v158, v68, v69
    v_cvt_pk_bf16_f32 v159, v70, v71
    s_mov_b32 s62, 32768
    v_permlane32_swap_b32 v152, v154
    v_permlane32_swap_b32 v153, v155
    v_permlane32_swap_b32 v156, v158
    v_permlane32_swap_b32 v157, v159
    v_permlane16_swap_b32 v152, v154
    v_permlane16_swap_b32 v153, v155
    v_permlane16_swap_b32 v156, v158
    v_permlane16_swap_b32 v157, v159
    buffer_store_dwordx4 v[152:155], v42, s[48:51], 0 offen
    buffer_store_dwordx4 v[156:159], v42, s[48:51], s62 offen
    s_endpgm
L_burst:
    s_add_u32 m0, s14, 0
    s_xor_b32 s65, s12, 0
    buffer_load_dwordx4 v10, s[24:27], s65 offen offset:0 nt lds
    buffer_load_dwordx4 v11, s[24:27], s65 offen offset:1024 nt lds
    buffer_load_dwordx4 v12, s[24:27], s65 offen offset:2048 nt lds
    buffer_load_dwordx4 v13, s[24:27], s65 offen offset:3072 nt lds
    s_add_u32 m0, s14, 16384
    s_xor_b32 s65, s12, 16384
    buffer_load_dwordx4 v10, s[24:27], s65 offen offset:0 nt lds
    buffer_load_dwordx4 v11, s[24:27], s65 offen offset:1024 nt lds
    buffer_load_dwordx4 v12, s[24:27], s65 offen offset:2048 nt lds
    buffer_load_dwordx4 v13, s[24:27], s65 offen offset:3072 nt lds
    s_add_u32 m0, s14, 32768
    s_xor_b32 s65, s12, 32768
    buffer_load_dwordx4 v10, s[24:27], s65 offen offset:0 nt lds
    buffer_load_dwordx4 v11, s[24:27], s65 offen offset:1024 nt lds
    buffer_load_dwordx4 v12, s[24:27], s65 offen offset:2048 nt lds
    buffer_load_dwordx4 v13, s[24:27], s65 offen offset:3072 nt lds
    s_waitcnt vmcnt(8) lgkmcnt(0)
    s_barrier
    ds_read_b128 a[0:3], v22 offset:0
    ds_read_b128 a[4:7], v22 offset:4096
    ds_read_b128 a[8:11], v23 offset:0
    ds_read_b128 a[12:15], v23 offset:4096
    ds_read_b128 a[16:19], v24 offset:0
    ds_read_b128 a[20:23], v24 offset:4096
    ds_read_b128 a[24:27], v25 offset:0
    ds_read_b128 a[28:31], v25 offset:4096
    s_add_u32 m0, s14, 49152
    s_xor_b32 s65, s12, 49152
    buffer_load_dwordx4 v10, s[24:27], s65 offen offset:0 nt lds
    buffer_load_dwordx4 v11, s[24:27], s65 offen offset:1024 nt lds
    buffer_load_dwordx4 v12, s[24:27], s65 offen offset:2048 nt lds
    buffer_load_dwordx4 v13, s[24:27], s65 offen offset:3072 nt lds
    s_waitcnt vmcnt(8) lgkmcnt(0)
    s_barrier
    ds_read_b128 a[32:35], v22 offset:16384
    ds_read_b128 a[36:39], v22 offset:20480
    ds_read_b128 a[40:43], v23 offset:16384
    ds_read_b128 a[44:47], v23 offset:20480
    ds_read_b128 a[48:51], v24 offset:16384
    ds_read_b128 a[52:55], v24 offset:20480
    ds_read_b128 a[56:59], v25 offset:16384
    ds_read_b128 a[60:63], v25 offset:20480
    s_add_u32 m0, s14, 0
    s_xor_b32 s65, s12, 65536
    buffer_load_dwordx4 v10, s[24:27], s65 offen offset:0 nt lds
    buffer_load_dwordx4 v11, s[24:27], s65 offen offset:1024 nt lds
    buffer_load_dwordx4 v12, s[24:27], s65 offen offset:2048 nt lds
    buffer_load_dwordx4 v13, s[24:27], s65 offen offset:3072 nt lds
    s_waitcnt vmcnt(8) lgkmcnt(0)
    s_barrier
    ds_read_b128 a[64:67], v22 offset:32768
    ds_read_b128 a[68:71], v22 offset:36864
    ds_read_b128 a[72:75], v23 offset:32768
    ds_read_b128 a[76:79], v23 offset:36864
    ds_read_b128 a[80:83], v24 offset:32768
    ds_read_b128 a[84:87], v24 offset:36864
    ds_read_b128 a[88:91], v25 offset:32768
    ds_read_b128 a[92:95], v25 offset:36864
    s_add_u32 m0, s14, 16384
    s_xor_b32 s65, s12, 81920
    buffer_load_dwordx4 v10, s[24:27], s65 offen offset:0 nt lds
    buffer_load_dwordx4 v11, s[24:27], s65 offen offset:1024 nt lds
    buffer_load_dwordx4 v12, s[24:27], s65 offen offset:2048 nt lds
    buffer_load_dwordx4 v13, s[24:27], s65 offen offset:3072 nt lds
    s_waitcnt vmcnt(8) lgkmcnt(0)
    s_barrier
    ds_read_b128 a[96:99], v22 offset:49152
    ds_read_b128 a[100:103], v22 offset:53248
    ds_read_b128 a[104:107], v23 offset:49152
    ds_read_b128 a[108:111], v23 offset:53248
    ds_read_b128 a[112:115], v24 offset:49152
    ds_read_b128 a[116:119], v24 offset:53248
    ds_read_b128 a[120:123], v25 offset:49152
    ds_read_b128 a[124:127], v25 offset:53248
    s_add_u32 m0, s14, 32768
    s_xor_b32 s65, s12, 98304
    buffer_load_dwordx4 v10, s[24:27], s65 offen offset:0 nt lds
    buffer_load_dwordx4 v11, s[24:27], s65 offen offset:1024 nt lds
    buffer_load_dwordx4 v12, s[24:27], s65 offen offset:2048 nt lds
    buffer_load_dwordx4 v13, s[24:27], s65 offen offset:3072 nt lds
    s_waitcnt vmcnt(8) lgkmcnt(0)
    s_barrier
    ds_read_b128 a[128:131], v22 offset:0
    ds_read_b128 a[132:135], v22 offset:4096
    ds_read_b128 a[136:139], v23 offset:0
    ds_read_b128 a[140:143], v23 offset:4096
    ds_read_b128 a[144:147], v24 offset:0
    ds_read_b128 a[148:151], v24 offset:4096
    ds_read_b128 a[152:155], v25 offset:0
    ds_read_b128 a[156:159], v25 offset:4096
    s_add_u32 m0, s14, 49152
    s_xor_b32 s65, s12, 114688
    buffer_load_dwordx4 v10, s[24:27], s65 offen offset:0 nt lds
    buffer_load_dwordx4 v11, s[24:27], s65 offen offset:1024 nt lds
    buffer_load_dwordx4 v12, s[24:27], s65 offen offset:2048 nt lds
    buffer_load_dwordx4 v13, s[24:27], s65 offen offset:3072 nt lds
    s_waitcnt vmcnt(8) lgkmcnt(0)
    s_barrier
    ds_read_b128 a[160:163], v22 offset:16384
    ds_read_b128 a[164:167], v22 offset:20480
    ds_read_b128 a[168:171], v23 offset:16384
    ds_read_b128 a[172:175], v23 offset:20480
    ds_read_b128 a[176:179], v24 offset:16384
    ds_read_b128 a[180:183], v24 offset:20480
    ds_read_b128 a[184:187], v25 offset:16384
    ds_read_b128 a[188:191], v25 offset:20480
    s_add_u32 m0, s14, 0
    s_xor_b32 s65, s12, 8192
    buffer_load_dwordx4 v10, s[24:27], s65 offen offset:0 nt lds
    buffer_load_dwordx4 v11, s[24:27], s65 offen offset:1024 nt lds
    buffer_load_dwordx4 v12, s[24:27], s65 offen offset:2048 nt lds
    buffer_load_dwordx4 v13, s[24:27], s65 offen offset:3072 nt lds
    s_waitcnt vmcnt(8) lgkmcnt(0)
    s_barrier
    ds_read_b128 a[192:195], v22 offset:32768
    ds_read_b128 a[196:199], v22 offset:36864
    ds_read_b128 a[200:203], v23 offset:32768
    ds_read_b128 a[204:207], v23 offset:36864
    ds_read_b128 a[208:211], v24 offset:32768
    ds_read_b128 a[212:215], v24 offset:36864
    ds_read_b128 a[216:219], v25 offset:32768
    ds_read_b128 a[220:223], v25 offset:36864
    s_add_u32 m0, s14, 16384
    s_xor_b32 s65, s12, 24576
    buffer_load_dwordx4 v10, s[24:27], s65 offen offset:0 nt lds
    buffer_load_dwordx4 v11, s[24:27], s65 offen offset:1024 nt lds
    buffer_load_dwordx4 v12, s[24:27], s65 offen offset:2048 nt lds
    buffer_load_dwordx4 v13, s[24:27], s65 offen offset:3072 nt lds
    s_waitcnt vmcnt(8) lgkmcnt(0)
    s_barrier
    ds_read_b128 a[224:227], v22 offset:49152
    ds_read_b128 a[228:231], v22 offset:53248
    ds_read_b128 a[232:235], v23 offset:49152
    ds_read_b128 a[236:239], v23 offset:53248
    ds_read_b128 a[240:243], v24 offset:49152
    ds_read_b128 a[244:247], v24 offset:53248
    ds_read_b128 a[248:251], v25 offset:49152
    ds_read_b128 a[252:255], v25 offset:53248
    s_add_u32 m0, s14, 32768
    s_xor_b32 s65, s12, 40960
    buffer_load_dwordx4 v10, s[24:27], s65 offen offset:0 nt lds
    buffer_load_dwordx4 v11, s[24:27], s65 offen offset:1024 nt lds
    buffer_load_dwordx4 v12, s[24:27], s65 offen offset:2048 nt lds
    buffer_load_dwordx4 v13, s[24:27], s65 offen offset:3072 nt lds
    s_waitcnt vmcnt(8) lgkmcnt(0)
    s_barrier
    ds_read_b128 v[216:219], v22 offset:0
    ds_read_b128 v[220:223], v22 offset:4096
    ds_read_b128 v[224:227], v23 offset:0
    ds_read_b128 v[228:231], v23 offset:4096
    ds_read_b128 v[232:235], v24 offset:0
    ds_read_b128 v[236:239], v24 offset:4096
    ds_read_b128 v[240:243], v25 offset:0
    ds_read_b128 v[244:247], v25 offset:4096
    s_add_u32 m0, s14, 49152
    s_xor_b32 s65, s12, 57344
    buffer_load_dwordx4 v10, s[24:27], s65 offen offset:0 nt lds
    buffer_load_dwordx4 v11, s[24:27], s65 offen offset:1024 nt lds
    buffer_load_dwordx4 v12, s[24:27], s65 offen offset:2048 nt lds
    buffer_load_dwordx4 v13, s[24:27], s65 offen offset:3072 nt lds
    s_waitcnt lgkmcnt(0)
    s_barrier
    s_add_u32 m0, s14, 0
    s_xor_b32 s65, s12, 73728
    buffer_load_dwordx4 v10, s[24:27], s65 offen offset:0 nt lds
    buffer_load_dwordx4 v11, s[24:27], s65 offen offset:1024 nt lds
    buffer_load_dwordx4 v12, s[24:27], s65 offen offset:2048 nt lds
    buffer_load_dwordx4 v13, s[24:27], s65 offen offset:3072 nt lds
    s_setpc_b64 s[32:33]
L_end:
    s_endpgm
L_rare_1:
    v_max3_f32 v42, v104, v105, v106
    v_max3_f32 v42, v42, v107, v108
    v_max3_f32 v42, v42, v109, v110
    v_max_f32 v42, v42, v111
    v_mov_b32 v56, v42
    s_nop 1
    v_permlane32_swap_b32 v42, v56
    v_max_f32 v42, v42, v56
    v_mov_b32 v56, v42
    s_nop 1
    v_permlane16_swap_b32 v42, v56
    v_max_f32 v42, v42, v56
    v_ceil_f32 v42, v42
    v_max_f32 v42, 0, v42
    v_sub_f32 v44, v44, v42
    v_sub_f32 v104, v104, v42
    v_sub_f32 v105, v105, v42
    v_sub_f32 v106, v106, v42
    v_sub_f32 v107, v107, v42
    v_sub_f32 v108, v108, v42
    v_sub_f32 v109, v109, v42
    v_sub_f32 v110, v110, v42
    v_sub_f32 v111, v111, v42
    v_min_f32 v42, 0x43960000, v42
    v_cvt_i32_f32 v42, v42
    v_sub_u32 v42, 0, v42
    v_max3_f32 v43, v112, v113, v114
    v_max3_f32 v43, v43, v115, v116
    v_max3_f32 v43, v43, v117, v118
    v_max_f32 v43, v43, v119
    v_mov_b32 v56, v43
    s_nop 1
    v_permlane32_swap_b32 v43, v56
    v_max_f32 v43, v43, v56
    v_mov_b32 v56, v43
    s_nop 1
    v_permlane16_swap_b32 v43, v56
    v_max_f32 v43, v43, v56
    v_ceil_f32 v43, v43
    v_max_f32 v43, 0, v43
    v_sub_f32 v45, v45, v43
    v_sub_f32 v112, v112, v43
    v_sub_f32 v113, v113, v43
    v_sub_f32 v114, v114, v43
    v_sub_f32 v115, v115, v43
    v_sub_f32 v116, v116, v43
    v_sub_f32 v117, v117, v43
    v_sub_f32 v118, v118, v43
    v_sub_f32 v119, v119, v43
    v_min_f32 v43, 0x43960000, v43
    v_cvt_i32_f32 v43, v43
    v_sub_u32 v43, 0, v43
    s_call_b64 s[32:33], L_fix_1
    s_branch L_back_1
L_rare_2:
    v_max3_f32 v42, v88, v89, v90
    v_max3_f32 v42, v42, v91, v92
    v_max3_f32 v42, v42, v93, v94
    v_max_f32 v42, v42, v95
    v_mov_b32 v56, v42
    s_nop 1
    v_permlane32_swap_b32 v42, v56
    v_max_f32 v42, v42, v56
    v_mov_b32 v56, v42
    s_nop 1
    v_permlane16_swap_b32 v42, v56
    v_max_f32 v42, v42, v56
    v_ceil_f32 v42, v42
    v_max_f32 v42, 0, v42
    v_sub_f32 v44, v44, v42
    v_sub_f32 v88, v88, v42
    v_sub_f32 v89, v89, v42
    v_sub_f32 v90, v90, v42
    v_sub_f32 v91, v91, v42
    v_sub_f32 v92, v92, v42
    v_sub_f32 v93, v93, v42
    v_sub_f32 v94, v94, v42
    v_sub_f32 v95, v95, v42
    v_min_f32 v42, 0x43960000, v42
    v_cvt_i32_f32 v42, v42
    v_sub_u32 v42, 0, v42
    v_max3_f32 v43, v96, v97, v98
    v_max3_f32 v43, v43, v99, v100
    v_max3_f32 v43, v43, v101, v102
    v_max_f32 v43, v43, v103
    v_mov_b32 v56, v43
    s_nop 1
    v_permlane32_swap_b32 v43, v56
    v_max_f32 v43, v43, v56
    v_mov_b32 v56, v43
    s_nop 1
    v_permlane16_swap_b32 v43, v56
    v_max_f32 v43, v43, v56
    v_ceil_f32 v43, v43
    v_max_f32 v43, 0, v43
    v_sub_f32 v45, v45, v43
    v_sub_f32 v96, v96, v43
    v_sub_f32 v97, v97, v43
    v_sub_f32 v98, v98, v43
    v_sub_f32 v99, v99, v43
    v_sub_f32 v100, v100, v43
    v_sub_f32 v101, v101, v43
    v_sub_f32 v102, v102, v43
    v_sub_f32 v103, v103, v43
    v_min_f32 v43, 0x43960000, v43
    v_cvt_i32_f32 v43, v43
    v_sub_u32 v43, 0, v43
    s_call_b64 s[32:33], L_fix_2
    s_branch L_back_2
L_rare_3:
    v_max3_f32 v42, v104, v105, v106
    v_max3_f32 v42, v42, v107, v108
    v_max3_f32 v42, v42, v109, v110
    v_max_f32 v42, v42, v111
    v_mov_b32 v56, v42
    s_nop 1
    v_permlane32_swap_b32 v42, v56
    v_max_f32 v42, v42, v56
    v_mov_b32 v56, v42
    s_nop 1
    v_permlane16_swap_b32 v42, v56
    v_max_f32 v42, v42, v56
    v_ceil_f32 v42, v42
    v_max_f32 v42, 0, v42
    v_sub_f32 v44, v44, v42
    v_sub_f32 v104, v104, v42
    v_sub_f32 v105, v105, v42
    v_sub_f32 v106, v106, v42
    v_sub_f32 v107, v107, v42
    v_sub_f32 v108, v108, v42
    v_sub_f32 v109, v109, v42
    v_sub_f32 v110, v110, v42
    v_sub_f32 v111, v111, v42
    v_min_f32 v42, 0x43960000, v42
    v_cvt_i32_f32 v42, v42
    v_sub_u32 v42, 0, v42
    v_max3_f32 v43, v112, v113, v114
    v_max3_f32 v43, v43, v115, v116
    v_max3_f32 v43, v43, v117, v118
    v_max_f32 v43, v43, v119
    v_mov_b32 v56, v43
    s_nop 1
    v_permlane32_swap_b32 v43, v56
    v_max_f32 v43, v43, v56
    v_mov_b32 v56, v43
    s_nop 1
    v_permlane16_swap_b32 v43, v56
    v_max_f32 v43, v43, v56
    v_ceil_f32 v43, v43
    v_max_f32 v43, 0, v43
    v_sub_f32 v45, v45, v43
    v_sub_f32 v112, v112, v43
    v_sub_f32 v113, v113, v43
    v_sub_f32 v114, v114, v43
    v_sub_f32 v115, v115, v43
    v_sub_f32 v116, v116, v43
    v_sub_f32 v117, v117, v43
    v_sub_f32 v118, v118, v43
    v_sub_f32 v119, v119, v43
    v_min_f32 v43, 0x43960000, v43
    v_cvt_i32_f32 v43, v43
    v_sub_u32 v43, 0, v43
    s_call_b64 s[32:33], L_fix_3
    s_branch L_back_3
L_rare_4:
    v_max3_f32 v42, v88, v89, v90
    v_max3_f32 v42, v42, v91, v92
    v_max3_f32 v42, v42, v93, v94
    v_max_f32 v42, v42, v95
    v_mov_b32 v56, v42
    s_nop 1
    v_permlane32_swap_b32 v42, v56
    v_max_f32 v42, v42, v56
    v_mov_b32 v56, v42
    s_nop 1
    v_permlane16_swap_b32 v42, v56
    v_max_f32 v42, v42, v56
    v_ceil_f32 v42, v42
    v_max_f32 v42, 0, v42
    v_sub_f32 v44, v44, v42
    v_sub_f32 v88, v88, v42
    v_sub_f32 v89, v89, v42
    v_sub_f32 v90, v90, v42
    v_sub_f32 v91, v91, v42
    v_sub_f32 v92, v92, v42
    v_sub_f32 v93, v93, v42
    v_sub_f32 v94, v94, v42
    v_sub_f32 v95, v95, v42
    v_min_f32 v42, 0x43960000, v42
    v_cvt_i32_f32 v42, v42
    v_sub_u32 v42, 0, v42
    v_max3_f32 v43, v96, v97, v98
    v_max3_f32 v43, v43, v99, v100
    v_max3_f32 v43, v43, v101, v102
    v_max_f32 v43, v43, v103
    v_mov_b32 v56, v43
    s_nop 1
    v_permlane32_swap_b32 v43, v56
    v_max_f32 v43, v43, v56
    v_mov_b32 v56, v43
    s_nop 1
    v_permlane16_swap_b32 v43, v56
    v_max_f32 v43, v43, v56
    v_ceil_f32 v43, v43
    v_max_f32 v43, 0, v43
    v_sub_f32 v45, v45, v43
    v_sub_f32 v96, v96, v43
    v_sub_f32 v97, v97, v43
    v_sub_f32 v98, v98, v43
    v_sub_f32 v99, v99, v43
    v_sub_f32 v100, v100, v43
    v_sub_f32 v101, v101, v43
    v_sub_f32 v102, v102, v43
    v_sub_f32 v103, v103, v43
    v_min_f32 v43, 0x43960000, v43
    v_cvt_i32_f32 v43, v43
    v_sub_u32 v43, 0, v43
    s_call_b64 s[32:33], L_fix_4
    s_branch L_back_4
L_rare_5:
    v_max3_f32 v42, v104, v105, v106
    v_max3_f32 v42, v42, v107, v108
    v_max3_f32 v42, v42, v109, v110
    v_max_f32 v42, v42, v111
    v_mov_b32 v56, v42
    s_nop 1
    v_permlane32_swap_b32 v42, v56
    v_max_f32 v42, v42, v56
    v_mov_b32 v56, v42
    s_nop 1
    v_permlane16_swap_b32 v42, v56
    v_max_f32 v42, v42, v56
    v_ceil_f32 v42, v42
    v_max_f32 v42, 0, v42
    v_sub_f32 v44, v44, v42
    v_sub_f32 v104, v104, v42
    v_sub_f32 v105, v105, v42
    v_sub_f32 v106, v106, v42
    v_sub_f32 v107, v107, v42
    v_sub_f32 v108, v108, v42
    v_sub_f32 v109, v109, v42
    v_sub_f32 v110, v110, v42
    v_sub_f32 v111, v111, v42
    v_min_f32 v42, 0x43960000, v42
    v_cvt_i32_f32 v42, v42
    v_sub_u32 v42, 0, v42
    v_max3_f32 v43, v112, v113, v114
    v_max3_f32 v43, v43, v115, v116
    v_max3_f32 v43, v43, v117, v118
    v_max_f32 v43, v43, v119
    v_mov_b32 v56, v43
    s_nop 1
    v_permlane32_swap_b32 v43, v56
    v_max_f32 v43, v43, v56
    v_mov_b32 v56, v43
    s_nop 1
    v_permlane16_swap_b32 v43, v56
    v_max_f32 v43, v43, v56
    v_ceil_f32 v43, v43
    v_max_f32 v43, 0, v43
    v_sub_f32 v45, v45, v43
    v_sub_f32 v112, v112, v43
    v_sub_f32 v113, v113, v43
    v_sub_f32 v114, v114, v43
    v_sub_f32 v115, v115, v43
    v_sub_f32 v116, v116, v43
    v_sub_f32 v117, v117, v43
    v_sub_f32 v118, v118, v43
    v_sub_f32 v119, v119, v43
    v_min_f32 v43, 0x43960000, v43
    v_cvt_i32_f32 v43, v43
    v_sub_u32 v43, 0, v43
    s_call_b64 s[32:33], L_fix_5
    s_branch L_back_5
L_rare_6:
    v_max3_f32 v42, v88, v89, v90
    v_max3_f32 v42, v42, v91, v92
    v_max3_f32 v42, v42, v93, v94
    v_max_f32 v42, v42, v95
    v_mov_b32 v56, v42
    s_nop 1
    v_permlane32_swap_b32 v42, v56
    v_max_f32 v42, v42, v56
    v_mov_b32 v56, v42
    s_nop 1
    v_permlane16_swap_b32 v42, v56
    v_max_f32 v42, v42, v56
    v_ceil_f32 v42, v42
    v_max_f32 v42, 0, v42
    v_sub_f32 v44, v44, v42
    v_sub_f32 v88, v88, v42
    v_sub_f32 v89, v89, v42
    v_sub_f32 v90, v90, v42
    v_sub_f32 v91, v91, v42
    v_sub_f32 v92, v92, v42
    v_sub_f32 v93, v93, v42
    v_sub_f32 v94, v94, v42
    v_sub_f32 v95, v95, v42
    v_min_f32 v42, 0x43960000, v42
    v_cvt_i32_f32 v42, v42
    v_sub_u32 v42, 0, v42
    v_max3_f32 v43, v96, v97, v98
    v_max3_f32 v43, v43, v99, v100
    v_max3_f32 v43, v43, v101, v102
    v_max_f32 v43, v43, v103
    v_mov_b32 v56, v43
    s_nop 1
    v_permlane32_swap_b32 v43, v56
    v_max_f32 v43, v43, v56
    v_mov_b32 v56, v43
    s_nop 1
    v_permlane16_swap_b32 v43, v56
    v_max_f32 v43, v43, v56
    v_ceil_f32 v43, v43
    v_max_f32 v43, 0, v43
    v_sub_f32 v45, v45, v43
    v_sub_f32 v96, v96, v43
    v_sub_f32 v97, v97, v43
    v_sub_f32 v98, v98, v43
    v_sub_f32 v99, v99, v43
    v_sub_f32 v100, v100, v43
    v_sub_f32 v101, v101, v43
    v_sub_f32 v102, v102, v43
    v_sub_f32 v103, v103, v43
    v_min_f32 v43, 0x43960000, v43
    v_cvt_i32_f32 v43, v43
    v_sub_u32 v43, 0, v43
    s_call_b64 s[32:33], L_fix_6
    s_branch L_back_6
L_rare_7:
    v_max3_f32 v42, v104, v105, v106
    v_max3_f32 v42, v42, v107, v108
    v_max3_f32 v42, v42, v109, v110
    v_max_f32 v42, v42, v111
    v_mov_b32 v56, v42
    s_nop 1
    v_permlane32_swap_b32 v42, v56
    v_max_f32 v42, v42, v56
    v_mov_b32 v56, v42
    s_nop 1
    v_permlane16_swap_b32 v42, v56
    v_max_f32 v42, v42, v56
    v_ceil_f32 v42, v42
    v_max_f32 v42, 0, v42
    v_sub_f32 v44, v44, v42
    v_sub_f32 v104, v104, v42
    v_sub_f32 v105, v105, v42
    v_sub_f32 v106, v106, v42
    v_sub_f32 v107, v107, v42
    v_sub_f32 v108, v108, v42
    v_sub_f32 v109, v109, v42
    v_sub_f32 v110, v110, v42
    v_sub_f32 v111, v111, v42
    v_min_f32 v42, 0x43960000, v42
    v_cvt_i32_f32 v42, v42
    v_sub_u32 v42, 0, v42
    v_max3_f32 v43, v112, v113, v114
    v_max3_f32 v43, v43, v115, v116
    v_max3_f32 v43, v43, v117, v118
    v_max_f32 v43, v43, v119
    v_mov_b32 v56, v43
    s_nop 1
    v_permlane32_swap_b32 v43, v56
    v_max_f32 v43, v43, v56
    v_mov_b32 v56, v43
    s_nop 1
    v_permlane16_swap_b32 v43, v56
    v_max_f32 v43, v43, v56
    v_ceil_f32 v43, v43
    v_max_f32 v43, 0, v43
    v_sub_f32 v45, v45, v43
    v_sub_f32 v112, v112, v43
    v_sub_f32 v113, v113, v43
    v_sub_f32 v114, v114, v43
    v_sub_f32 v115, v115, v43
    v_sub_f32 v116, v116, v43
    v_sub_f32 v117, v117, v43
    v_sub_f32 v118, v118, v43
    v_sub_f32 v119, v119, v43
    v_min_f32 v43, 0x43960000, v43
    v_cvt_i32_f32 v43, v43
    v_sub_u32 v43, 0, v43
    s_call_b64 s[32:33], L_fix_7
    s_branch L_back_7
L_rare_8:
    v_max3_f32 v42, v88, v89, v90
    v_max3_f32 v42, v42, v91, v92
    v_max3_f32 v42, v42, v93, v94
    v_max_f32 v42, v42, v95
    v_mov_b32 v56, v42
    s_nop 1
    v_permlane32_swap_b32 v42, v56
    v_max_f32 v42, v42, v56
    v_mov_b32 v56, v42
    s_nop 1
    v_permlane16_swap_b32 v42, v56
    v_max_f32 v42, v42, v56
    v_ceil_f32 v42, v42
    v_max_f32 v42, 0, v42
    v_sub_f32 v44, v44, v42
    v_sub_f32 v88, v88, v42
    v_sub_f32 v89, v89, v42
    v_sub_f32 v90, v90, v42
    v_sub_f32 v91, v91, v42
    v_sub_f32 v92, v92, v42
    v_sub_f32 v93, v93, v42
    v_sub_f32 v94, v94, v42
    v_sub_f32 v95, v95, v42
    v_min_f32 v42, 0x43960000, v42
    v_cvt_i32_f32 v42, v42
    v_sub_u32 v42, 0, v42
    v_max3_f32 v43, v96, v97, v98
    v_max3_f32 v43, v43, v99, v100
    v_max3_f32 v43, v43, v101, v102
    v_max_f32 v43, v43, v103
    v_mov_b32 v56, v43
    s_nop 1
    v_permlane32_swap_b32 v43, v56
    v_max_f32 v43, v43, v56
    v_mov_b32 v56, v43
    s_nop 1
    v_permlane16_swap_b32 v43, v56
    v_max_f32 v43, v43, v56
    v_ceil_f32 v43, v43
    v_max_f32 v43, 0, v43
    v_sub_f32 v45, v45, v43
    v_sub_f32 v96, v96, v43
    v_sub_f32 v97, v97, v43
    v_sub_f32 v98, v98, v43
    v_sub_f32 v99, v99, v43
    v_sub_f32 v100, v100, v43
    v_sub_f32 v101, v101, v43
    v_sub_f32 v102, v102, v43
    v_sub_f32 v103, v103, v43
    v_min_f32 v43, 0x43960000, v43
    v_cvt_i32_f32 v43, v43
    v_sub_u32 v43, 0, v43
    s_call_b64 s[32:33], L_fix_8
    s_branch L_back_8
L_rare_9:
    v_max3_f32 v42, v104, v105, v106
    v_max3_f32 v42, v42, v107, v108
    v_max3_f32 v42, v42, v109, v110
    v_max_f32 v42, v42, v111
    v_mov_b32 v56, v42
    s_nop 1
    v_permlane32_swap_b32 v42, v56
    v_max_f32 v42, v42, v56
    v_mov_b32 v56, v42
    s_nop 1
    v_permlane16_swap_b32 v42, v56
    v_max_f32 v42, v42, v56
    v_ceil_f32 v42, v42
    v_max_f32 v42, 0, v42
    v_sub_f32 v44, v44, v42
    v_sub_f32 v104, v104, v42
    v_sub_f32 v105, v105, v42
    v_sub_f32 v106, v106, v42
    v_sub_f32 v107, v107, v42
    v_sub_f32 v108, v108, v42
    v_sub_f32 v109, v109, v42
    v_sub_f32 v110, v110, v42
    v_sub_f32 v111, v111, v42
    v_min_f32 v42, 0x43960000, v42
    v_cvt_i32_f32 v42, v42
    v_sub_u32 v42, 0, v42
    v_max3_f32 v43, v112, v113, v114
    v_max3_f32 v43, v43, v115, v116
    v_max3_f32 v43, v43, v117, v118
    v_max_f32 v43, v43, v119
    v_mov_b32 v56, v43
    s_nop 1
    v_permlane32_swap_b32 v43, v56
    v_max_f32 v43, v43, v56
    v_mov_b32 v56, v43
    s_nop 1
    v_permlane16_swap_b32 v43, v56
    v_max_f32 v43, v43, v56
    v_ceil_f32 v43, v43
    v_max_f32 v43, 0, v43
    v_sub_f32 v45, v45, v43
    v_sub_f32 v112, v112, v43
    v_sub_f32 v113, v113, v43
    v_sub_f32 v114, v114, v43
    v_sub_f32 v115, v115, v43
    v_sub_f32 v116, v116, v43
    v_sub_f32 v117, v117, v43
    v_sub_f32 v118, v118, v43
    v_sub_f32 v119, v119, v43
    v_min_f32 v43, 0x43960000, v43
    v_cvt_i32_f32 v43, v43
    v_sub_u32 v43, 0, v43
    s_call_b64 s[32:33], L_fix_9
    s_branch L_back_9
L_rare_10:
    v_max3_f32 v42, v88, v89, v90
    v_max3_f32 v42, v42, v91, v92
    v_max3_f32 v42, v42, v93, v94
    v_max_f32 v42, v42, v95
    v_mov_b32 v56, v42
    s_nop 1
    v_permlane32_swap_b32 v42, v56
    v_max_f32 v42, v42, v56
    v_mov_b32 v56, v42
    s_nop 1
    v_permlane16_swap_b32 v42, v56
    v_max_f32 v42, v42, v56
    v_ceil_f32 v42, v42
    v_max_f32 v42, 0, v42
    v_sub_f32 v44, v44, v42
    v_sub_f32 v88, v88, v42
    v_sub_f32 v89, v89, v42
    v_sub_f32 v90, v90, v42
    v_sub_f32 v91, v91, v42
    v_sub_f32 v92, v92, v42
    v_sub_f32 v93, v93, v42
    v_sub_f32 v94, v94, v42
    v_sub_f32 v95, v95, v42
    v_min_f32 v42, 0x43960000, v42
    v_cvt_i32_f32 v42, v42
    v_sub_u32 v42, 0, v42
    v_max3_f32 v43, v96, v97, v98
    v_max3_f32 v43, v43, v99, v100
    v_max3_f32 v43, v43, v101, v102
    v_max_f32 v43, v43, v103
    v_mov_b32 v56, v43
    s_nop 1
    v_permlane32_swap_b32 v43, v56
    v_max_f32 v43, v43, v56
    v_mov_b32 v56, v43
    s_nop 1
    v_permlane16_swap_b32 v43, v56
    v_max_f32 v43, v43, v56
    v_ceil_f32 v43, v43
    v_max_f32 v43, 0, v43
    v_sub_f32 v45, v45, v43
    v_sub_f32 v96, v96, v43
    v_sub_f32 v97, v97, v43
    v_sub_f32 v98, v98, v43
    v_sub_f32 v99, v99, v43
    v_sub_f32 v100, v100, v43
    v_sub_f32 v101, v101, v43
    v_sub_f32 v102, v102, v43
    v_sub_f32 v103, v103, v43
    v_min_f32 v43, 0x43960000, v43
    v_cvt_i32_f32 v43, v43
    v_sub_u32 v43, 0, v43
    s_call_b64 s[32:33], L_fix_10
    s_branch L_back_10
L_rare_11:
    v_max3_f32 v42, v104, v105, v106
    v_max3_f32 v42, v42, v107, v108
    v_max3_f32 v42, v42, v109, v110
    v_max_f32 v42, v42, v111
    v_mov_b32 v56, v42
    s_nop 1
    v_permlane32_swap_b32 v42, v56
    v_max_f32 v42, v42, v56
    v_mov_b32 v56, v42
    s_nop 1
    v_permlane16_swap_b32 v42, v56
    v_max_f32 v42, v42, v56
    v_ceil_f32 v42, v42
    v_max_f32 v42, 0, v42
    v_sub_f32 v44, v44, v42
    v_sub_f32 v104, v104, v42
    v_sub_f32 v105, v105, v42
    v_sub_f32 v106, v106, v42
    v_sub_f32 v107, v107, v42
    v_sub_f32 v108, v108, v42
    v_sub_f32 v109, v109, v42
    v_sub_f32 v110, v110, v42
    v_sub_f32 v111, v111, v42
    v_min_f32 v42, 0x43960000, v42
    v_cvt_i32_f32 v42, v42
    v_sub_u32 v42, 0, v42
    v_max3_f32 v43, v112, v113, v114
    v_max3_f32 v43, v43, v115, v116
    v_max3_f32 v43, v43, v117, v118
    v_max_f32 v43, v43, v119
    v_mov_b32 v56, v43
    s_nop 1
    v_permlane32_swap_b32 v43, v56
    v_max_f32 v43, v43, v56
    v_mov_b32 v56, v43
    s_nop 1
    v_permlane16_swap_b32 v43, v56
    v_max_f32 v43, v43, v56
    v_ceil_f32 v43, v43
    v_max_f32 v43, 0, v43
    v_sub_f32 v45, v45, v43
    v_sub_f32 v112, v112, v43
    v_sub_f32 v113, v113, v43
    v_sub_f32 v114, v114, v43
    v_sub_f32 v115, v115, v43
    v_sub_f32 v116, v116, v43
    v_sub_f32 v117, v117, v43
    v_sub_f32 v118, v118, v43
    v_sub_f32 v119, v119, v43
    v_min_f32 v43, 0x43960000, v43
    v_cvt_i32_f32 v43, v43
    v_sub_u32 v43, 0, v43
    s_call_b64 s[32:33], L_fix_11
    s_branch L_back_11
L_rare_12:
    v_max3_f32 v42, v88, v89, v90
    v_max3_f32 v42, v42, v91, v92
    v_max3_f32 v42, v42, v93, v94
    v_max_f32 v42, v42, v95
    v_mov_b32 v56, v42
    s_nop 1
    v_permlane32_swap_b32 v42, v56
    v_max_f32 v42, v42, v56
    v_mov_b32 v56, v42
    s_nop 1
    v_permlane16_swap_b32 v42, v56
    v_max_f32 v42, v42, v56
    v_ceil_f32 v42, v42
    v_max_f32 v42, 0, v42
    v_sub_f32 v44, v44, v42
    v_sub_f32 v88, v88, v42
    v_sub_f32 v89, v89, v42
    v_sub_f32 v90, v90, v42
    v_sub_f32 v91, v91, v42
    v_sub_f32 v92, v92, v42
    v_sub_f32 v93, v93, v42
    v_sub_f32 v94, v94, v42
    v_sub_f32 v95, v95, v42
    v_min_f32 v42, 0x43960000, v42
    v_cvt_i32_f32 v42, v42
    v_sub_u32 v42, 0, v42
    v_max3_f32 v43, v96, v97, v98
    v_max3_f32 v43, v43, v99, v100
    v_max3_f32 v43, v43, v101, v102
    v_max_f32 v43, v43, v103
    v_mov_b32 v56, v43
    s_nop 1
    v_permlane32_swap_b32 v43, v56
    v_max_f32 v43, v43, v56
    v_mov_b32 v56, v43
    s_nop 1
    v_permlane16_swap_b32 v43, v56
    v_max_f32 v43, v43, v56
    v_ceil_f32 v43, v43
    v_max_f32 v43, 0, v43
    v_sub_f32 v45, v45, v43
    v_sub_f32 v96, v96, v43
    v_sub_f32 v97, v97, v43
    v_sub_f32 v98, v98, v43
    v_sub_f32 v99, v99, v43
    v_sub_f32 v100, v100, v43
    v_sub_f32 v101, v101, v43
    v_sub_f32 v102, v102, v43
    v_sub_f32 v103, v103, v43
    v_min_f32 v43, 0x43960000, v43
    v_cvt_i32_f32 v43, v43
    v_sub_u32 v43, 0, v43
    s_call_b64 s[32:33], L_fix_12
    s_branch L_back_12
L_rare_13:
    v_max3_f32 v42, v104, v105, v106
    v_max3_f32 v42, v42, v107, v108
    v_max3_f32 v42, v42, v109, v110
    v_max_f32 v42, v42, v111
    v_mov_b32 v56, v42
    s_nop 1
    v_permlane32_swap_b32 v42, v56
    v_max_f32 v42, v42, v56
    v_mov_b32 v56, v42
    s_nop 1
    v_permlane16_swap_b32 v42, v56
    v_max_f32 v42, v42, v56
    v_ceil_f32 v42, v42
    v_max_f32 v42, 0, v42
    v_sub_f32 v44, v44, v42
    v_sub_f32 v104, v104, v42
    v_sub_f32 v105, v105, v42
    v_sub_f32 v106, v106, v42
    v_sub_f32 v107, v107, v42
    v_sub_f32 v108, v108, v42
    v_sub_f32 v109, v109, v42
    v_sub_f32 v110, v110, v42
    v_sub_f32 v111, v111, v42
    v_min_f32 v42, 0x43960000, v42
    v_cvt_i32_f32 v42, v42
    v_sub_u32 v42, 0, v42
    v_max3_f32 v43, v112, v113, v114
    v_max3_f32 v43, v43, v115, v116
    v_max3_f32 v43, v43, v117, v118
    v_max_f32 v43, v43, v119
    v_mov_b32 v56, v43
    s_nop 1
    v_permlane32_swap_b32 v43, v56
    v_max_f32 v43, v43, v56
    v_mov_b32 v56, v43
    s_nop 1
    v_permlane16_swap_b32 v43, v56
    v_max_f32 v43, v43, v56
    v_ceil_f32 v43, v43
    v_max_f32 v43, 0, v43
    v_sub_f32 v45, v45, v43
    v_sub_f32 v112, v112, v43
    v_sub_f32 v113, v113, v43
    v_sub_f32 v114, v114, v43
    v_sub_f32 v115, v115, v43
    v_sub_f32 v116, v116, v43
    v_sub_f32 v117, v117, v43
    v_sub_f32 v118, v118, v43
    v_sub_f32 v119, v119, v43
    v_min_f32 v43, 0x43960000, v43
    v_cvt_i32_f32 v43, v43
    v_sub_u32 v43, 0, v43
    s_call_b64 s[32:33], L_fix_13
    s_branch L_back_13
L_rare_14:
    v_max3_f32 v42, v88, v89, v90
    v_max3_f32 v42, v42, v91, v92
    v_max3_f32 v42, v42, v93, v94
    v_max_f32 v42, v42, v95
    v_mov_b32 v56, v42
    s_nop 1
    v_permlane32_swap_b32 v42, v56
    v_max_f32 v42, v42, v56
    v_mov_b32 v56, v42
    s_nop 1
    v_permlane16_swap_b32 v42, v56
    v_max_f32 v42, v42, v56
    v_ceil_f32 v42, v42
    v_max_f32 v42, 0, v42
    v_sub_f32 v44, v44, v42
    v_sub_f32 v88, v88, v42
    v_sub_f32 v89, v89, v42
    v_sub_f32 v90, v90, v42
    v_sub_f32 v91, v91, v42
    v_sub_f32 v92, v92, v42
    v_sub_f32 v93, v93, v42
    v_sub_f32 v94, v94, v42
    v_sub_f32 v95, v95, v42
    v_min_f32 v42, 0x43960000, v42
    v_cvt_i32_f32 v42, v42
    v_sub_u32 v42, 0, v42
    v_max3_f32 v43, v96, v97, v98
    v_max3_f32 v43, v43, v99, v100
    v_max3_f32 v43, v43, v101, v102
    v_max_f32 v43, v43, v103
    v_mov_b32 v56, v43
    s_nop 1
    v_permlane32_swap_b32 v43, v56
    v_max_f32 v43, v43, v56
    v_mov_b32 v56, v43
    s_nop 1
    v_permlane16_swap_b32 v43, v56
    v_max_f32 v43, v43, v56
    v_ceil_f32 v43, v43
    v_max_f32 v43, 0, v43
    v_sub_f32 v45, v45, v43
    v_sub_f32 v96, v96, v43
    v_sub_f32 v97, v97, v43
    v_sub_f32 v98, v98, v43
    v_sub_f32 v99, v99, v43
    v_sub_f32 v100, v100, v43
    v_sub_f32 v101, v101, v43
    v_sub_f32 v102, v102, v43
    v_sub_f32 v103, v103, v43
    v_min_f32 v43, 0x43960000, v43
    v_cvt_i32_f32 v43, v43
    v_sub_u32 v43, 0, v43
    s_call_b64 s[32:33], L_fix_14
    s_branch L_back_14
L_rare_15:
    v_max3_f32 v42, v104, v105, v106
    v_max3_f32 v42, v42, v107, v108
    v_max3_f32 v42, v42, v109, v110
    v_max_f32 v42, v42, v111
    v_mov_b32 v56, v42
    s_nop 1
    v_permlane32_swap_b32 v42, v56
    v_max_f32 v42, v42, v56
    v_mov_b32 v56, v42
    s_nop 1
    v_permlane16_swap_b32 v42, v56
    v_max_f32 v42, v42, v56
    v_ceil_f32 v42, v42
    v_max_f32 v42, 0, v42
    v_sub_f32 v44, v44, v42
    v_sub_f32 v104, v104, v42
    v_sub_f32 v105, v105, v42
    v_sub_f32 v106, v106, v42
    v_sub_f32 v107, v107, v42
    v_sub_f32 v108, v108, v42
    v_sub_f32 v109, v109, v42
    v_sub_f32 v110, v110, v42
    v_sub_f32 v111, v111, v42
    v_min_f32 v42, 0x43960000, v42
    v_cvt_i32_f32 v42, v42
    v_sub_u32 v42, 0, v42
    v_max3_f32 v43, v112, v113, v114
    v_max3_f32 v43, v43, v115, v116
    v_max3_f32 v43, v43, v117, v118
    v_max_f32 v43, v43, v119
    v_mov_b32 v56, v43
    s_nop 1
    v_permlane32_swap_b32 v43, v56
    v_max_f32 v43, v43, v56
    v_mov_b32 v56, v43
    s_nop 1
    v_permlane16_swap_b32 v43, v56
    v_max_f32 v43, v43, v56
    v_ceil_f32 v43, v43
    v_max_f32 v43, 0, v43
    v_sub_f32 v45, v45, v43
    v_sub_f32 v112, v112, v43
    v_sub_f32 v113, v113, v43
    v_sub_f32 v114, v114, v43
    v_sub_f32 v115, v115, v43
    v_sub_f32 v116, v116, v43
    v_sub_f32 v117, v117, v43
    v_sub_f32 v118, v118, v43
    v_sub_f32 v119, v119, v43
    v_min_f32 v43, 0x43960000, v43
    v_cvt_i32_f32 v43, v43
    v_sub_u32 v43, 0, v43
    s_call_b64 s[32:33], L_fix_15
    s_branch L_back_15
L_fix_15:
    v_accvgpr_read_b32 v56, a112
    v_lshlrev_b32 v57, 16, v56
    v_and_b32 v56, 0xffff0000, v56
    v_ldexp_f32 v57, v57, v42
    v_ldexp_f32 v56, v56, v42
    v_cvt_pk_bf16_f32 v56, v57, v56
    v_accvgpr_write_b32 a112, v56
    v_accvgpr_read_b32 v56, a113
    v_lshlrev_b32 v57, 16, v56
    v_and_b32 v56, 0xffff0000, v56
    v_ldexp_f32 v57, v57, v42
    v_ldexp_f32 v56, v56, v42
    v_cvt_pk_bf16_f32 v56, v57, v56
    v_accvgpr_write_b32 a113, v56
    v_accvgpr_read_b32 v56, a114
    v_lshlrev_b32 v57, 16, v56
    v_and_b32 v56, 0xffff0000, v56
    v_ldexp_f32 v57, v57, v42
    v_ldexp_f32 v56, v56, v42
    v_cvt_pk_bf16_f32 v56, v57, v56
    v_accvgpr_write_b32 a114, v56
    v_accvgpr_read_b32 v56, a115
    v_lshlrev_b32 v57, 16, v56
    v_and_b32 v56, 0xffff0000, v56
    v_ldexp_f32 v57, v57, v42
    v_ldexp_f32 v56, v56, v42
    v_cvt_pk_bf16_f32 v56, v57, v56
    v_accvgpr_write_b32 a115, v56
    v_accvgpr_read_b32 v56, a116
    v_lshlrev_b32 v57, 16, v56
    v_and_b32 v56, 0xffff0000, v56
    v_ldexp_f32 v57, v57, v43
    v_ldexp_f32 v56, v56, v43
    v_cvt_pk_bf16_f32 v56, v57, v56
    v_accvgpr_write_b32 a116, v56
    v_accvgpr_read_b32 v56, a117
    v_lshlrev_b32 v57, 16, v56
    v_and_b32 v56, 0xffff0000, v56
    v_ldexp_f32 v57, v57, v43
    v_ldexp_f32 v56, v56, v43
    v_cvt_pk_bf16_f32 v56, v57, v56
    v_accvgpr_write_b32 a117, v56
    v_accvgpr_read_b32 v56, a118
    v_lshlrev_b32 v57, 16, v56
    v_and_b32 v56, 0xffff0000, v56
    v_ldexp_f32 v57, v57, v43
    v_ldexp_f32 v56, v56, v43
    v_cvt_pk_bf16_f32 v56, v57, v56
    v_accvgpr_write_b32 a118, v56
    v_accvgpr_read_b32 v56, a119
    v_lshlrev_b32 v57, 16, v56
    v_and_b32 v56, 0xffff0000, v56
    v_ldexp_f32 v57, v57, v43
    v_ldexp_f32 v56, v56, v43
    v_cvt_pk_bf16_f32 v56, v57, v56
    v_accvgpr_write_b32 a119, v56
L_fix_14:
    v_accvgpr_read_b32 v56, a104
    v_lshlrev_b32 v57, 16, v56
    v_and_b32 v56, 0xffff0000, v56
    v_ldexp_f32 v57, v57, v42
    v_ldexp_f32 v56, v56, v42
    v_cvt_pk_bf16_f32 v56, v57, v56
    v_accvgpr_write_b32 a104, v56
    v_accvgpr_read_b32 v56, a105
    v_lshlrev_b32 v57, 16, v56
    v_and_b32 v56, 0xffff0000, v56
    v_ldexp_f32 v57, v57, v42
    v_ldexp_f32 v56, v56, v42
    v_cvt_pk_bf16_f32 v56, v57, v56
    v_accvgpr_write_b32 a105, v56
    v_accvgpr_read_b32 v56, a106
    v_lshlrev_b32 v57, 16, v56
    v_and_b32 v56, 0xffff0000, v56
    v_ldexp_f32 v57, v57, v42
    v_ldexp_f32 v56, v56, v42
    v_cvt_pk_bf16_f32 v56, v57, v56
    v_accvgpr_write_b32 a106, v56
    v_accvgpr_read_b32 v56, a107
    v_lshlrev_b32 v57, 16, v56
    v_and_b32 v56, 0xffff0000, v56
    v_ldexp_f32 v57, v57, v42
    v_ldexp_f32 v56, v56, v42
    v_cvt_pk_bf16_f32 v56, v57, v56
    v_accvgpr_write_b32 a107, v56
    v_accvgpr_read_b32 v56, a108
    v_lshlrev_b32 v57, 16, v56
    v_and_b32 v56, 0xffff0000, v56
    v_ldexp_f32 v57, v57, v43
    v_ldexp_f32 v56, v56, v43
    v_cvt_pk_bf16_f32 v56, v57, v56
    v_accvgpr_write_b32 a108, v56
    v_accvgpr_read_b32 v56, a109
    v_lshlrev_b32 v57, 16, v56
    v_and_b32 v56, 0xffff0000, v56
    v_ldexp_f32 v57, v57, v43
    v_ldexp_f32 v56, v56, v43
    v_cvt_pk_bf16_f32 v56, v57, v56
    v_accvgpr_write_b32 a109, v56
    v_accvgpr_read_b32 v56, a110
    v_lshlrev_b32 v57, 16, v56
    v_and_b32 v56, 0xffff0000, v56
    v_ldexp_f32 v57, v57, v43
    v_ldexp_f32 v56, v56, v43
    v_cvt_pk_bf16_f32 v56, v57, v56
    v_accvgpr_write_b32 a110, v56
    v_accvgpr_read_b32 v56, a111
    v_lshlrev_b32 v57, 16, v56
    v_and_b32 v56, 0xffff0000, v56
    v_ldexp_f32 v57, v57, v43
    v_ldexp_f32 v56, v56, v43
    v_cvt_pk_bf16_f32 v56, v57, v56
    v_accvgpr_write_b32 a111, v56
L_fix_13:
    v_accvgpr_read_b32 v56, a96
    v_lshlrev_b32 v57, 16, v56
    v_and_b32 v56, 0xffff0000, v56
    v_ldexp_f32 v57, v57, v42
    v_ldexp_f32 v56, v56, v42
    v_cvt_pk_bf16_f32 v56, v57, v56
    v_accvgpr_write_b32 a96, v56
    v_accvgpr_read_b32 v56, a97
    v_lshlrev_b32 v57, 16, v56
    v_and_b32 v56, 0xffff0000, v56
    v_ldexp_f32 v57, v57, v42
    v_ldexp_f32 v56, v56, v42
    v_cvt_pk_bf16_f32 v56, v57, v56
    v_accvgpr_write_b32 a97, v56
    v_accvgpr_read_b32 v56, a98
    v_lshlrev_b32 v57, 16, v56
    v_and_b32 v56, 0xffff0000, v56
    v_ldexp_f32 v57, v57, v42
    v_ldexp_f32 v56, v56, v42
    v_cvt_pk_bf16_f32 v56, v57, v56
    v_accvgpr_write_b32 a98, v56
    v_accvgpr_read_b32 v56, a99
    v_lshlrev_b32 v57, 16, v56
    v_and_b32 v56, 0xffff0000, v56
    v_ldexp_f32 v57, v57, v42
    v_ldexp_f32 v56, v56, v42
    v_cvt_pk_bf16_f32 v56, v57, v56
    v_accvgpr_write_b32 a99, v56
    v_accvgpr_read_b32 v56, a100
    v_lshlrev_b32 v57, 16, v56
    v_and_b32 v56, 0xffff0000, v56
    v_ldexp_f32 v57, v57, v43
    v_ldexp_f32 v56, v56, v43
    v_cvt_pk_bf16_f32 v56, v57, v56
    v_accvgpr_write_b32 a100, v56
    v_accvgpr_read_b32 v56, a101
    v_lshlrev_b32 v57, 16, v56
    v_and_b32 v56, 0xffff0000, v56
    v_ldexp_f32 v57, v57, v43
    v_ldexp_f32 v56, v56, v43
    v_cvt_pk_bf16_f32 v56, v57, v56
    v_accvgpr_write_b32 a101, v56
    v_accvgpr_read_b32 v56, a102
    v_lshlrev_b32 v57, 16, v56
    v_and_b32 v56, 0xffff0000, v56
    v_ldexp_f32 v57, v57, v43
    v_ldexp_f32 v56, v56, v43
    v_cvt_pk_bf16_f32 v56, v57, v56
    v_accvgpr_write_b32 a102, v56
    v_accvgpr_read_b32 v56, a103
    v_lshlrev_b32 v57, 16, v56
    v_and_b32 v56, 0xffff0000, v56
    v_ldexp_f32 v57, v57, v43
    v_ldexp_f32 v56, v56, v43
    v_cvt_pk_bf16_f32 v56, v57, v56
    v_accvgpr_write_b32 a103, v56
L_fix_12:
    v_accvgpr_read_b32 v56, a88
    v_lshlrev_b32 v57, 16, v56
    v_and_b32 v56, 0xffff0000, v56
    v_ldexp_f32 v57, v57, v42
    v_ldexp_f32 v56, v56, v42
    v_cvt_pk_bf16_f32 v56, v57, v56
    v_accvgpr_write_b32 a88, v56
    v_accvgpr_read_b32 v56, a89
    v_lshlrev_b32 v57, 16, v56
    v_and_b32 v56, 0xffff0000, v56
    v_ldexp_f32 v57, v57, v42
    v_ldexp_f32 v56, v56, v42
    v_cvt_pk_bf16_f32 v56, v57, v56
    v_accvgpr_write_b32 a89, v56
    v_accvgpr_read_b32 v56, a90
    v_lshlrev_b32 v57, 16, v56
    v_and_b32 v56, 0xffff0000, v56
    v_ldexp_f32 v57, v57, v42
    v_ldexp_f32 v56, v56, v42
    v_cvt_pk_bf16_f32 v56, v57, v56
    v_accvgpr_write_b32 a90, v56
    v_accvgpr_read_b32 v56, a91
    v_lshlrev_b32 v57, 16, v56
    v_and_b32 v56, 0xffff0000, v56
    v_ldexp_f32 v57, v57, v42
    v_ldexp_f32 v56, v56, v42
    v_cvt_pk_bf16_f32 v56, v57, v56
    v_accvgpr_write_b32 a91, v56
    v_accvgpr_read_b32 v56, a92
    v_lshlrev_b32 v57, 16, v56
    v_and_b32 v56, 0xffff0000, v56
    v_ldexp_f32 v57, v57, v43
    v_ldexp_f32 v56, v56, v43
    v_cvt_pk_bf16_f32 v56, v57, v56
    v_accvgpr_write_b32 a92, v56
    v_accvgpr_read_b32 v56, a93
    v_lshlrev_b32 v57, 16, v56
    v_and_b32 v56, 0xffff0000, v56
    v_ldexp_f32 v57, v57, v43
    v_ldexp_f32 v56, v56, v43
    v_cvt_pk_bf16_f32 v56, v57, v56
    v_accvgpr_write_b32 a93, v56
    v_accvgpr_read_b32 v56, a94
    v_lshlrev_b32 v57, 16, v56
    v_and_b32 v56, 0xffff0000, v56
    v_ldexp_f32 v57, v57, v43
    v_ldexp_f32 v56, v56, v43
    v_cvt_pk_bf16_f32 v56, v57, v56
    v_accvgpr_write_b32 a94, v56
    v_accvgpr_read_b32 v56, a95
    v_lshlrev_b32 v57, 16, v56
    v_and_b32 v56, 0xffff0000, v56
    v_ldexp_f32 v57, v57, v43
    v_ldexp_f32 v56, v56, v43
    v_cvt_pk_bf16_f32 v56, v57, v56
    v_accvgpr_write_b32 a95, v56
L_fix_11:
    v_accvgpr_read_b32 v56, a80
    v_lshlrev_b32 v57, 16, v56
    v_and_b32 v56, 0xffff0000, v56
    v_ldexp_f32 v57, v57, v42
    v_ldexp_f32 v56, v56, v42
    v_cvt_pk_bf16_f32 v56, v57, v56
    v_accvgpr_write_b32 a80, v56
    v_accvgpr_read_b32 v56, a81
    v_lshlrev_b32 v57, 16, v56
    v_and_b32 v56, 0xffff0000, v56
    v_ldexp_f32 v57, v57, v42
    v_ldexp_f32 v56, v56, v42
    v_cvt_pk_bf16_f32 v56, v57, v56
    v_accvgpr_write_b32 a81, v56
    v_accvgpr_read_b32 v56, a82
    v_lshlrev_b32 v57, 16, v56
    v_and_b32 v56, 0xffff0000, v56
    v_ldexp_f32 v57, v57, v42
    v_ldexp_f32 v56, v56, v42
    v_cvt_pk_bf16_f32 v56, v57, v56
    v_accvgpr_write_b32 a82, v56
    v_accvgpr_read_b32 v56, a83
    v_lshlrev_b32 v57, 16, v56
    v_and_b32 v56, 0xffff0000, v56
    v_ldexp_f32 v57, v57, v42
    v_ldexp_f32 v56, v56, v42
    v_cvt_pk_bf16_f32 v56, v57, v56
    v_accvgpr_write_b32 a83, v56
    v_accvgpr_read_b32 v56, a84
    v_lshlrev_b32 v57, 16, v56
    v_and_b32 v56, 0xffff0000, v56
    v_ldexp_f32 v57, v57, v43
    v_ldexp_f32 v56, v56, v43
    v_cvt_pk_bf16_f32 v56, v57, v56
    v_accvgpr_write_b32 a84, v56
    v_accvgpr_read_b32 v56, a85
    v_lshlrev_b32 v57, 16, v56
    v_and_b32 v56, 0xffff0000, v56
    v_ldexp_f32 v57, v57, v43
    v_ldexp_f32 v56, v56, v43
    v_cvt_pk_bf16_f32 v56, v57, v56
    v_accvgpr_write_b32 a85, v56
    v_accvgpr_read_b32 v56, a86
    v_lshlrev_b32 v57, 16, v56
    v_and_b32 v56, 0xffff0000, v56
    v_ldexp_f32 v57, v57, v43
    v_ldexp_f32 v56, v56, v43
    v_cvt_pk_bf16_f32 v56, v57, v56
    v_accvgpr_write_b32 a86, v56
    v_accvgpr_read_b32 v56, a87
    v_lshlrev_b32 v57, 16, v56
    v_and_b32 v56, 0xffff0000, v56
    v_ldexp_f32 v57, v57, v43
    v_ldexp_f32 v56, v56, v43
    v_cvt_pk_bf16_f32 v56, v57, v56
    v_accvgpr_write_b32 a87, v56
L_fix_10:
    v_accvgpr_read_b32 v56, a72
    v_lshlrev_b32 v57, 16, v56
    v_and_b32 v56, 0xffff0000, v56
    v_ldexp_f32 v57, v57, v42
    v_ldexp_f32 v56, v56, v42
    v_cvt_pk_bf16_f32 v56, v57, v56
    v_accvgpr_write_b32 a72, v56
    v_accvgpr_read_b32 v56, a73
    v_lshlrev_b32 v57, 16, v56
    v_and_b32 v56, 0xffff0000, v56
    v_ldexp_f32 v57, v57, v42
    v_ldexp_f32 v56, v56, v42
    v_cvt_pk_bf16_f32 v56, v57, v56
    v_accvgpr_write_b32 a73, v56
    v_accvgpr_read_b32 v56, a74
    v_lshlrev_b32 v57, 16, v56
    v_and_b32 v56, 0xffff0000, v56
    v_ldexp_f32 v57, v57, v42
    v_ldexp_f32 v56, v56, v42
    v_cvt_pk_bf16_f32 v56, v57, v56
    v_accvgpr_write_b32 a74, v56
    v_accvgpr_read_b32 v56, a75
    v_lshlrev_b32 v57, 16, v56
    v_and_b32 v56, 0xffff0000, v56
    v_ldexp_f32 v57, v57, v42
    v_ldexp_f32 v56, v56, v42
    v_cvt_pk_bf16_f32 v56, v57, v56
    v_accvgpr_write_b32 a75, v56
    v_accvgpr_read_b32 v56, a76
    v_lshlrev_b32 v57, 16, v56
    v_and_b32 v56, 0xffff0000, v56
    v_ldexp_f32 v57, v57, v43
    v_ldexp_f32 v56, v56, v43
    v_cvt_pk_bf16_f32 v56, v57, v56
    v_accvgpr_write_b32 a76, v56
    v_accvgpr_read_b32 v56, a77
    v_lshlrev_b32 v57, 16, v56
    v_and_b32 v56, 0xffff0000, v56
    v_ldexp_f32 v57, v57, v43
    v_ldexp_f32 v56, v56, v43
    v_cvt_pk_bf16_f32 v56, v57, v56
    v_accvgpr_write_b32 a77, v56
    v_accvgpr_read_b32 v56, a78
    v_lshlrev_b32 v57, 16, v56
    v_and_b32 v56, 0xffff0000, v56
    v_ldexp_f32 v57, v57, v43
    v_ldexp_f32 v56, v56, v43
    v_cvt_pk_bf16_f32 v56, v57, v56
    v_accvgpr_write_b32 a78, v56
    v_accvgpr_read_b32 v56, a79
    v_lshlrev_b32 v57, 16, v56
    v_and_b32 v56, 0xffff0000, v56
    v_ldexp_f32 v57, v57, v43
    v_ldexp_f32 v56, v56, v43
    v_cvt_pk_bf16_f32 v56, v57, v56
    v_accvgpr_write_b32 a79, v56
L_fix_9:
    v_accvgpr_read_b32 v56, a64
    v_lshlrev_b32 v57, 16, v56
    v_and_b32 v56, 0xffff0000, v56
    v_ldexp_f32 v57, v57, v42
    v_ldexp_f32 v56, v56, v42
    v_cvt_pk_bf16_f32 v56, v57, v56
    v_accvgpr_write_b32 a64, v56
    v_accvgpr_read_b32 v56, a65
    v_lshlrev_b32 v57, 16, v56
    v_and_b32 v56, 0xffff0000, v56
    v_ldexp_f32 v57, v57, v42
    v_ldexp_f32 v56, v56, v42
    v_cvt_pk_bf16_f32 v56, v57, v56
    v_accvgpr_write_b32 a65, v56
    v_accvgpr_read_b32 v56, a66
    v_lshlrev_b32 v57, 16, v56
    v_and_b32 v56, 0xffff0000, v56
    v_ldexp_f32 v57, v57, v42
    v_ldexp_f32 v56, v56, v42
    v_cvt_pk_bf16_f32 v56, v57, v56
    v_accvgpr_write_b32 a66, v56
    v_accvgpr_read_b32 v56, a67
    v_lshlrev_b32 v57, 16, v56
    v_and_b32 v56, 0xffff0000, v56
    v_ldexp_f32 v57, v57, v42
    v_ldexp_f32 v56, v56, v42
    v_cvt_pk_bf16_f32 v56, v57, v56
    v_accvgpr_write_b32 a67, v56
    v_accvgpr_read_b32 v56, a68
    v_lshlrev_b32 v57, 16, v56
    v_and_b32 v56, 0xffff0000, v56
    v_ldexp_f32 v57, v57, v43
    v_ldexp_f32 v56, v56, v43
    v_cvt_pk_bf16_f32 v56, v57, v56
    v_accvgpr_write_b32 a68, v56
    v_accvgpr_read_b32 v56, a69
    v_lshlrev_b32 v57, 16, v56
    v_and_b32 v56, 0xffff0000, v56
    v_ldexp_f32 v57, v57, v43
    v_ldexp_f32 v56, v56, v43
    v_cvt_pk_bf16_f32 v56, v57, v56
    v_accvgpr_write_b32 a69, v56
    v_accvgpr_read_b32 v56, a70
    v_lshlrev_b32 v57, 16, v56
    v_and_b32 v56, 0xffff0000, v56
    v_ldexp_f32 v57, v57, v43
    v_ldexp_f32 v56, v56, v43
    v_cvt_pk_bf16_f32 v56, v57, v56
    v_accvgpr_write_b32 a70, v56
    v_accvgpr_read_b32 v56, a71
    v_lshlrev_b32 v57, 16, v56
    v_and_b32 v56, 0xffff0000, v56
    v_ldexp_f32 v57, v57, v43
    v_ldexp_f32 v56, v56, v43
    v_cvt_pk_bf16_f32 v56, v57, v56
    v_accvgpr_write_b32 a71, v56
L_fix_8:
    v_accvgpr_read_b32 v56, a56
    v_lshlrev_b32 v57, 16, v56
    v_and_b32 v56, 0xffff0000, v56
    v_ldexp_f32 v57, v57, v42
    v_ldexp_f32 v56, v56, v42
    v_cvt_pk_bf16_f32 v56, v57, v56
    v_accvgpr_write_b32 a56, v56
    v_accvgpr_read_b32 v56, a57
    v_lshlrev_b32 v57, 16, v56
    v_and_b32 v56, 0xffff0000, v56
    v_ldexp_f32 v57, v57, v42
    v_ldexp_f32 v56, v56, v42
    v_cvt_pk_bf16_f32 v56, v57, v56
    v_accvgpr_write_b32 a57, v56
    v_accvgpr_read_b32 v56, a58
    v_lshlrev_b32 v57, 16, v56
    v_and_b32 v56, 0xffff0000, v56
    v_ldexp_f32 v57, v57, v42
    v_ldexp_f32 v56, v56, v42
    v_cvt_pk_bf16_f32 v56, v57, v56
    v_accvgpr_write_b32 a58, v56
    v_accvgpr_read_b32 v56, a59
    v_lshlrev_b32 v57, 16, v56
    v_and_b32 v56, 0xffff0000, v56
    v_ldexp_f32 v57, v57, v42
    v_ldexp_f32 v56, v56, v42
    v_cvt_pk_bf16_f32 v56, v57, v56
    v_accvgpr_write_b32 a59, v56
    v_accvgpr_read_b32 v56, a60
    v_lshlrev_b32 v57, 16, v56
    v_and_b32 v56, 0xffff0000, v56
    v_ldexp_f32 v57, v57, v43
    v_ldexp_f32 v56, v56, v43
    v_cvt_pk_bf16_f32 v56, v57, v56
    v_accvgpr_write_b32 a60, v56
    v_accvgpr_read_b32 v56, a61
    v_lshlrev_b32 v57, 16, v56
    v_and_b32 v56, 0xffff0000, v56
    v_ldexp_f32 v57, v57, v43
    v_ldexp_f32 v56, v56, v43
    v_cvt_pk_bf16_f32 v56, v57, v56
    v_accvgpr_write_b32 a61, v56
    v_accvgpr_read_b32 v56, a62
    v_lshlrev_b32 v57, 16, v56
    v_and_b32 v56, 0xffff0000, v56
    v_ldexp_f32 v57, v57, v43
    v_ldexp_f32 v56, v56, v43
    v_cvt_pk_bf16_f32 v56, v57, v56
    v_accvgpr_write_b32 a62, v56
    v_accvgpr_read_b32 v56, a63
    v_lshlrev_b32 v57, 16, v56
    v_and_b32 v56, 0xffff0000, v56
    v_ldexp_f32 v57, v57, v43
    v_ldexp_f32 v56, v56, v43
    v_cvt_pk_bf16_f32 v56, v57, v56
    v_accvgpr_write_b32 a63, v56
L_fix_7:
    v_accvgpr_read_b32 v56, a48
    v_lshlrev_b32 v57, 16, v56
    v_and_b32 v56, 0xffff0000, v56
    v_ldexp_f32 v57, v57, v42
    v_ldexp_f32 v56, v56, v42
    v_cvt_pk_bf16_f32 v56, v57, v56
    v_accvgpr_write_b32 a48, v56
    v_accvgpr_read_b32 v56, a49
    v_lshlrev_b32 v57, 16, v56
    v_and_b32 v56, 0xffff0000, v56
    v_ldexp_f32 v57, v57, v42
    v_ldexp_f32 v56, v56, v42
    v_cvt_pk_bf16_f32 v56, v57, v56
    v_accvgpr_write_b32 a49, v56
    v_accvgpr_read_b32 v56, a50
    v_lshlrev_b32 v57, 16, v56
    v_and_b32 v56, 0xffff0000, v56
    v_ldexp_f32 v57, v57, v42
    v_ldexp_f32 v56, v56, v42
    v_cvt_pk_bf16_f32 v56, v57, v56
    v_accvgpr_write_b32 a50, v56
    v_accvgpr_read_b32 v56, a51
    v_lshlrev_b32 v57, 16, v56
    v_and_b32 v56, 0xffff0000, v56
    v_ldexp_f32 v57, v57, v42
    v_ldexp_f32 v56, v56, v42
    v_cvt_pk_bf16_f32 v56, v57, v56
    v_accvgpr_write_b32 a51, v56
    v_accvgpr_read_b32 v56, a52
    v_lshlrev_b32 v57, 16, v56
    v_and_b32 v56, 0xffff0000, v56
    v_ldexp_f32 v57, v57, v43
    v_ldexp_f32 v56, v56, v43
    v_cvt_pk_bf16_f32 v56, v57, v56
    v_accvgpr_write_b32 a52, v56
    v_accvgpr_read_b32 v56, a53
    v_lshlrev_b32 v57, 16, v56
    v_and_b32 v56, 0xffff0000, v56
    v_ldexp_f32 v57, v57, v43
    v_ldexp_f32 v56, v56, v43
    v_cvt_pk_bf16_f32 v56, v57, v56
    v_accvgpr_write_b32 a53, v56
    v_accvgpr_read_b32 v56, a54
    v_lshlrev_b32 v57, 16, v56
    v_and_b32 v56, 0xffff0000, v56
    v_ldexp_f32 v57, v57, v43
    v_ldexp_f32 v56, v56, v43
    v_cvt_pk_bf16_f32 v56, v57, v56
    v_accvgpr_write_b32 a54, v56
    v_accvgpr_read_b32 v56, a55
    v_lshlrev_b32 v57, 16, v56
    v_and_b32 v56, 0xffff0000, v56
    v_ldexp_f32 v57, v57, v43
    v_ldexp_f32 v56, v56, v43
    v_cvt_pk_bf16_f32 v56, v57, v56
    v_accvgpr_write_b32 a55, v56
L_fix_6:
    v_accvgpr_read_b32 v56, a40
    v_lshlrev_b32 v57, 16, v56
    v_and_b32 v56, 0xffff0000, v56
    v_ldexp_f32 v57, v57, v42
    v_ldexp_f32 v56, v56, v42
    v_cvt_pk_bf16_f32 v56, v57, v56
    v_accvgpr_write_b32 a40, v56
    v_accvgpr_read_b32 v56, a41
    v_lshlrev_b32 v57, 16, v56
    v_and_b32 v56, 0xffff0000, v56
    v_ldexp_f32 v57, v57, v42
    v_ldexp_f32 v56, v56, v42
    v_cvt_pk_bf16_f32 v56, v57, v56
    v_accvgpr_write_b32 a41, v56
    v_accvgpr_read_b32 v56, a42
    v_lshlrev_b32 v57, 16, v56
    v_and_b32 v56, 0xffff0000, v56
    v_ldexp_f32 v57, v57, v42
    v_ldexp_f32 v56, v56, v42
    v_cvt_pk_bf16_f32 v56, v57, v56
    v_accvgpr_write_b32 a42, v56
    v_accvgpr_read_b32 v56, a43
    v_lshlrev_b32 v57, 16, v56
    v_and_b32 v56, 0xffff0000, v56
    v_ldexp_f32 v57, v57, v42
    v_ldexp_f32 v56, v56, v42
    v_cvt_pk_bf16_f32 v56, v57, v56
    v_accvgpr_write_b32 a43, v56
    v_accvgpr_read_b32 v56, a44
    v_lshlrev_b32 v57, 16, v56
    v_and_b32 v56, 0xffff0000, v56
    v_ldexp_f32 v57, v57, v43
    v_ldexp_f32 v56, v56, v43
    v_cvt_pk_bf16_f32 v56, v57, v56
    v_accvgpr_write_b32 a44, v56
    v_accvgpr_read_b32 v56, a45
    v_lshlrev_b32 v57, 16, v56
    v_and_b32 v56, 0xffff0000, v56
    v_ldexp_f32 v57, v57, v43
    v_ldexp_f32 v56, v56, v43
    v_cvt_pk_bf16_f32 v56, v57, v56
    v_accvgpr_write_b32 a45, v56
    v_accvgpr_read_b32 v56, a46
    v_lshlrev_b32 v57, 16, v56
    v_and_b32 v56, 0xffff0000, v56
    v_ldexp_f32 v57, v57, v43
    v_ldexp_f32 v56, v56, v43
    v_cvt_pk_bf16_f32 v56, v57, v56
    v_accvgpr_write_b32 a46, v56
    v_accvgpr_read_b32 v56, a47
    v_lshlrev_b32 v57, 16, v56
    v_and_b32 v56, 0xffff0000, v56
    v_ldexp_f32 v57, v57, v43
    v_ldexp_f32 v56, v56, v43
    v_cvt_pk_bf16_f32 v56, v57, v56
    v_accvgpr_write_b32 a47, v56
L_fix_5:
    v_accvgpr_read_b32 v56, a32
    v_lshlrev_b32 v57, 16, v56
    v_and_b32 v56, 0xffff0000, v56
    v_ldexp_f32 v57, v57, v42
    v_ldexp_f32 v56, v56, v42
    v_cvt_pk_bf16_f32 v56, v57, v56
    v_accvgpr_write_b32 a32, v56
    v_accvgpr_read_b32 v56, a33
    v_lshlrev_b32 v57, 16, v56
    v_and_b32 v56, 0xffff0000, v56
    v_ldexp_f32 v57, v57, v42
    v_ldexp_f32 v56, v56, v42
    v_cvt_pk_bf16_f32 v56, v57, v56
    v_accvgpr_write_b32 a33, v56
    v_accvgpr_read_b32 v56, a34
    v_lshlrev_b32 v57, 16, v56
    v_and_b32 v56, 0xffff0000, v56
    v_ldexp_f32 v57, v57, v42
    v_ldexp_f32 v56, v56, v42
    v_cvt_pk_bf16_f32 v56, v57, v56
    v_accvgpr_write_b32 a34, v56
    v_accvgpr_read_b32 v56, a35
    v_lshlrev_b32 v57, 16, v56
    v_and_b32 v56, 0xffff0000, v56
    v_ldexp_f32 v57, v57, v42
    v_ldexp_f32 v56, v56, v42
    v_cvt_pk_bf16_f32 v56, v57, v56
    v_accvgpr_write_b32 a35, v56
    v_accvgpr_read_b32 v56, a36
    v_lshlrev_b32 v57, 16, v56
    v_and_b32 v56, 0xffff0000, v56
    v_ldexp_f32 v57, v57, v43
    v_ldexp_f32 v56, v56, v43
    v_cvt_pk_bf16_f32 v56, v57, v56
    v_accvgpr_write_b32 a36, v56
    v_accvgpr_read_b32 v56, a37
    v_lshlrev_b32 v57, 16, v56
    v_and_b32 v56, 0xffff0000, v56
    v_ldexp_f32 v57, v57, v43
    v_ldexp_f32 v56, v56, v43
    v_cvt_pk_bf16_f32 v56, v57, v56
    v_accvgpr_write_b32 a37, v56
    v_accvgpr_read_b32 v56, a38
    v_lshlrev_b32 v57, 16, v56
    v_and_b32 v56, 0xffff0000, v56
    v_ldexp_f32 v57, v57, v43
    v_ldexp_f32 v56, v56, v43
    v_cvt_pk_bf16_f32 v56, v57, v56
    v_accvgpr_write_b32 a38, v56
    v_accvgpr_read_b32 v56, a39
    v_lshlrev_b32 v57, 16, v56
    v_and_b32 v56, 0xffff0000, v56
    v_ldexp_f32 v57, v57, v43
    v_ldexp_f32 v56, v56, v43
    v_cvt_pk_bf16_f32 v56, v57, v56
    v_accvgpr_write_b32 a39, v56
L_fix_4:
    v_accvgpr_read_b32 v56, a24
    v_lshlrev_b32 v57, 16, v56
    v_and_b32 v56, 0xffff0000, v56
    v_ldexp_f32 v57, v57, v42
    v_ldexp_f32 v56, v56, v42
    v_cvt_pk_bf16_f32 v56, v57, v56
    v_accvgpr_write_b32 a24, v56
    v_accvgpr_read_b32 v56, a25
    v_lshlrev_b32 v57, 16, v56
    v_and_b32 v56, 0xffff0000, v56
    v_ldexp_f32 v57, v57, v42
    v_ldexp_f32 v56, v56, v42
    v_cvt_pk_bf16_f32 v56, v57, v56
    v_accvgpr_write_b32 a25, v56
    v_accvgpr_read_b32 v56, a26
    v_lshlrev_b32 v57, 16, v56
    v_and_b32 v56, 0xffff0000, v56
    v_ldexp_f32 v57, v57, v42
    v_ldexp_f32 v56, v56, v42
    v_cvt_pk_bf16_f32 v56, v57, v56
    v_accvgpr_write_b32 a26, v56
    v_accvgpr_read_b32 v56, a27
    v_lshlrev_b32 v57, 16, v56
    v_and_b32 v56, 0xffff0000, v56
    v_ldexp_f32 v57, v57, v42
    v_ldexp_f32 v56, v56, v42
    v_cvt_pk_bf16_f32 v56, v57, v56
    v_accvgpr_write_b32 a27, v56
    v_accvgpr_read_b32 v56, a28
    v_lshlrev_b32 v57, 16, v56
    v_and_b32 v56, 0xffff0000, v56
    v_ldexp_f32 v57, v57, v43
    v_ldexp_f32 v56, v56, v43
    v_cvt_pk_bf16_f32 v56, v57, v56
    v_accvgpr_write_b32 a28, v56
    v_accvgpr_read_b32 v56, a29
    v_lshlrev_b32 v57, 16, v56
    v_and_b32 v56, 0xffff0000, v56
    v_ldexp_f32 v57, v57, v43
    v_ldexp_f32 v56, v56, v43
    v_cvt_pk_bf16_f32 v56, v57, v56
    v_accvgpr_write_b32 a29, v56
    v_accvgpr_read_b32 v56, a30
    v_lshlrev_b32 v57, 16, v56
    v_and_b32 v56, 0xffff0000, v56
    v_ldexp_f32 v57, v57, v43
    v_ldexp_f32 v56, v56, v43
    v_cvt_pk_bf16_f32 v56, v57, v56
    v_accvgpr_write_b32 a30, v56
    v_accvgpr_read_b32 v56, a31
    v_lshlrev_b32 v57, 16, v56
    v_and_b32 v56, 0xffff0000, v56
    v_ldexp_f32 v57, v57, v43
    v_ldexp_f32 v56, v56, v43
    v_cvt_pk_bf16_f32 v56, v57, v56
    v_accvgpr_write_b32 a31, v56
L_fix_3:
    v_accvgpr_read_b32 v56, a16
    v_lshlrev_b32 v57, 16, v56
    v_and_b32 v56, 0xffff0000, v56
    v_ldexp_f32 v57, v57, v42
    v_ldexp_f32 v56, v56, v42
    v_cvt_pk_bf16_f32 v56, v57, v56
    v_accvgpr_write_b32 a16, v56
    v_accvgpr_read_b32 v56, a17
    v_lshlrev_b32 v57, 16, v56
    v_and_b32 v56, 0xffff0000, v56
    v_ldexp_f32 v57, v57, v42
    v_ldexp_f32 v56, v56, v42
    v_cvt_pk_bf16_f32 v56, v57, v56
    v_accvgpr_write_b32 a17, v56
    v_accvgpr_read_b32 v56, a18
    v_lshlrev_b32 v57, 16, v56
    v_and_b32 v56, 0xffff0000, v56
    v_ldexp_f32 v57, v57, v42
    v_ldexp_f32 v56, v56, v42
    v_cvt_pk_bf16_f32 v56, v57, v56
    v_accvgpr_write_b32 a18, v56
    v_accvgpr_read_b32 v56, a19
    v_lshlrev_b32 v57, 16, v56
    v_and_b32 v56, 0xffff0000, v56
    v_ldexp_f32 v57, v57, v42
    v_ldexp_f32 v56, v56, v42
    v_cvt_pk_bf16_f32 v56, v57, v56
    v_accvgpr_write_b32 a19, v56
    v_accvgpr_read_b32 v56, a20
    v_lshlrev_b32 v57, 16, v56
    v_and_b32 v56, 0xffff0000, v56
    v_ldexp_f32 v57, v57, v43
    v_ldexp_f32 v56, v56, v43
    v_cvt_pk_bf16_f32 v56, v57, v56
    v_accvgpr_write_b32 a20, v56
    v_accvgpr_read_b32 v56, a21
    v_lshlrev_b32 v57, 16, v56
    v_and_b32 v56, 0xffff0000, v56
    v_ldexp_f32 v57, v57, v43
    v_ldexp_f32 v56, v56, v43
    v_cvt_pk_bf16_f32 v56, v57, v56
    v_accvgpr_write_b32 a21, v56
    v_accvgpr_read_b32 v56, a22
    v_lshlrev_b32 v57, 16, v56
    v_and_b32 v56, 0xffff0000, v56
    v_ldexp_f32 v57, v57, v43
    v_ldexp_f32 v56, v56, v43
    v_cvt_pk_bf16_f32 v56, v57, v56
    v_accvgpr_write_b32 a22, v56
    v_accvgpr_read_b32 v56, a23
    v_lshlrev_b32 v57, 16, v56
    v_and_b32 v56, 0xffff0000, v56
    v_ldexp_f32 v57, v57, v43
    v_ldexp_f32 v56, v56, v43
    v_cvt_pk_bf16_f32 v56, v57, v56
    v_accvgpr_write_b32 a23, v56
L_fix_2:
    v_accvgpr_read_b32 v56, a8
    v_lshlrev_b32 v57, 16, v56
    v_and_b32 v56, 0xffff0000, v56
    v_ldexp_f32 v57, v57, v42
    v_ldexp_f32 v56, v56, v42
    v_cvt_pk_bf16_f32 v56, v57, v56
    v_accvgpr_write_b32 a8, v56
    v_accvgpr_read_b32 v56, a9
    v_lshlrev_b32 v57, 16, v56
    v_and_b32 v56, 0xffff0000, v56
    v_ldexp_f32 v57, v57, v42
    v_ldexp_f32 v56, v56, v42
    v_cvt_pk_bf16_f32 v56, v57, v56
    v_accvgpr_write_b32 a9, v56
    v_accvgpr_read_b32 v56, a10
    v_lshlrev_b32 v57, 16, v56
    v_and_b32 v56, 0xffff0000, v56
    v_ldexp_f32 v57, v57, v42
    v_ldexp_f32 v56, v56, v42
    v_cvt_pk_bf16_f32 v56, v57, v56
    v_accvgpr_write_b32 a10, v56
    v_accvgpr_read_b32 v56, a11
    v_lshlrev_b32 v57, 16, v56
    v_and_b32 v56, 0xffff0000, v56
    v_ldexp_f32 v57, v57, v42
    v_ldexp_f32 v56, v56, v42
    v_cvt_pk_bf16_f32 v56, v57, v56
    v_accvgpr_write_b32 a11, v56
    v_accvgpr_read_b32 v56, a12
    v_lshlrev_b32 v57, 16, v56
    v_and_b32 v56, 0xffff0000, v56
    v_ldexp_f32 v57, v57, v43
    v_ldexp_f32 v56, v56, v43
    v_cvt_pk_bf16_f32 v56, v57, v56
    v_accvgpr_write_b32 a12, v56
    v_accvgpr_read_b32 v56, a13
    v_lshlrev_b32 v57, 16, v56
    v_and_b32 v56, 0xffff0000, v56
    v_ldexp_f32 v57, v57, v43
    v_ldexp_f32 v56, v56, v43
    v_cvt_pk_bf16_f32 v56, v57, v56
    v_accvgpr_write_b32 a13, v56
    v_accvgpr_read_b32 v56, a14
    v_lshlrev_b32 v57, 16, v56
    v_and_b32 v56, 0xffff0000, v56
    v_ldexp_f32 v57, v57, v43
    v_ldexp_f32 v56, v56, v43
    v_cvt_pk_bf16_f32 v56, v57, v56
    v_accvgpr_write_b32 a14, v56
    v_accvgpr_read_b32 v56, a15
    v_lshlrev_b32 v57, 16, v56
    v_and_b32 v56, 0xffff0000, v56
    v_ldexp_f32 v57, v57, v43
    v_ldexp_f32 v56, v56, v43
    v_cvt_pk_bf16_f32 v56, v57, v56
    v_accvgpr_write_b32 a15, v56
L_fix_1:
    v_accvgpr_read_b32 v56, a0
    v_lshlrev_b32 v57, 16, v56
    v_and_b32 v56, 0xffff0000, v56
    v_ldexp_f32 v57, v57, v42
    v_ldexp_f32 v56, v56, v42
    v_cvt_pk_bf16_f32 v56, v57, v56
    v_accvgpr_write_b32 a0, v56
    v_accvgpr_read_b32 v56, a1
    v_lshlrev_b32 v57, 16, v56
    v_and_b32 v56, 0xffff0000, v56
    v_ldexp_f32 v57, v57, v42
    v_ldexp_f32 v56, v56, v42
    v_cvt_pk_bf16_f32 v56, v57, v56
    v_accvgpr_write_b32 a1, v56
    v_accvgpr_read_b32 v56, a2
    v_lshlrev_b32 v57, 16, v56
    v_and_b32 v56, 0xffff0000, v56
    v_ldexp_f32 v57, v57, v42
    v_ldexp_f32 v56, v56, v42
    v_cvt_pk_bf16_f32 v56, v57, v56
    v_accvgpr_write_b32 a2, v56
    v_accvgpr_read_b32 v56, a3
    v_lshlrev_b32 v57, 16, v56
    v_and_b32 v56, 0xffff0000, v56
    v_ldexp_f32 v57, v57, v42
    v_ldexp_f32 v56, v56, v42
    v_cvt_pk_bf16_f32 v56, v57, v56
    v_accvgpr_write_b32 a3, v56
    v_accvgpr_read_b32 v56, a4
    v_lshlrev_b32 v57, 16, v56
    v_and_b32 v56, 0xffff0000, v56
    v_ldexp_f32 v57, v57, v43
    v_ldexp_f32 v56, v56, v43
    v_cvt_pk_bf16_f32 v56, v57, v56
    v_accvgpr_write_b32 a4, v56
    v_accvgpr_read_b32 v56, a5
    v_lshlrev_b32 v57, 16, v56
    v_and_b32 v56, 0xffff0000, v56
    v_ldexp_f32 v57, v57, v43
    v_ldexp_f32 v56, v56, v43
    v_cvt_pk_bf16_f32 v56, v57, v56
    v_accvgpr_write_b32 a5, v56
    v_accvgpr_read_b32 v56, a6
    v_lshlrev_b32 v57, 16, v56
    v_and_b32 v56, 0xffff0000, v56
    v_ldexp_f32 v57, v57, v43
    v_ldexp_f32 v56, v56, v43
    v_cvt_pk_bf16_f32 v56, v57, v56
    v_accvgpr_write_b32 a6, v56
    v_accvgpr_read_b32 v56, a7
    v_lshlrev_b32 v57, 16, v56
    v_and_b32 v56, 0xffff0000, v56
    v_ldexp_f32 v57, v57, v43
    v_ldexp_f32 v56, v56, v43
    v_cvt_pk_bf16_f32 v56, v57, v56
    v_accvgpr_write_b32 a7, v56
    s_setpc_b64 s[32:33]
.section .rodata,"a"
.p2align 6
.amdhsa_kernel standalone__mha_block_cached__near_ridge_kernel
  .amdhsa_next_free_vgpr 512
  .amdhsa_next_free_sgpr 102
  .amdhsa_accum_offset 256
  .amdhsa_group_segment_fixed_size 0
  .amdhsa_kernarg_size 64
  .amdhsa_user_sgpr_count 2
  .amdhsa_user_sgpr_kernarg_segment_ptr 1
  .amdhsa_system_sgpr_workgroup_id_x 1
.end_amdhsa_kernel
```
